```python
import torch

def _softmax(x, axis=-1):
    return torch.softmax(x, dim=axis)
def _gelu(x):
    return torch.nn.functional.gelu(x, approximate="tanh")
def _silu(x):
    return torch.nn.functional.silu(x)
def _sigmoid(x):
    return torch.sigmoid(x)
def _layernorm(x, axis=-1, eps=1e-5):
    m = x.mean(dim=axis, keepdim=True)
    v = x.var(dim=axis, keepdim=True, unbiased=False)
    return (x - m) / torch.sqrt(v + eps)
def _scatter_add(tgt, idx, src, axis=0):
    return tgt.clone().index_add_(axis, idx, src)
def _segment_sum(src, seg, n):
    out = torch.zeros((n,) + src.shape[1:], dtype=src.dtype)
    return out.index_add_(0, seg, src)
def _pad(x, pw):
    flat = tuple(v for pair in reversed(pw) for v in pair)
    return torch.nn.functional.pad(x, flat)

kernel_name = 'parallel_sum__softmax_full_mha__glu_gated_glu__prompt'

def setup_inputs():

    _w = (lambda a: (lambda t: t.to(torch.bfloat16) if t.is_floating_point() else t)(torch.as_tensor(a)))
    def _A_setup():
        B, S, D = 1, 2048, 576
        return {
            "x": _w((lambda *s: torch.randn(*s, dtype=torch.bfloat16) * 0.05)(B, S, D)),
            "wqkv": _w((lambda *s: torch.randn(*s, dtype=torch.bfloat16) * 0.2)(D, 3 * D)),
            "wo": _w((lambda *s: torch.randn(*s, dtype=torch.bfloat16) * 0.1)(D, D)),
        }
    _A_in = _A_setup()

    def _B_setup():
        B, S, D, F = 1, 2048, 576, 4608
        return {
            "x": _w((lambda *s: torch.randn(*s, dtype=torch.bfloat16) * 0.05)(B, S, D)),
            "w_gate": _w((lambda *s: torch.randn(*s, dtype=torch.bfloat16) * 0.8)(D, F)),
            "w_up": _w((lambda *s: torch.randn(*s, dtype=torch.bfloat16) * 0.1)(D, F)),
            "w_down": _w((lambda *s: torch.randn(*s, dtype=torch.bfloat16) * 0.1)(F, D)),
        }
    _B_in = _B_setup()

    return {
        "A_x": _A_in["x"],
        "A_wqkv": _A_in["wqkv"],
        "A_wo": _A_in["wo"],
        "B_x": _B_in["x"],
        "B_w_gate": _B_in["w_gate"],
        "B_w_up": _B_in["w_up"],
        "B_w_down": _B_in["w_down"],
    }

def reference(A_x, A_wqkv, A_wo, B_x, B_w_gate, B_w_up, B_w_down):
    def _A_ref(x, wqkv, wo):
        B, S, D = x.shape
        H = 32; Dh = D // H
        qkv = (lambda x, *d: x.permute(*d))((x @ wqkv).reshape(B, S, 3, H, Dh), 2, 0, 3, 1, 4)
        q, k, v = qkv[0], qkv[1], qkv[2]
        scale = Dh ** -0.5
        scores = torch.einsum("bhqd,bhkd->bhqk", q, k) * scale
        p = _softmax(scores, axis=-1)
        o = torch.einsum("bhqk,bhkd->bhqd", p, v)
        return (lambda x, *d: x.permute(*d))(o, 0, 2, 1, 3).reshape(B, S, D) @ wo

    def _B_ref(x, w_gate, w_up, w_down):
        g = torch.einsum("bsd,df->bsf", x, w_gate)
        u = torch.einsum("bsd,df->bsf", x, w_up)
        h = _sigmoid(g) * u
        return torch.einsum("bsf,fd->bsd", h, w_down)

    x = A_x
    xn = _layernorm(x, axis=-1)
    return x + _A_ref(xn, A_wqkv, A_wo) + _B_ref(xn, B_w_gate, B_w_up, B_w_down)
```

```asm
; @launch grid=(256,1,1) block=(512,1,1) lds=163840
.amdgcn_target "amdgcn-amd-amdhsa--gfx950"
.text
.globl parallel_sum__softmax_full_mha__glu_gated_glu__prompt_kernel
.p2align 8
.type parallel_sum__softmax_full_mha__glu_gated_glu__prompt_kernel,@function
parallel_sum__softmax_full_mha__glu_gated_glu__prompt_kernel:
    s_cmp_ge_u32 s2, 256
    s_cbranch_scc1 L_g1_end
    s_load_dwordx4 s[36:39], s[0:1], 0
    s_load_dwordx4 s[4:7], s[0:1], 64
    s_load_dwordx4 s[8:11], s[0:1], 32
    s_load_dwordx2 s[52:53], s[0:1], 48
    s_load_dwordx2 s[54:55], s[0:1], 16
    s_memrealtime s[66:67]
    s_getpc_b64 s[40:41]
L_epf:
    v_lshlrev_b32 v2, 7, v0
    v_min_u32 v2, L_g1_end-L_epf, v2
    v_mov_b32 v3, s41
    v_add_co_u32 v2, vcc, s40, v2
    s_nop 1
    v_addc_co_u32 v3, vcc, 0, v3, vcc
    global_load_dword v43, v[2:3], off
    v_lshrrev_b32 v10, 6, v0
    v_and_b32 v16, 255, v0
    v_and_b32 v0, 63, v0
    v_readfirstlane_b32 s24, v10
    s_and_b32 s25, s2, 7
    s_lshl_b32 s25, s25, 2
    s_bfe_u32 s3, s2, 0x20003
    s_add_u32 s25, s25, s3
    s_lshr_b32 s26, s2, 5
    v_lshlrev_b32 v1, 4, v0
    v_mov_b32 v15, 0x80000000
    v_cmp_eq_u32 vcc, 0, v0
    s_and_b32 s31, s24, 3
    s_mov_b32 s43, 0x20000
    v_cndmask_b32 v13, v15, 0, vcc
    s_cmp_ge_u32 s24, 4
    s_cbranch_scc1 L_p0_b
    v_and_b32 v17, 31, v0
    v_lshrrev_b32 v18, 5, v16
    s_lshl_b32 s3, s26, 8
    s_lshl_b32 s40, s25, 3
    s_add_u32 s3, s3, s40
    s_mul_i32 s3, s3, 1152
    v_mul_u32_u24 v19, 1152, v18
    v_lshl_add_u32 v19, v17, 4, v19
    v_cmp_gt_u32 s[48:49], 24, v17
    s_mov_b32 s42, 2359296
    s_waitcnt lgkmcnt(0)
    v_cndmask_b32 v19, v15, v19, s[48:49]
    s_mov_b32 s40, s36
    s_and_b32 s41, s37, 0xffff
    s_mov_b64 s[68:69], s[40:41]
    buffer_load_dwordx4 v[20:23], v19, s[40:43], s3 offen
    buffer_load_dwordx4 v[24:27], v19, s[40:43], s3 offen offset:384
    buffer_load_dwordx4 v[28:31], v19, s[40:43], s3 offen offset:768
    s_mov_b32 s36, s4
    s_and_b32 s37, s5, 0xffff
    s_mov_b32 s38, 256
    s_mov_b32 s39, 0x20000
    s_branch L_p0_j1
L_p0_b:
    s_cmp_lg_u32 s24, 5
    s_cbranch_scc1 L_p0_b1
    s_mov_b64 s[48:49], 0
    s_mov_b64 exec, 0
    s_branch L_p0_ln2
L_p0_lnr:
    s_mov_b64 exec, -1
L_p0_b1:
    s_waitcnt lgkmcnt(0)
    s_mov_b32 s68, s38
    s_and_b32 s69, s39, 0xffff
    s_mov_b32 s36, s4
    s_and_b32 s37, s5, 0xffff
    s_mov_b32 s38, 256
    s_mov_b32 s39, 0x20000
    s_or_b32 s3, s66, 1
    v_mov_b32 v14, s3
    s_lshl_b32 s3, s2, 3
    s_add_u32 s3, s3, s24
    s_cmp_lg_u32 s3, 4
    s_cbranch_scc1 L_p0_nonce
    buffer_store_dword v14, v13, s[36:39], 0 offen sc0 sc1
L_p0_nonce:
    v_mov_b32 v41, 0
    v_mov_b32 v42, 132096
    ds_write_b32 v42, v41
    v_and_b32 v42, 7, v0
    v_lshlrev_b32 v42, 2, v42
    v_add_u32 v42, 162816, v42
    ds_write_b32 v42, v41
L_p0_j1:
    s_mov_b32 s20, s6
    s_and_b32 s21, s7, 0xffff
    s_mov_b32 s22, 49629184
    s_mov_b32 s23, 0x20000
    s_cmp_lg_u32 s24, 4
    s_cbranch_scc1 L_p0_ft
    v_lshlrev_b32 v20, 15, v0
    v_cmp_gt_u32 vcc, 2, v0
    s_lshl_b32 s3, s2, 7
    s_add_u32 s3, s3, 49291264
    v_cndmask_b32 v20, v15, v20, vcc
    buffer_load_dword v21, v20, s[20:23], s3 offen sc0 sc1
L_p0_ft:
    s_lshl_b32 s33, s26, 4
    s_lshl_b32 s3, s24, 1
    s_add_u32 s33, s33, s3
    s_mul_i32 s33, s33, 18432
    s_add_u32 s33, s33, 0
    s_add_u32 s34, s33, 18432
    s_lshl_b32 s30, s24, 11
    s_add_u32 s30, s30, 18432
    s_and_b32 s97, s2, 1
    s_lshl_b32 s97, s97, 7
    s_lshr_b32 s3, s2, 1
    s_add_u32 s97, s97, s3
    s_lshl_b32 s67, s97, 2
    s_mul_i32 s3, s97, 57
    s_lshr_b32 s3, s3, 9
    s_mul_i32 s40, s3, 9
    s_sub_u32 s40, s97, s40
    s_mul_i32 s56, s3, 288
    s_lshr_b32 s41, s40, 2
    s_mul_i32 s41, s41, 144
    s_and_b32 s42, s40, 3
    s_lshl_b32 s42, s42, 5
    s_add_u32 s41, s41, s42
    s_cmp_eq_u32 s40, 8
    s_cselect_b32 s41, 128, s41
    s_cselect_b32 s57, 4, 16
    s_cselect_b32 s58, 144, 8
    s_cselect_b32 s59, 8, 4
    s_add_u32 s56, s56, s41
    s_mov_b32 s60, 2
    s_mov_b32 s16, s52
    s_mov_b32 s17, s53
    s_mov_b32 s18, 5308416
    s_mov_b32 s19, 0x20000
    s_cmp_lt_u32 s97, 144
    s_cbranch_scc1 L_g1_pdone
    s_mov_b32 s16, s54
    s_mov_b32 s17, s55
    s_mov_b32 s18, 663552
    s_sub_u32 s3, s97, 144
    s_mul_i32 s56, s3, 36
    s_mov_b32 s57, 8
    s_mov_b32 s58, 18
    s_mov_b32 s59, 4
    s_cmp_lt_u32 s97, 160
    s_cbranch_scc1 L_g1_pdone
    s_sub_u32 s3, s97, 160
    s_mul_i32 s56, s3, 288
    s_add_u32 s56, s56, 16
    s_mov_b32 s57, 36
    s_mov_b32 s58, 144
    s_mov_b32 s59, 72
    s_mov_b32 s60, 18
    s_cmp_lt_u32 s97, 162
    s_cselect_b32 s18, s18, 0
L_g1_pdone:
    s_and_b32 s17, s17, 0xffff
    s_mul_i32 s56, s56, 1152
    s_mul_i32 s61, s97, 36864
    s_mul_i32 s3, s31, 9216
    s_add_u32 s61, s61, s3
    s_add_u32 s61, s61, 40370176
    s_cmp_lt_u32 s97, 162
    s_cselect_b32 s61, s61, 0x7fff0000
    s_mul_i32 s62, s24, 320
    s_movk_i32 s63, 1152
    s_cmp_ge_u32 s24, 6
    s_cbranch_scc1 L_g1_roleq
    s_cmp_ge_u32 s24, 3
    s_cselect_b32 s3, 3, 0
    s_sub_u32 s3, s24, s3
    s_mul_i32 s40, s3, 192
    v_add_u32 v10, s40, v0
    v_add_u32 v10, 0, v10
    v_mul_u32_u24 v11, 3641, v10
    v_lshrrev_b32 v11, 16, v11
    v_mul_u32_u24 v12, 18, v11
    v_sub_u32 v12, v10, v12
    v_lshrrev_b32 v9, 1, v11
    v_xor_b32 v9, v9, v11
    v_and_b32 v9, 4, v9
    v_mul_u32_u24 v9, 3, v9
    v_xor_b32 v11, v11, v9
    v_mul_u32_u24 v11, 9216, v11
    v_lshl_add_u32 v2, v12, 4, v11
    v_add_u32 v10, s40, v0
    v_add_u32 v10, 64, v10
    v_mul_u32_u24 v11, 3641, v10
    v_lshrrev_b32 v11, 16, v11
    v_mul_u32_u24 v12, 18, v11
    v_sub_u32 v12, v10, v12
    v_lshrrev_b32 v9, 1, v11
    v_xor_b32 v9, v9, v11
    v_and_b32 v9, 4, v9
    v_mul_u32_u24 v9, 3, v9
    v_xor_b32 v11, v11, v9
    v_mul_u32_u24 v11, 9216, v11
    v_lshl_add_u32 v3, v12, 4, v11
    v_add_u32 v10, s40, v0
    v_add_u32 v10, 128, v10
    v_mul_u32_u24 v11, 3641, v10
    v_lshrrev_b32 v11, 16, v11
    v_mul_u32_u24 v12, 18, v11
    v_sub_u32 v12, v10, v12
    v_lshrrev_b32 v9, 1, v11
    v_xor_b32 v9, v9, v11
    v_and_b32 v9, 4, v9
    v_mul_u32_u24 v9, 3, v9
    v_xor_b32 v11, v11, v9
    v_mul_u32_u24 v11, 9216, v11
    v_lshl_add_u32 v4, v12, 4, v11
    s_mul_i32 s29, s24, 3072
    s_mul_i32 s27, s25, 288
    s_mov_b32 s28, 294912
    s_cmp_ge_u32 s24, 3
    s_cselect_b32 s12, s10, s8
    s_cselect_b32 s13, s11, s9
    s_and_b32 s13, s13, 0xffff
    s_mov_b32 s14, 5308416
    s_mov_b32 s15, 0x20000
    s_branch L_p0_j4
L_g1_roleq:
    s_sub_u32 s3, s24, 6
    s_mul_i32 s40, s3, 192
    s_movk_i32 s41, 320
    v_add_u32 v10, s40, v0
    v_add_u32 v10, 0, v10
    v_mul_u32_u24 v11, 6554, v10
    v_lshrrev_b32 v11, 16, v11
    v_mul_u32_u24 v12, 10, v11
    v_sub_u32 v12, v10, v12
    v_lshrrev_b32 v9, 1, v11
    v_xor_b32 v9, v9, v11
    v_and_b32 v9, 4, v9
    v_mul_u32_u24 v9, 3, v9
    v_xor_b32 v11, v11, v9
    v_lshrrev_b32 v9, 1, v12
    v_mul_u32_u24 v9, 1152, v9
    v_and_b32 v8, 1, v12
    v_lshl_add_u32 v9, v8, 4, v9
    v_sub_u32 v8, 8, v12
    v_mul_u32_u24 v8, 1152, v8
    v_add_u32 v8, 32, v8
    v_cmp_gt_u32 vcc, 6, v12
    v_mul_u32_u24 v11, 3456, v11
    v_cmp_gt_u32 s[42:43], s41, v10
    v_cndmask_b32 v9, v8, v9, vcc
    v_cmp_gt_u32 vcc, 9, v12
    v_add_u32 v9, v9, v11
    s_nop 0
    v_cndmask_b32 v9, v15, v9, vcc
    v_cndmask_b32 v2, v15, v9, s[42:43]
    v_add_u32 v10, s40, v0
    v_add_u32 v10, 64, v10
    v_mul_u32_u24 v11, 6554, v10
    v_lshrrev_b32 v11, 16, v11
    v_mul_u32_u24 v12, 10, v11
    v_sub_u32 v12, v10, v12
    v_lshrrev_b32 v9, 1, v11
    v_xor_b32 v9, v9, v11
    v_and_b32 v9, 4, v9
    v_mul_u32_u24 v9, 3, v9
    v_xor_b32 v11, v11, v9
    v_lshrrev_b32 v9, 1, v12
    v_mul_u32_u24 v9, 1152, v9
    v_and_b32 v8, 1, v12
    v_lshl_add_u32 v9, v8, 4, v9
    v_sub_u32 v8, 8, v12
    v_mul_u32_u24 v8, 1152, v8
    v_add_u32 v8, 32, v8
    v_cmp_gt_u32 vcc, 6, v12
    v_mul_u32_u24 v11, 3456, v11
    v_cmp_gt_u32 s[42:43], s41, v10
    v_cndmask_b32 v9, v8, v9, vcc
    v_cmp_gt_u32 vcc, 9, v12
    v_add_u32 v9, v9, v11
    s_nop 0
    v_cndmask_b32 v9, v15, v9, vcc
    v_cndmask_b32 v3, v15, v9, s[42:43]
    v_add_u32 v10, s40, v0
    v_add_u32 v10, 128, v10
    v_mul_u32_u24 v11, 6554, v10
    v_lshrrev_b32 v11, 16, v11
    v_mul_u32_u24 v12, 10, v11
    v_sub_u32 v12, v10, v12
    v_lshrrev_b32 v9, 1, v11
    v_xor_b32 v9, v9, v11
    v_and_b32 v9, 4, v9
    v_mul_u32_u24 v9, 3, v9
    v_xor_b32 v11, v11, v9
    v_lshrrev_b32 v9, 1, v12
    v_mul_u32_u24 v9, 1152, v9
    v_and_b32 v8, 1, v12
    v_lshl_add_u32 v9, v8, 4, v9
    v_sub_u32 v8, 8, v12
    v_mul_u32_u24 v8, 1152, v8
    v_add_u32 v8, 32, v8
    v_cmp_gt_u32 vcc, 6, v12
    v_mul_u32_u24 v11, 3456, v11
    v_cmp_gt_u32 s[42:43], s41, v10
    v_cndmask_b32 v9, v8, v9, vcc
    v_cmp_gt_u32 vcc, 9, v12
    v_add_u32 v9, v9, v11
    s_nop 0
    v_cndmask_b32 v9, v15, v9, vcc
    v_cndmask_b32 v4, v15, v9, s[42:43]
    s_mul_i32 s29, s24, 3072
    s_add_u32 s29, s29, 16384
    s_mul_i32 s27, s25, 36
    s_mov_b32 s28, 110592
    s_mov_b32 s12, s68
    s_mov_b32 s13, s69
    s_mov_b32 s14, 1990656
    s_mov_b32 s15, 0x20000
L_p0_j4:
    v_lshrrev_b32 v10, 5, v0
    v_bfe_u32 v11, v0, 2, 3
    v_lshl_add_u32 v10, v10, 4, v11
    v_and_b32 v11, 3, v0
    v_mul_u32_u24 v5, 288, v10
    v_lshl_add_u32 v5, v11, 3, v5
    s_lshl_b32 s3, s31, 12
    v_add_u32 v6, s3, v1
    v_mul_u32_u24 v8, 160, v10
    v_add_u32 v8, 34816, v8
    v_lshl_add_u32 v7, v11, 3, v8
    v_min_u32 v11, 2, v11
    v_lshl_add_u32 v8, v11, 4, v8
    v_mov_b32 v9, v5
    v_mov_b32 v10, v6
    v_mov_b32 v11, v7
    v_mov_b32 v12, v8
    s_mov_b32 s46, 40960
    s_mov_b32 s47, 81920
    s_mov_b32 s35, 0
    s_mov_b32 s98, 0
    s_add_u32 s45, s29, 0
    s_add_u32 m0, s45, 0
    s_nop 0
    buffer_load_dwordx4 v2, s[12:15], s27 offen sc1 lds
    s_add_u32 m0, s45, 1024
    s_nop 0
    buffer_load_dwordx4 v3, s[12:15], s27 offen sc1 lds
    s_add_u32 m0, s45, 2048
    s_nop 0
    buffer_load_dwordx4 v4, s[12:15], s27 offen sc1 lds
    s_add_u32 s27, s27, s28
    s_cmp_lt_u32 s24, 4
    s_cbranch_scc1 L_p0_ln
    s_mul_i32 s50, s26, 440
    s_add_u32 s50, s50, 2240
    s_movk_i32 s44, 440
    s_mov_b32 s45, 52429
    v_add_u32 v36, 0, v16
    v_cmp_gt_u32 s[46:47], s44, v36
    v_add_u32 v36, s50, v36
    v_mul_lo_u32 v37, v36, s45
    v_lshrrev_b32 v37, 19, v37
    v_mul_u32_u24 v38, 10, v37
    v_sub_u32 v38, v36, v38
    v_lshrrev_b32 v39, 1, v37
    v_xor_b32 v39, v39, v37
    v_and_b32 v39, 4, v39
    v_mul_u32_u24 v39, 3, v39
    v_xor_b32 v37, v37, v39
    v_mul_u32_u24 v37, 3456, v37
    v_lshrrev_b32 v39, 1, v38
    v_mul_u32_u24 v39, 1152, v39
    v_and_b32 v40, 1, v38
    v_lshl_add_u32 v39, v40, 4, v39
    v_sub_u32 v40, 8, v38
    v_mul_u32_u24 v40, 1152, v40
    v_add_u32 v40, 32, v40
    v_cmp_gt_u32 vcc, 6, v38
    v_cmp_gt_u32 s[48:49], 9, v38
    v_lshlrev_b32 v36, 4, v36
    v_cndmask_b32 v39, v40, v39, vcc
    s_and_b64 s[48:49], s[46:47], s[48:49]
    v_add_u32 v39, v39, v37
    v_cndmask_b32 v206, v15, v39, s[48:49]
    v_cndmask_b32 v208, v15, v36, s[46:47]
    v_add_u32 v36, 256, v16
    v_cmp_gt_u32 s[46:47], s44, v36
    v_add_u32 v36, s50, v36
    v_mul_lo_u32 v37, v36, s45
    v_lshrrev_b32 v37, 19, v37
    v_mul_u32_u24 v38, 10, v37
    v_sub_u32 v38, v36, v38
    v_lshrrev_b32 v39, 1, v37
    v_xor_b32 v39, v39, v37
    v_and_b32 v39, 4, v39
    v_mul_u32_u24 v39, 3, v39
    v_xor_b32 v37, v37, v39
    v_mul_u32_u24 v37, 3456, v37
    v_lshrrev_b32 v39, 1, v38
    v_mul_u32_u24 v39, 1152, v39
    v_and_b32 v40, 1, v38
    v_lshl_add_u32 v39, v40, 4, v39
    v_sub_u32 v40, 8, v38
    v_mul_u32_u24 v40, 1152, v40
    v_add_u32 v40, 32, v40
    v_cmp_gt_u32 vcc, 6, v38
    v_cmp_gt_u32 s[48:49], 9, v38
    v_lshlrev_b32 v36, 4, v36
    v_cndmask_b32 v39, v40, v39, vcc
    s_and_b64 s[48:49], s[46:47], s[48:49]
    v_add_u32 v39, v39, v37
    v_cndmask_b32 v207, v15, v39, s[48:49]
    v_cndmask_b32 v209, v15, v36, s[46:47]
    s_mov_b32 s46, 40960
    v_add_u32 v212, s62, v0
    v_add_u32 v212, 0, v212
    v_mul_u32_u24 v213, 3641, v212
    v_lshrrev_b32 v213, 18, v213
    v_mul_u32_u24 v214, 72, v213
    v_sub_u32 v212, v212, v214
    v_and_b32 v214, 1, v213
    v_cmp_gt_u32 vcc, 32, v213
    v_bfe_u32 v215, v213, 4, 1
    v_mad_u32_u24 v214, v215, s57, v214
    v_bfe_u32 v215, v213, 3, 1
    v_mad_u32_u24 v214, v215, s58, v214
    v_bfe_u32 v215, v213, 2, 1
    v_mad_u32_u24 v214, v215, s59, v214
    v_bfe_u32 v215, v213, 1, 1
    v_mad_u32_u24 v214, v215, s60, v214
    v_mul_lo_u32 v214, v214, s63
    v_lshl_add_u32 v212, v212, 4, v214
    v_cndmask_b32 v200, v15, v212, vcc
    v_add_u32 v212, s62, v0
    v_add_u32 v212, 64, v212
    v_mul_u32_u24 v213, 3641, v212
    v_lshrrev_b32 v213, 18, v213
    v_mul_u32_u24 v214, 72, v213
    v_sub_u32 v212, v212, v214
    v_and_b32 v214, 1, v213
    v_cmp_gt_u32 vcc, 32, v213
    v_bfe_u32 v215, v213, 4, 1
    v_mad_u32_u24 v214, v215, s57, v214
    v_bfe_u32 v215, v213, 3, 1
    v_mad_u32_u24 v214, v215, s58, v214
    v_bfe_u32 v215, v213, 2, 1
    v_mad_u32_u24 v214, v215, s59, v214
    v_bfe_u32 v215, v213, 1, 1
    v_mad_u32_u24 v214, v215, s60, v214
    v_mul_lo_u32 v214, v214, s63
    v_lshl_add_u32 v212, v212, 4, v214
    v_cndmask_b32 v201, v15, v212, vcc
    v_add_u32 v212, s62, v0
    v_add_u32 v212, 128, v212
    v_mul_u32_u24 v213, 3641, v212
    v_lshrrev_b32 v213, 18, v213
    v_mul_u32_u24 v214, 72, v213
    v_sub_u32 v212, v212, v214
    v_and_b32 v214, 1, v213
    v_cmp_gt_u32 vcc, 32, v213
    v_bfe_u32 v215, v213, 4, 1
    v_mad_u32_u24 v214, v215, s57, v214
    v_bfe_u32 v215, v213, 3, 1
    v_mad_u32_u24 v214, v215, s58, v214
    v_bfe_u32 v215, v213, 2, 1
    v_mad_u32_u24 v214, v215, s59, v214
    v_bfe_u32 v215, v213, 1, 1
    v_mad_u32_u24 v214, v215, s60, v214
    v_mul_lo_u32 v214, v214, s63
    v_lshl_add_u32 v212, v212, 4, v214
    v_cndmask_b32 v202, v15, v212, vcc
    v_add_u32 v212, s62, v0
    v_add_u32 v212, 192, v212
    v_mul_u32_u24 v213, 3641, v212
    v_lshrrev_b32 v213, 18, v213
    v_mul_u32_u24 v214, 72, v213
    v_sub_u32 v212, v212, v214
    v_and_b32 v214, 1, v213
    v_cmp_gt_u32 vcc, 32, v213
    v_bfe_u32 v215, v213, 4, 1
    v_mad_u32_u24 v214, v215, s57, v214
    v_bfe_u32 v215, v213, 3, 1
    v_mad_u32_u24 v214, v215, s58, v214
    v_bfe_u32 v215, v213, 2, 1
    v_mad_u32_u24 v214, v215, s59, v214
    v_bfe_u32 v215, v213, 1, 1
    v_mad_u32_u24 v214, v215, s60, v214
    v_mul_lo_u32 v214, v214, s63
    v_lshl_add_u32 v212, v212, 4, v214
    v_cndmask_b32 v203, v15, v212, vcc
    v_add_u32 v212, s62, v0
    v_add_u32 v212, 256, v212
    v_mul_u32_u24 v213, 3641, v212
    v_lshrrev_b32 v213, 18, v213
    v_mul_u32_u24 v214, 72, v213
    v_sub_u32 v212, v212, v214
    v_and_b32 v214, 1, v213
    v_cmp_gt_u32 vcc, 32, v213
    v_bfe_u32 v215, v213, 4, 1
    v_mad_u32_u24 v214, v215, s57, v214
    v_bfe_u32 v215, v213, 3, 1
    v_mad_u32_u24 v214, v215, s58, v214
    v_bfe_u32 v215, v213, 2, 1
    v_mad_u32_u24 v214, v215, s59, v214
    v_bfe_u32 v215, v213, 1, 1
    v_mad_u32_u24 v214, v215, s60, v214
    v_mul_lo_u32 v214, v214, s63
    v_lshl_add_u32 v212, v212, 4, v214
    v_cndmask_b32 v204, v15, v212, vcc
    s_cmp_lg_u32 s24, 7
    s_cbranch_scc1 L_p0_j2
    buffer_load_dword v41, v13, s[36:39], 0 offen sc0 sc1
    s_branch L_p0_j2
L_p0_ln:
    v_mov_b32 v200, v15
    v_mov_b32 v201, v15
    v_mov_b32 v202, v15
    v_mov_b32 v203, v15
    v_mov_b32 v204, v15
    v_mov_b32 v205, v15
    v_mov_b32 v206, v15
    v_mov_b32 v207, v15
    v_mov_b32 v208, v15
    v_mov_b32 v209, v15
    s_waitcnt vmcnt(3)
L_p0_ln2:
    s_mov_b32 s40, 0xffff0000
    v_lshlrev_b32 v32, 16, v20
    v_and_b32 v33, s40, v20
    v_lshlrev_b32 v34, 16, v21
    v_and_b32 v35, s40, v21
    v_lshlrev_b32 v36, 16, v22
    v_and_b32 v37, s40, v22
    v_lshlrev_b32 v38, 16, v23
    v_and_b32 v39, s40, v23
    v_lshlrev_b32 v40, 16, v24
    v_and_b32 v41, s40, v24
    v_lshlrev_b32 v42, 16, v25
    v_and_b32 v43, s40, v25
    v_lshlrev_b32 v44, 16, v26
    v_and_b32 v45, s40, v26
    v_lshlrev_b32 v46, 16, v27
    v_and_b32 v47, s40, v27
    v_lshlrev_b32 v48, 16, v28
    v_and_b32 v49, s40, v28
    v_lshlrev_b32 v50, 16, v29
    v_and_b32 v51, s40, v29
    v_lshlrev_b32 v52, 16, v30
    v_and_b32 v53, s40, v30
    v_lshlrev_b32 v54, 16, v31
    v_and_b32 v55, s40, v31
    v_pk_add_f32 v[56:57], v[32:33], v[34:35]
    v_pk_add_f32 v[58:59], v[36:37], v[38:39]
    v_pk_add_f32 v[56:57], v[56:57], v[40:41]
    v_pk_add_f32 v[58:59], v[58:59], v[42:43]
    v_pk_add_f32 v[56:57], v[56:57], v[44:45]
    v_pk_add_f32 v[58:59], v[58:59], v[46:47]
    v_pk_add_f32 v[56:57], v[56:57], v[48:49]
    v_pk_add_f32 v[58:59], v[58:59], v[50:51]
    v_pk_add_f32 v[56:57], v[56:57], v[52:53]
    v_pk_add_f32 v[58:59], v[58:59], v[54:55]
    v_pk_add_f32 v[56:57], v[56:57], v[58:59]
    v_add_f32 v56, v56, v57
    s_nop 1
    v_add_f32_dpp v56, v56, v56 row_ror:8 row_mask:0xf bank_mask:0xf
    s_nop 1
    v_add_f32_dpp v56, v56, v56 row_ror:4 row_mask:0xf bank_mask:0xf
    s_nop 1
    v_add_f32_dpp v56, v56, v56 row_ror:2 row_mask:0xf bank_mask:0xf
    s_nop 1
    v_add_f32_dpp v56, v56, v56 row_ror:1 row_mask:0xf bank_mask:0xf
    v_mov_b32 v57, v56
    s_nop 1
    v_permlane16_swap_b32 v56, v57
    s_nop 1
    v_add_f32 v56, v56, v57
    v_mul_f32 v56, 0xbae38e39, v56
    v_mov_b32 v57, v56
    v_pk_add_f32 v[64:65], v[32:33], v[56:57]
    v_pk_add_f32 v[66:67], v[34:35], v[56:57]
    v_pk_mul_f32 v[60:61], v[64:65], v[64:65]
    v_pk_mul_f32 v[62:63], v[66:67], v[66:67]
    v_pk_add_f32 v[64:65], v[36:37], v[56:57]
    v_pk_add_f32 v[66:67], v[38:39], v[56:57]
    v_pk_fma_f32 v[60:61], v[64:65], v[64:65], v[60:61]
    v_pk_fma_f32 v[62:63], v[66:67], v[66:67], v[62:63]
    v_pk_add_f32 v[64:65], v[40:41], v[56:57]
    v_pk_add_f32 v[66:67], v[42:43], v[56:57]
    v_pk_fma_f32 v[60:61], v[64:65], v[64:65], v[60:61]
    v_pk_fma_f32 v[62:63], v[66:67], v[66:67], v[62:63]
    v_pk_add_f32 v[64:65], v[44:45], v[56:57]
    v_pk_add_f32 v[66:67], v[46:47], v[56:57]
    v_pk_fma_f32 v[60:61], v[64:65], v[64:65], v[60:61]
    v_pk_fma_f32 v[62:63], v[66:67], v[66:67], v[62:63]
    v_pk_add_f32 v[64:65], v[48:49], v[56:57]
    v_pk_add_f32 v[66:67], v[50:51], v[56:57]
    v_pk_fma_f32 v[60:61], v[64:65], v[64:65], v[60:61]
    v_pk_fma_f32 v[62:63], v[66:67], v[66:67], v[62:63]
    v_pk_add_f32 v[64:65], v[52:53], v[56:57]
    v_pk_add_f32 v[66:67], v[54:55], v[56:57]
    v_pk_fma_f32 v[60:61], v[64:65], v[64:65], v[60:61]
    v_pk_fma_f32 v[62:63], v[66:67], v[66:67], v[62:63]
    v_pk_add_f32 v[60:61], v[60:61], v[62:63]
    v_add_f32 v60, v60, v61
    v_cndmask_b32 v60, 0, v60, s[48:49]
    s_nop 1
    v_add_f32_dpp v60, v60, v60 row_ror:8 row_mask:0xf bank_mask:0xf
    s_nop 1
    v_add_f32_dpp v60, v60, v60 row_ror:4 row_mask:0xf bank_mask:0xf
    s_nop 1
    v_add_f32_dpp v60, v60, v60 row_ror:2 row_mask:0xf bank_mask:0xf
    s_nop 1
    v_add_f32_dpp v60, v60, v60 row_ror:1 row_mask:0xf bank_mask:0xf
    v_mov_b32 v61, v60
    s_nop 1
    v_permlane16_swap_b32 v60, v61
    s_nop 1
    v_add_f32 v60, v60, v61
    v_mul_f32 v60, 0x3ae38e39, v60
    v_cvt_pk_bf16_f32 v56, v56, v56
    v_cvt_pk_bf16_f32 v60, v60, v60
    v_and_b32 v56, s40, v56
    v_and_b32 v60, s40, v60
    v_mov_b32 v57, v56
    v_add_f32 v60, 0x3727c5ac, v60
    v_cvt_pk_bf16_f32 v60, v60, v60
    v_and_b32 v60, s40, v60
    v_sqrt_f32 v60, v60
    v_lshlrev_b32 v19, 7, v17
    v_cvt_pk_bf16_f32 v60, v60, v60
    v_and_b32 v60, s40, v60
    v_rcp_f32 v60, v60
    v_lshl_add_u32 v19, v18, 4, v19
    v_add_u32 v19, 122880, v19
    v_mov_b32 v61, v60
    v_pk_add_f32 v[32:33], v[32:33], v[56:57]
    v_pk_add_f32 v[34:35], v[34:35], v[56:57]
    v_pk_add_f32 v[36:37], v[36:37], v[56:57]
    v_pk_add_f32 v[38:39], v[38:39], v[56:57]
    v_pk_add_f32 v[40:41], v[40:41], v[56:57]
    v_pk_add_f32 v[42:43], v[42:43], v[56:57]
    v_pk_add_f32 v[44:45], v[44:45], v[56:57]
    v_pk_add_f32 v[46:47], v[46:47], v[56:57]
    v_pk_add_f32 v[48:49], v[48:49], v[56:57]
    v_pk_add_f32 v[50:51], v[50:51], v[56:57]
    v_pk_add_f32 v[52:53], v[52:53], v[56:57]
    v_pk_add_f32 v[54:55], v[54:55], v[56:57]
    v_cvt_pk_bf16_f32 v20, v32, v33
    v_cvt_pk_bf16_f32 v21, v34, v35
    v_cvt_pk_bf16_f32 v22, v36, v37
    v_cvt_pk_bf16_f32 v23, v38, v39
    v_cvt_pk_bf16_f32 v24, v40, v41
    v_cvt_pk_bf16_f32 v25, v42, v43
    v_cvt_pk_bf16_f32 v26, v44, v45
    v_cvt_pk_bf16_f32 v27, v46, v47
    v_cvt_pk_bf16_f32 v28, v48, v49
    v_cvt_pk_bf16_f32 v29, v50, v51
    v_cvt_pk_bf16_f32 v30, v52, v53
    v_cvt_pk_bf16_f32 v31, v54, v55
    v_lshlrev_b32 v32, 16, v20
    v_and_b32 v33, s40, v20
    v_lshlrev_b32 v34, 16, v21
    v_and_b32 v35, s40, v21
    v_lshlrev_b32 v36, 16, v22
    v_and_b32 v37, s40, v22
    v_lshlrev_b32 v38, 16, v23
    v_and_b32 v39, s40, v23
    v_lshlrev_b32 v40, 16, v24
    v_and_b32 v41, s40, v24
    v_lshlrev_b32 v42, 16, v25
    v_and_b32 v43, s40, v25
    v_lshlrev_b32 v44, 16, v26
    v_and_b32 v45, s40, v26
    v_lshlrev_b32 v46, 16, v27
    v_and_b32 v47, s40, v27
    v_lshlrev_b32 v48, 16, v28
    v_and_b32 v49, s40, v28
    v_lshlrev_b32 v50, 16, v29
    v_and_b32 v51, s40, v29
    v_lshlrev_b32 v52, 16, v30
    v_and_b32 v53, s40, v30
    v_lshlrev_b32 v54, 16, v31
    v_and_b32 v55, s40, v31
    v_pk_mul_f32 v[32:33], v[32:33], v[60:61]
    v_pk_mul_f32 v[34:35], v[34:35], v[60:61]
    v_pk_mul_f32 v[36:37], v[36:37], v[60:61]
    v_pk_mul_f32 v[38:39], v[38:39], v[60:61]
    v_pk_mul_f32 v[40:41], v[40:41], v[60:61]
    v_pk_mul_f32 v[42:43], v[42:43], v[60:61]
    v_pk_mul_f32 v[44:45], v[44:45], v[60:61]
    v_pk_mul_f32 v[46:47], v[46:47], v[60:61]
    v_pk_mul_f32 v[48:49], v[48:49], v[60:61]
    v_pk_mul_f32 v[50:51], v[50:51], v[60:61]
    v_pk_mul_f32 v[52:53], v[52:53], v[60:61]
    v_pk_mul_f32 v[54:55], v[54:55], v[60:61]
    v_cvt_pk_bf16_f32 v20, v32, v33
    v_cvt_pk_bf16_f32 v21, v34, v35
    v_cvt_pk_bf16_f32 v22, v36, v37
    v_cvt_pk_bf16_f32 v23, v38, v39
    v_cvt_pk_bf16_f32 v24, v40, v41
    v_cvt_pk_bf16_f32 v25, v42, v43
    v_cvt_pk_bf16_f32 v26, v44, v45
    v_cvt_pk_bf16_f32 v27, v46, v47
    v_cvt_pk_bf16_f32 v28, v48, v49
    v_cvt_pk_bf16_f32 v29, v50, v51
    v_cvt_pk_bf16_f32 v30, v52, v53
    v_cvt_pk_bf16_f32 v31, v54, v55
    s_cbranch_execz L_p0_lnr
    s_mov_b64 exec, s[48:49]
    ds_write_b128 v19, v[20:23] offset:0
    ds_write_b128 v19, v[24:27] offset:3072
    ds_write_b128 v19, v[28:31] offset:6144
    s_mov_b64 exec, -1
L_p0_j2:
    v_mov_b32 v42, 132096
    s_waitcnt lgkmcnt(0)
    s_barrier
    s_cmp_ge_u32 s24, 4
    s_cbranch_scc1 L_p0_b2
    s_lshl_b32 s41, s24, 10
    s_add_u32 s3, s41, 122880
    v_add_u32 v36, s3, v1
    ds_read_b128 v[40:43], v36 offset:0
    ds_read_b128 v[44:47], v36 offset:4096
    ds_read_b128 v[48:51], v36 offset:8192
    v_lshrrev_b32 v37, 3, v0
    v_and_b32 v38, 7, v0
    v_lshlrev_b32 v38, 4, v38
    v_lshl_add_u32 v37, v37, 8, v38
    s_lshl_b32 s42, s26, 4
    s_lshr_b32 s3, s25, 1
    s_add_u32 s42, s42, s3
    s_mul_i32 s42, s42, 18432
    s_and_b32 s3, s25, 1
    s_lshl_b32 s3, s3, 7
    s_add_u32 s42, s42, s3
    s_lshl_b32 s3, s41, 1
    s_add_u32 s42, s42, s3
    s_add_u32 s42, s42, 0
    s_add_u32 s43, s42, 8192
    s_add_u32 s44, s42, 16384
    s_cmp_lg_u32 s24, 0
    s_cselect_b32 s44, 0x7fff0000, s44
    s_waitcnt lgkmcnt(0)
    buffer_store_dwordx4 v[40:43], v37, s[20:23], s42 offen sc1
    buffer_store_dwordx4 v[44:47], v37, s[20:23], s43 offen sc1
    buffer_store_dwordx4 v[48:51], v37, s[20:23], s44 offen sc1
    s_lshl_b32 s65, s26, 3
    s_lshr_b32 s3, s25, 2
    s_add_u32 s65, s65, s3
    s_lshl_b32 s65, s65, 7
    s_and_b32 s3, s25, 3
    s_lshl_b32 s3, s3, 2
    s_add_u32 s3, s3, s24
    s_lshl_b32 s3, s3, 2
    s_add_u32 s65, s65, s3
    s_add_u32 s65, s65, 49319936
    v_add_u32 v73, s62, v0
    v_add_u32 v73, 0, v73
    v_mul_u32_u24 v74, 3641, v73
    v_lshrrev_b32 v74, 18, v74
    v_mul_u32_u24 v75, 72, v74
    v_sub_u32 v73, v73, v75
    v_and_b32 v75, 1, v74
    v_cmp_gt_u32 vcc, 32, v74
    v_bfe_u32 v76, v74, 4, 1
    v_mad_u32_u24 v75, v76, s57, v75
    v_bfe_u32 v76, v74, 3, 1
    v_mad_u32_u24 v75, v76, s58, v75
    v_bfe_u32 v76, v74, 2, 1
    v_mad_u32_u24 v75, v76, s59, v75
    v_bfe_u32 v76, v74, 1, 1
    v_mad_u32_u24 v75, v76, s60, v75
    v_mul_lo_u32 v75, v75, s63
    v_lshl_add_u32 v73, v73, 4, v75
    v_cndmask_b32 v68, v15, v73, vcc
    v_add_u32 v73, s62, v0
    v_add_u32 v73, 64, v73
    v_mul_u32_u24 v74, 3641, v73
    v_lshrrev_b32 v74, 18, v74
    v_mul_u32_u24 v75, 72, v74
    v_sub_u32 v73, v73, v75
    v_and_b32 v75, 1, v74
    v_cmp_gt_u32 vcc, 32, v74
    v_bfe_u32 v76, v74, 4, 1
    v_mad_u32_u24 v75, v76, s57, v75
    v_bfe_u32 v76, v74, 3, 1
    v_mad_u32_u24 v75, v76, s58, v75
    v_bfe_u32 v76, v74, 2, 1
    v_mad_u32_u24 v75, v76, s59, v75
    v_bfe_u32 v76, v74, 1, 1
    v_mad_u32_u24 v75, v76, s60, v75
    v_mul_lo_u32 v75, v75, s63
    v_lshl_add_u32 v73, v73, 4, v75
    v_cndmask_b32 v69, v15, v73, vcc
    v_add_u32 v73, s62, v0
    v_add_u32 v73, 128, v73
    v_mul_u32_u24 v74, 3641, v73
    v_lshrrev_b32 v74, 18, v74
    v_mul_u32_u24 v75, 72, v74
    v_sub_u32 v73, v73, v75
    v_and_b32 v75, 1, v74
    v_cmp_gt_u32 vcc, 32, v74
    v_bfe_u32 v76, v74, 4, 1
    v_mad_u32_u24 v75, v76, s57, v75
    v_bfe_u32 v76, v74, 3, 1
    v_mad_u32_u24 v75, v76, s58, v75
    v_bfe_u32 v76, v74, 2, 1
    v_mad_u32_u24 v75, v76, s59, v75
    v_bfe_u32 v76, v74, 1, 1
    v_mad_u32_u24 v75, v76, s60, v75
    v_mul_lo_u32 v75, v75, s63
    v_lshl_add_u32 v73, v73, 4, v75
    v_cndmask_b32 v70, v15, v73, vcc
    v_add_u32 v73, s62, v0
    v_add_u32 v73, 192, v73
    v_mul_u32_u24 v74, 3641, v73
    v_lshrrev_b32 v74, 18, v74
    v_mul_u32_u24 v75, 72, v74
    v_sub_u32 v73, v73, v75
    v_and_b32 v75, 1, v74
    v_cmp_gt_u32 vcc, 32, v74
    v_bfe_u32 v76, v74, 4, 1
    v_mad_u32_u24 v75, v76, s57, v75
    v_bfe_u32 v76, v74, 3, 1
    v_mad_u32_u24 v75, v76, s58, v75
    v_bfe_u32 v76, v74, 2, 1
    v_mad_u32_u24 v75, v76, s59, v75
    v_bfe_u32 v76, v74, 1, 1
    v_mad_u32_u24 v75, v76, s60, v75
    v_mul_lo_u32 v75, v75, s63
    v_lshl_add_u32 v73, v73, 4, v75
    v_cndmask_b32 v71, v15, v73, vcc
    v_add_u32 v73, s62, v0
    v_add_u32 v73, 256, v73
    v_mul_u32_u24 v74, 3641, v73
    v_lshrrev_b32 v74, 18, v74
    v_mul_u32_u24 v75, 72, v74
    v_sub_u32 v73, v73, v75
    v_and_b32 v75, 1, v74
    v_cmp_gt_u32 vcc, 32, v74
    v_bfe_u32 v76, v74, 4, 1
    v_mad_u32_u24 v75, v76, s57, v75
    v_bfe_u32 v76, v74, 3, 1
    v_mad_u32_u24 v75, v76, s58, v75
    v_bfe_u32 v76, v74, 2, 1
    v_mad_u32_u24 v75, v76, s59, v75
    v_bfe_u32 v76, v74, 1, 1
    v_mad_u32_u24 v75, v76, s60, v75
    v_mul_lo_u32 v75, v75, s63
    v_lshl_add_u32 v73, v73, 4, v75
    v_cndmask_b32 v72, v15, v73, vcc
    v_mov_b32 v88, v15
    v_mov_b32 v89, v15
    v_mov_b32 v90, v15
    v_mov_b32 v91, v15
    s_branch L_p0_j3
L_p0_b2:
    s_cmp_lg_u32 s24, 7
    s_cbranch_scc1 L_p0_nn
    s_mov_b32 s100, 100000
L_p0_np:
    s_waitcnt vmcnt(0)
    v_readfirstlane_b32 s3, v41
    s_cmp_lg_u32 s3, 0
    s_cbranch_scc1 L_p0_npok
    s_sub_u32 s100, s100, 1
    s_cbranch_scc1 L_p0_npto
    s_sleep 2
    buffer_load_dword v41, v13, s[36:39], 0 offen sc0 sc1
    s_branch L_p0_np
L_p0_npto:
    s_mov_b32 s3, 1
L_p0_npok:
    v_mov_b32 v41, s3
    ds_write_b32 v42, v41
L_p0_nn:
    s_mov_b32 s32, 0
    s_mov_b64 s[94:95], s[32:33]
    s_mov_b32 s92, s34
    s_mov_b64 exec, 0
    s_cmp_eq_u32 s24, 4
    s_cbranch_scc1 L_dry_0
    s_cmp_eq_u32 s24, 5
    s_cbranch_scc1 L_dry_1
    s_cmp_eq_u32 s24, 6
    s_cbranch_scc1 L_dry_2
    s_branch L_dry_3
L_dry_done:
    s_mov_b64 exec, -1
    s_mov_b32 s35, 0
    s_mov_b64 s[32:33], s[94:95]
    s_mov_b32 s34, s92
    s_nop 15
    v_mov_b32 v68, v200
    v_mov_b32 v69, v201
    v_mov_b32 v70, v202
    v_mov_b32 v71, v203
    v_mov_b32 v72, v204
    v_mov_b32 v88, v206
    v_mov_b32 v89, v207
    v_mov_b32 v90, v208
    v_mov_b32 v91, v209
    s_mov_b32 s65, 0x7fff0000
L_p0_j3:
    s_mul_i32 s64, s24, 5120
    s_add_u32 s64, s64, 81920
    s_mov_b32 s36, s68
    s_mov_b32 s37, s69
    s_mov_b32 s38, 1990656
    s_mov_b32 s39, 0x20000
    s_mul_i32 s51, s25, 36
    s_mul_i32 s41, s25, 92160
    s_add_u32 s41, s41, 46342144
    s_lshl_b32 s50, s25, 7
    s_lshl_b32 s3, s26, 4
    s_add_u32 s50, s50, s3
    s_lshl_b32 s3, s31, 2
    s_add_u32 s50, s50, s3
    s_add_u32 s50, s50, 49328128
    s_lshl_b32 s42, s26, 3
    s_add_u32 s42, s42, s24
    s_lshl_b32 s42, s42, 7
    s_add_u32 s42, s42, 49319936
    s_and_b32 s3, s2, 0
    s_mul_i32 s3, s3, 41216
    s_add_u32 s42, s42, s3
    v_mul_u32_u24 v38, 41216, v0
    v_cmp_gt_u32 vcc, 1, v0
    s_nop 1
    v_cndmask_b32 v38, v15, v38, vcc
    s_lshl_b32 s43, s25, 7
    s_add_u32 s43, s43, 49328128
    v_lshlrev_b32 v36, 2, v0
    v_cmp_gt_u32 vcc, 16, v0
    v_cmp_gt_u32 s[48:49], 32, v0
    s_nop 0
    v_cndmask_b32 v37, v15, v36, vcc
    v_cndmask_b32 v77, v15, v36, s[48:49]
    v_mov_b32 v39, 132096
    s_mov_b32 s100, 6400000
L_p0_nw:
    ds_read_b32 v14, v39
    s_waitcnt lgkmcnt(0)
    v_readfirstlane_b32 s99, v14
    s_cmp_lg_u32 s99, 0
    s_cbranch_scc1 L_p0_nwok
    s_sub_u32 s100, s100, 1
    s_cbranch_scc0 L_p0_nw
L_p0_nwok:
    s_waitcnt vmcnt(0)
    buffer_store_dword v14, v38, s[20:23], s65 offen sc0 sc1
    s_add_u32 s45, s29, 40960
    s_add_u32 m0, s45, 0
    s_nop 0
    buffer_load_dwordx4 v2, s[12:15], s27 offen sc1 lds
    s_add_u32 m0, s45, 1024
    s_nop 0
    buffer_load_dwordx4 v3, s[12:15], s27 offen sc1 lds
    s_add_u32 m0, s45, 2048
    s_nop 0
    buffer_load_dwordx4 v4, s[12:15], s27 offen sc1 lds
    s_add_u32 s27, s27, s28
    buffer_load_dwordx4 v[80:83], v88, s[36:39], s51 offen
    buffer_load_dwordx4 v[84:87], v89, s[36:39], s51 offen
    s_mov_b32 s100, 100000
L_parall_poll_1:
    s_sleep 8
    buffer_load_dword v39, v37, s[20:23], s42 offen sc0 sc1
    s_waitcnt vmcnt(0)
    v_cmp_eq_u32 vcc, s99, v39
    s_nop 3
    s_bcnt1_i32_b64 s101, vcc
    s_cmp_eq_u32 s101, 16
    s_cbranch_scc1 L_parall_poll_1_ok
    s_sub_u32 s100, s100, 1
    s_cbranch_scc1 L_parall_poll_1_ok
    s_branch L_parall_poll_1
L_parall_poll_1_ok:
    s_add_u32 s44, s30, 0
    s_add_u32 s45, s29, 0
    s_add_u32 m0, s44, 0
    s_nop 0
    buffer_load_dwordx4 v1, s[20:23], s33 offen sc1 lds
    s_add_u32 s33, s33, 1024
    s_add_u32 m0, s44, 1024
    s_nop 0
    buffer_load_dwordx4 v1, s[20:23], s34 offen sc1 lds
    s_add_u32 s34, s34, 1024
    s_add_u32 s44, s30, 40960
    s_add_u32 s45, s29, 40960
    s_add_u32 m0, s44, 0
    s_nop 0
    buffer_load_dwordx4 v1, s[20:23], s33 offen sc1 lds
    s_add_u32 s33, s33, 1024
    s_add_u32 m0, s44, 1024
    s_nop 0
    buffer_load_dwordx4 v1, s[20:23], s34 offen sc1 lds
    s_add_u32 s34, s34, 1024
    s_add_u32 s44, s30, 81920
    s_add_u32 s45, s29, 81920
    s_add_u32 m0, s44, 0
    s_nop 0
    buffer_load_dwordx4 v1, s[20:23], s33 offen sc1 lds
    s_add_u32 s33, s33, 1024
    s_add_u32 m0, s44, 1024
    s_nop 0
    buffer_load_dwordx4 v1, s[20:23], s34 offen sc1 lds
    s_add_u32 s34, s34, 1024
    s_add_u32 m0, s45, 0
    s_nop 0
    buffer_load_dwordx4 v2, s[12:15], s27 offen sc1 lds
    s_add_u32 m0, s45, 1024
    s_nop 0
    buffer_load_dwordx4 v3, s[12:15], s27 offen sc1 lds
    s_add_u32 m0, s45, 2048
    s_nop 0
    buffer_load_dwordx4 v4, s[12:15], s27 offen sc1 lds
    s_add_u32 s27, s27, s28
    s_waitcnt vmcnt(7)
    s_barrier
    s_cmp_ge_u32 s24, 4
    s_cbranch_scc1 L_g1_grpB
    v_mov_b32 v7, v68
    v_mov_b32 v8, v69
    v_mov_b32 v11, v70
    v_mov_b32 v12, v71
    v_mov_b32 v15, v72
    ds_read_b128 v[16:19], v10 offset:18432
    ds_read_b128 v[20:23], v10 offset:19456
    ds_read_b128 v[24:27], v10 offset:20480
    ds_read_b128 v[28:31], v10 offset:21504
    ds_read_b64_tr_b16 v[48:49], v9 offset:0
    ds_read_b64_tr_b16 v[50:51], v9 offset:2304
    ds_read_b64_tr_b16 v[52:53], v9 offset:9216
    ds_read_b64_tr_b16 v[54:55], v9 offset:11520
    ds_read_b64_tr_b16 v[56:57], v9 offset:32
    ds_read_b64_tr_b16 v[58:59], v9 offset:2336
    s_waitcnt lgkmcnt(4)
    v_mfma_f32_16x16x32_bf16 v[64:67], v[48:51], v[16:19], 0
    ds_read_b64_tr_b16 v[60:61], v9 offset:9248
    v_mfma_f32_16x16x32_bf16 v[68:71], v[48:51], v[20:23], 0
    ds_read_b64_tr_b16 v[62:63], v9 offset:11552
    v_mfma_f32_16x16x32_bf16 v[72:75], v[48:51], v[24:27], 0
    s_add_u32 s44, s30, 122880
    s_add_u32 s45, s29, 122880
    v_mfma_f32_16x16x32_bf16 v[76:79], v[48:51], v[28:31], 0
    s_waitcnt lgkmcnt(4)
    v_mfma_f32_16x16x32_bf16 v[92:95], v[52:55], v[28:31], 0
    ds_read_b64_tr_b16 v[48:49], v9 offset:64
    s_add_u32 m0, s45, 0
    v_mfma_f32_16x16x32_bf16 v[88:91], v[52:55], v[24:27], 0
    ds_read_b64_tr_b16 v[50:51], v9 offset:2368
    v_mfma_f32_16x16x32_bf16 v[84:87], v[52:55], v[20:23], 0
    buffer_load_dwordx4 v2, s[12:15], s27 offen sc1 lds
    v_mfma_f32_16x16x32_bf16 v[80:83], v[52:55], v[16:19], 0
    s_waitcnt lgkmcnt(4)
    v_mfma_f32_16x16x32_bf16 v[96:99], v[56:59], v[16:19], 0
    ds_read_b64_tr_b16 v[52:53], v9 offset:9280
    s_add_u32 m0, s45, 1024
    v_mfma_f32_16x16x32_bf16 v[100:103], v[56:59], v[20:23], 0
    ds_read_b64_tr_b16 v[54:55], v9 offset:11584
    v_mfma_f32_16x16x32_bf16 v[104:107], v[56:59], v[24:27], 0
    buffer_load_dwordx4 v3, s[12:15], s27 offen sc1 lds
    v_mfma_f32_16x16x32_bf16 v[108:111], v[56:59], v[28:31], 0
    s_waitcnt lgkmcnt(4)
    v_mfma_f32_16x16x32_bf16 v[124:127], v[60:63], v[28:31], 0
    ds_read_b64_tr_b16 v[56:57], v9 offset:96
    s_add_u32 m0, s45, 2048
    v_mfma_f32_16x16x32_bf16 v[120:123], v[60:63], v[24:27], 0
    ds_read_b64_tr_b16 v[58:59], v9 offset:2400
    v_mfma_f32_16x16x32_bf16 v[116:119], v[60:63], v[20:23], 0
    buffer_load_dwordx4 v4, s[12:15], s27 offen sc1 lds
    s_add_u32 s27, s27, s28
    v_mfma_f32_16x16x32_bf16 v[112:115], v[60:63], v[16:19], 0
    s_waitcnt lgkmcnt(4)
    v_mfma_f32_16x16x32_bf16 v[128:131], v[48:51], v[16:19], 0
    ds_read_b64_tr_b16 v[60:61], v9 offset:9312
    s_add_u32 m0, s44, 0
    v_mfma_f32_16x16x32_bf16 v[132:135], v[48:51], v[20:23], 0
    ds_read_b64_tr_b16 v[62:63], v9 offset:11616
    v_mfma_f32_16x16x32_bf16 v[136:139], v[48:51], v[24:27], 0
    buffer_load_dwordx4 v1, s[20:23], s33 offen sc1 lds
    s_add_u32 s33, s33, 1024
    v_mfma_f32_16x16x32_bf16 v[140:143], v[48:51], v[28:31], 0
    s_waitcnt lgkmcnt(4)
    v_mfma_f32_16x16x32_bf16 v[156:159], v[52:55], v[28:31], 0
    ds_read_b64_tr_b16 v[48:49], v9 offset:128
    s_add_u32 m0, s44, 1024
    v_mfma_f32_16x16x32_bf16 v[152:155], v[52:55], v[24:27], 0
    ds_read_b64_tr_b16 v[50:51], v9 offset:2432
    v_mfma_f32_16x16x32_bf16 v[148:151], v[52:55], v[20:23], 0
    buffer_load_dwordx4 v1, s[20:23], s34 offen sc1 lds
    s_add_u32 s34, s34, 1024
    v_mfma_f32_16x16x32_bf16 v[144:147], v[52:55], v[16:19], 0
    s_waitcnt lgkmcnt(4)
    v_mfma_f32_16x16x32_bf16 v[160:163], v[56:59], v[16:19], 0
    ds_read_b64_tr_b16 v[52:53], v9 offset:9344
    v_mfma_f32_16x16x32_bf16 v[164:167], v[56:59], v[20:23], 0
    ds_read_b64_tr_b16 v[54:55], v9 offset:11648
    v_mfma_f32_16x16x32_bf16 v[168:171], v[56:59], v[24:27], 0
    v_mfma_f32_16x16x32_bf16 v[172:175], v[56:59], v[28:31], 0
    s_waitcnt lgkmcnt(4)
    v_mfma_f32_16x16x32_bf16 v[188:191], v[60:63], v[28:31], 0
    ds_read_b64_tr_b16 v[56:57], v9 offset:160
    v_mfma_f32_16x16x32_bf16 v[184:187], v[60:63], v[24:27], 0
    ds_read_b64_tr_b16 v[58:59], v9 offset:2464
    v_mfma_f32_16x16x32_bf16 v[180:183], v[60:63], v[20:23], 0
    v_mfma_f32_16x16x32_bf16 v[176:179], v[60:63], v[16:19], 0
    s_waitcnt lgkmcnt(4)
    v_mfma_f32_16x16x32_bf16 v[192:195], v[48:51], v[16:19], 0
    ds_read_b64_tr_b16 v[60:61], v9 offset:9376
    v_mfma_f32_16x16x32_bf16 v[196:199], v[48:51], v[20:23], 0
    ds_read_b64_tr_b16 v[62:63], v9 offset:11680
    v_mfma_f32_16x16x32_bf16 v[200:203], v[48:51], v[24:27], 0
    v_add_u32 v9, s46, v5
    v_add_u32 v10, s46, v6
    v_mfma_f32_16x16x32_bf16 v[204:207], v[48:51], v[28:31], 0
    s_waitcnt vmcnt(10) lgkmcnt(4)
    s_barrier
    v_mfma_f32_16x16x32_bf16 v[220:223], v[52:55], v[28:31], 0
    ds_read_b64_tr_b16 v[48:49], v9 offset:0
    v_mfma_f32_16x16x32_bf16 v[216:219], v[52:55], v[24:27], 0
    ds_read_b64_tr_b16 v[50:51], v9 offset:2304
    v_mfma_f32_16x16x32_bf16 v[212:215], v[52:55], v[20:23], 0
    ds_read_b128 v[32:35], v10 offset:18432
    v_mfma_f32_16x16x32_bf16 v[208:211], v[52:55], v[16:19], 0
    ds_read_b128 v[36:39], v10 offset:19456
    s_waitcnt lgkmcnt(6)
    v_mfma_f32_16x16x32_bf16 v[224:227], v[56:59], v[16:19], 0
    ds_read_b64_tr_b16 v[52:53], v9 offset:9216
    s_add_u32 s46, s46, 40960
    s_cmp_eq_u32 s46, 163840
    s_cselect_b32 s46, 0, s46
    v_mfma_f32_16x16x32_bf16 v[228:231], v[56:59], v[20:23], 0
    ds_read_b64_tr_b16 v[54:55], v9 offset:11520
    v_mfma_f32_16x16x32_bf16 v[232:235], v[56:59], v[24:27], 0
    ds_read_b128 v[40:43], v10 offset:20480
    v_mfma_f32_16x16x32_bf16 v[236:239], v[56:59], v[28:31], 0
    ds_read_b128 v[44:47], v10 offset:21504
    s_waitcnt lgkmcnt(8)
    v_mfma_f32_16x16x32_bf16 v[252:255], v[60:63], v[28:31], 0
    ds_read_b64_tr_b16 v[56:57], v9 offset:32
    v_mfma_f32_16x16x32_bf16 v[248:251], v[60:63], v[24:27], 0
    ds_read_b64_tr_b16 v[58:59], v9 offset:2336
    v_mfma_f32_16x16x32_bf16 v[244:247], v[60:63], v[20:23], 0
    v_mfma_f32_16x16x32_bf16 v[240:243], v[60:63], v[16:19], 0
    s_mov_b32 s47, 0
    s_waitcnt lgkmcnt(2)
    v_mfma_f32_16x16x32_bf16 v[64:67], v[48:51], v[32:35], v[64:67]
    ds_read_b64_tr_b16 v[60:61], v9 offset:9248
    v_mfma_f32_16x16x32_bf16 v[68:71], v[48:51], v[36:39], v[68:71]
    ds_read_b64_tr_b16 v[62:63], v9 offset:11552
    v_mfma_f32_16x16x32_bf16 v[72:75], v[48:51], v[40:43], v[72:75]
    s_add_u32 s44, s30, s47
    s_add_u32 s45, s29, s47
    v_mfma_f32_16x16x32_bf16 v[76:79], v[48:51], v[44:47], v[76:79]
    s_waitcnt lgkmcnt(4)
    v_mfma_f32_16x16x32_bf16 v[92:95], v[52:55], v[44:47], v[92:95]
    ds_read_b64_tr_b16 v[48:49], v9 offset:64
    s_add_u32 m0, s45, 0
    v_mfma_f32_16x16x32_bf16 v[88:91], v[52:55], v[40:43], v[88:91]
    ds_read_b64_tr_b16 v[50:51], v9 offset:2368
    v_mfma_f32_16x16x32_bf16 v[84:87], v[52:55], v[36:39], v[84:87]
    buffer_load_dwordx4 v2, s[12:15], s27 offen sc1 lds
    v_mfma_f32_16x16x32_bf16 v[80:83], v[52:55], v[32:35], v[80:83]
    s_waitcnt lgkmcnt(4)
    v_mfma_f32_16x16x32_bf16 v[96:99], v[56:59], v[32:35], v[96:99]
    ds_read_b64_tr_b16 v[52:53], v9 offset:9280
    s_add_u32 m0, s45, 1024
    v_mfma_f32_16x16x32_bf16 v[100:103], v[56:59], v[36:39], v[100:103]
    ds_read_b64_tr_b16 v[54:55], v9 offset:11584
    v_mfma_f32_16x16x32_bf16 v[104:107], v[56:59], v[40:43], v[104:107]
    buffer_load_dwordx4 v3, s[12:15], s27 offen sc1 lds
    v_mfma_f32_16x16x32_bf16 v[108:111], v[56:59], v[44:47], v[108:111]
    s_waitcnt lgkmcnt(4)
    v_mfma_f32_16x16x32_bf16 v[124:127], v[60:63], v[44:47], v[124:127]
    ds_read_b64_tr_b16 v[56:57], v9 offset:96
    s_add_u32 m0, s45, 2048
    v_mfma_f32_16x16x32_bf16 v[120:123], v[60:63], v[40:43], v[120:123]
    ds_read_b64_tr_b16 v[58:59], v9 offset:2400
    v_mfma_f32_16x16x32_bf16 v[116:119], v[60:63], v[36:39], v[116:119]
    buffer_load_dwordx4 v4, s[12:15], s27 offen sc1 lds
    s_add_u32 s27, s27, s28
    v_mfma_f32_16x16x32_bf16 v[112:115], v[60:63], v[32:35], v[112:115]
    s_waitcnt lgkmcnt(4)
    v_mfma_f32_16x16x32_bf16 v[128:131], v[48:51], v[32:35], v[128:131]
    ds_read_b64_tr_b16 v[60:61], v9 offset:9312
    s_add_u32 m0, s44, 0
    v_mfma_f32_16x16x32_bf16 v[132:135], v[48:51], v[36:39], v[132:135]
    ds_read_b64_tr_b16 v[62:63], v9 offset:11616
    v_mfma_f32_16x16x32_bf16 v[136:139], v[48:51], v[40:43], v[136:139]
    buffer_load_dwordx4 v1, s[20:23], s33 offen sc1 lds
    s_add_u32 s33, s33, 1024
    v_mfma_f32_16x16x32_bf16 v[140:143], v[48:51], v[44:47], v[140:143]
    s_waitcnt lgkmcnt(4)
    v_mfma_f32_16x16x32_bf16 v[156:159], v[52:55], v[44:47], v[156:159]
    ds_read_b64_tr_b16 v[48:49], v9 offset:128
    s_add_u32 m0, s44, 1024
    v_mfma_f32_16x16x32_bf16 v[152:155], v[52:55], v[40:43], v[152:155]
    ds_read_b64_tr_b16 v[50:51], v9 offset:2432
    v_mfma_f32_16x16x32_bf16 v[148:151], v[52:55], v[36:39], v[148:151]
    buffer_load_dwordx4 v1, s[20:23], s34 offen sc1 lds
    s_add_u32 s34, s34, 1024
    v_mfma_f32_16x16x32_bf16 v[144:147], v[52:55], v[32:35], v[144:147]
    s_waitcnt lgkmcnt(4)
    v_mfma_f32_16x16x32_bf16 v[160:163], v[56:59], v[32:35], v[160:163]
    ds_read_b64_tr_b16 v[52:53], v9 offset:9344
    v_mfma_f32_16x16x32_bf16 v[164:167], v[56:59], v[36:39], v[164:167]
    ds_read_b64_tr_b16 v[54:55], v9 offset:11648
    v_mfma_f32_16x16x32_bf16 v[168:171], v[56:59], v[40:43], v[168:171]
    v_mfma_f32_16x16x32_bf16 v[172:175], v[56:59], v[44:47], v[172:175]
    s_waitcnt lgkmcnt(4)
    v_mfma_f32_16x16x32_bf16 v[188:191], v[60:63], v[44:47], v[188:191]
    ds_read_b64_tr_b16 v[56:57], v9 offset:160
    v_mfma_f32_16x16x32_bf16 v[184:187], v[60:63], v[40:43], v[184:187]
    ds_read_b64_tr_b16 v[58:59], v9 offset:2464
    v_mfma_f32_16x16x32_bf16 v[180:183], v[60:63], v[36:39], v[180:183]
    v_mfma_f32_16x16x32_bf16 v[176:179], v[60:63], v[32:35], v[176:179]
    s_waitcnt lgkmcnt(4)
    v_mfma_f32_16x16x32_bf16 v[192:195], v[48:51], v[32:35], v[192:195]
    ds_read_b64_tr_b16 v[60:61], v9 offset:9376
    v_mfma_f32_16x16x32_bf16 v[196:199], v[48:51], v[36:39], v[196:199]
    ds_read_b64_tr_b16 v[62:63], v9 offset:11680
    v_mfma_f32_16x16x32_bf16 v[200:203], v[48:51], v[40:43], v[200:203]
    v_add_u32 v9, s46, v5
    v_add_u32 v10, s46, v6
    v_mfma_f32_16x16x32_bf16 v[204:207], v[48:51], v[44:47], v[204:207]
    s_waitcnt vmcnt(10) lgkmcnt(4)
    s_barrier
    v_mfma_f32_16x16x32_bf16 v[220:223], v[52:55], v[44:47], v[220:223]
    ds_read_b64_tr_b16 v[48:49], v9 offset:0
    v_mfma_f32_16x16x32_bf16 v[216:219], v[52:55], v[40:43], v[216:219]
    ds_read_b64_tr_b16 v[50:51], v9 offset:2304
    v_mfma_f32_16x16x32_bf16 v[212:215], v[52:55], v[36:39], v[212:215]
    ds_read_b128 v[16:19], v10 offset:18432
    v_mfma_f32_16x16x32_bf16 v[208:211], v[52:55], v[32:35], v[208:211]
    ds_read_b128 v[20:23], v10 offset:19456
    s_waitcnt lgkmcnt(6)
    v_mfma_f32_16x16x32_bf16 v[224:227], v[56:59], v[32:35], v[224:227]
    ds_read_b64_tr_b16 v[52:53], v9 offset:9216
    s_add_u32 s46, s46, 40960
    s_cmp_eq_u32 s46, 163840
    s_cselect_b32 s46, 0, s46
    v_mfma_f32_16x16x32_bf16 v[228:231], v[56:59], v[36:39], v[228:231]
    ds_read_b64_tr_b16 v[54:55], v9 offset:11520
    v_mfma_f32_16x16x32_bf16 v[232:235], v[56:59], v[40:43], v[232:235]
    ds_read_b128 v[24:27], v10 offset:20480
    v_mfma_f32_16x16x32_bf16 v[236:239], v[56:59], v[44:47], v[236:239]
    ds_read_b128 v[28:31], v10 offset:21504
    s_waitcnt lgkmcnt(8)
    v_mfma_f32_16x16x32_bf16 v[252:255], v[60:63], v[44:47], v[252:255]
    ds_read_b64_tr_b16 v[56:57], v9 offset:32
    v_mfma_f32_16x16x32_bf16 v[248:251], v[60:63], v[40:43], v[248:251]
    ds_read_b64_tr_b16 v[58:59], v9 offset:2336
    v_mfma_f32_16x16x32_bf16 v[244:247], v[60:63], v[36:39], v[244:247]
    v_mfma_f32_16x16x32_bf16 v[240:243], v[60:63], v[32:35], v[240:243]
    s_add_u32 s47, s47, 40960
    s_cmp_eq_u32 s47, 163840
    s_cselect_b32 s47, 0, s47
.p2align 6
L_g1_loop0:
    s_waitcnt lgkmcnt(2)
    v_mfma_f32_16x16x32_bf16 v[64:67], v[48:51], v[16:19], v[64:67]
    ds_read_b64_tr_b16 v[60:61], v9 offset:9248
    v_mfma_f32_16x16x32_bf16 v[68:71], v[48:51], v[20:23], v[68:71]
    ds_read_b64_tr_b16 v[62:63], v9 offset:11552
    v_mfma_f32_16x16x32_bf16 v[72:75], v[48:51], v[24:27], v[72:75]
    s_add_u32 s44, s30, s47
    s_add_u32 s45, s29, s47
    v_mfma_f32_16x16x32_bf16 v[76:79], v[48:51], v[28:31], v[76:79]
    s_waitcnt lgkmcnt(4)
    v_mfma_f32_16x16x32_bf16 v[92:95], v[52:55], v[28:31], v[92:95]
    ds_read_b64_tr_b16 v[48:49], v9 offset:64
    s_add_u32 m0, s45, 0
    v_mfma_f32_16x16x32_bf16 v[88:91], v[52:55], v[24:27], v[88:91]
    ds_read_b64_tr_b16 v[50:51], v9 offset:2368
    v_mfma_f32_16x16x32_bf16 v[84:87], v[52:55], v[20:23], v[84:87]
    buffer_load_dwordx4 v2, s[12:15], s27 offen sc1 lds
    v_mfma_f32_16x16x32_bf16 v[80:83], v[52:55], v[16:19], v[80:83]
    s_waitcnt lgkmcnt(4)
    v_mfma_f32_16x16x32_bf16 v[96:99], v[56:59], v[16:19], v[96:99]
    ds_read_b64_tr_b16 v[52:53], v9 offset:9280
    s_add_u32 m0, s45, 1024
    v_mfma_f32_16x16x32_bf16 v[100:103], v[56:59], v[20:23], v[100:103]
    ds_read_b64_tr_b16 v[54:55], v9 offset:11584
    v_mfma_f32_16x16x32_bf16 v[104:107], v[56:59], v[24:27], v[104:107]
    buffer_load_dwordx4 v3, s[12:15], s27 offen sc1 lds
    v_mfma_f32_16x16x32_bf16 v[108:111], v[56:59], v[28:31], v[108:111]
    s_waitcnt lgkmcnt(4)
    v_mfma_f32_16x16x32_bf16 v[124:127], v[60:63], v[28:31], v[124:127]
    ds_read_b64_tr_b16 v[56:57], v9 offset:96
    s_add_u32 m0, s45, 2048
    v_mfma_f32_16x16x32_bf16 v[120:123], v[60:63], v[24:27], v[120:123]
    ds_read_b64_tr_b16 v[58:59], v9 offset:2400
    v_mfma_f32_16x16x32_bf16 v[116:119], v[60:63], v[20:23], v[116:119]
    buffer_load_dwordx4 v4, s[12:15], s27 offen sc1 lds
    s_add_u32 s27, s27, s28
    v_mfma_f32_16x16x32_bf16 v[112:115], v[60:63], v[16:19], v[112:115]
    s_waitcnt lgkmcnt(4)
    v_mfma_f32_16x16x32_bf16 v[128:131], v[48:51], v[16:19], v[128:131]
    ds_read_b64_tr_b16 v[60:61], v9 offset:9312
    s_add_u32 m0, s44, 0
    v_mfma_f32_16x16x32_bf16 v[132:135], v[48:51], v[20:23], v[132:135]
    ds_read_b64_tr_b16 v[62:63], v9 offset:11616
    v_mfma_f32_16x16x32_bf16 v[136:139], v[48:51], v[24:27], v[136:139]
    buffer_load_dwordx4 v1, s[20:23], s33 offen sc1 lds
    s_add_u32 s33, s33, 1024
    v_mfma_f32_16x16x32_bf16 v[140:143], v[48:51], v[28:31], v[140:143]
    s_waitcnt lgkmcnt(4)
    v_mfma_f32_16x16x32_bf16 v[156:159], v[52:55], v[28:31], v[156:159]
    ds_read_b64_tr_b16 v[48:49], v9 offset:128
    s_add_u32 m0, s44, 1024
    v_mfma_f32_16x16x32_bf16 v[152:155], v[52:55], v[24:27], v[152:155]
    ds_read_b64_tr_b16 v[50:51], v9 offset:2432
    v_mfma_f32_16x16x32_bf16 v[148:151], v[52:55], v[20:23], v[148:151]
    buffer_load_dwordx4 v1, s[20:23], s34 offen sc1 lds
    s_add_u32 s34, s34, 1024
    v_mfma_f32_16x16x32_bf16 v[144:147], v[52:55], v[16:19], v[144:147]
    s_waitcnt lgkmcnt(4)
    v_mfma_f32_16x16x32_bf16 v[160:163], v[56:59], v[16:19], v[160:163]
    ds_read_b64_tr_b16 v[52:53], v9 offset:9344
    v_mfma_f32_16x16x32_bf16 v[164:167], v[56:59], v[20:23], v[164:167]
    ds_read_b64_tr_b16 v[54:55], v9 offset:11648
    v_mfma_f32_16x16x32_bf16 v[168:171], v[56:59], v[24:27], v[168:171]
    v_mfma_f32_16x16x32_bf16 v[172:175], v[56:59], v[28:31], v[172:175]
    s_waitcnt lgkmcnt(4)
    v_mfma_f32_16x16x32_bf16 v[188:191], v[60:63], v[28:31], v[188:191]
    ds_read_b64_tr_b16 v[56:57], v9 offset:160
    v_mfma_f32_16x16x32_bf16 v[184:187], v[60:63], v[24:27], v[184:187]
    ds_read_b64_tr_b16 v[58:59], v9 offset:2464
    v_mfma_f32_16x16x32_bf16 v[180:183], v[60:63], v[20:23], v[180:183]
    v_mfma_f32_16x16x32_bf16 v[176:179], v[60:63], v[16:19], v[176:179]
    s_waitcnt lgkmcnt(4)
    v_mfma_f32_16x16x32_bf16 v[192:195], v[48:51], v[16:19], v[192:195]
    ds_read_b64_tr_b16 v[60:61], v9 offset:9376
    v_mfma_f32_16x16x32_bf16 v[196:199], v[48:51], v[20:23], v[196:199]
    ds_read_b64_tr_b16 v[62:63], v9 offset:11680
    v_mfma_f32_16x16x32_bf16 v[200:203], v[48:51], v[24:27], v[200:203]
    v_add_u32 v9, s46, v5
    v_add_u32 v10, s46, v6
    v_mfma_f32_16x16x32_bf16 v[204:207], v[48:51], v[28:31], v[204:207]
    s_waitcnt vmcnt(10) lgkmcnt(4)
    s_barrier
    v_mfma_f32_16x16x32_bf16 v[220:223], v[52:55], v[28:31], v[220:223]
    ds_read_b64_tr_b16 v[48:49], v9 offset:0
    v_mfma_f32_16x16x32_bf16 v[216:219], v[52:55], v[24:27], v[216:219]
    ds_read_b64_tr_b16 v[50:51], v9 offset:2304
    v_mfma_f32_16x16x32_bf16 v[212:215], v[52:55], v[20:23], v[212:215]
    ds_read_b128 v[32:35], v10 offset:18432
    v_mfma_f32_16x16x32_bf16 v[208:211], v[52:55], v[16:19], v[208:211]
    ds_read_b128 v[36:39], v10 offset:19456
    s_waitcnt lgkmcnt(6)
    v_mfma_f32_16x16x32_bf16 v[224:227], v[56:59], v[16:19], v[224:227]
    ds_read_b64_tr_b16 v[52:53], v9 offset:9216
    s_add_u32 s46, s46, 40960
    s_cmp_eq_u32 s46, 163840
    s_cselect_b32 s46, 0, s46
    v_mfma_f32_16x16x32_bf16 v[228:231], v[56:59], v[20:23], v[228:231]
    ds_read_b64_tr_b16 v[54:55], v9 offset:11520
    v_mfma_f32_16x16x32_bf16 v[232:235], v[56:59], v[24:27], v[232:235]
    ds_read_b128 v[40:43], v10 offset:20480
    v_mfma_f32_16x16x32_bf16 v[236:239], v[56:59], v[28:31], v[236:239]
    ds_read_b128 v[44:47], v10 offset:21504
    s_waitcnt lgkmcnt(8)
    v_mfma_f32_16x16x32_bf16 v[252:255], v[60:63], v[28:31], v[252:255]
    ds_read_b64_tr_b16 v[56:57], v9 offset:32
    v_mfma_f32_16x16x32_bf16 v[248:251], v[60:63], v[24:27], v[248:251]
    ds_read_b64_tr_b16 v[58:59], v9 offset:2336
    v_mfma_f32_16x16x32_bf16 v[244:247], v[60:63], v[20:23], v[244:247]
    v_mfma_f32_16x16x32_bf16 v[240:243], v[60:63], v[16:19], v[240:243]
    s_add_u32 s47, s47, 40960
    s_cmp_eq_u32 s47, 163840
    s_cselect_b32 s47, 0, s47
    s_waitcnt lgkmcnt(2)
    v_mfma_f32_16x16x32_bf16 v[64:67], v[48:51], v[32:35], v[64:67]
    ds_read_b64_tr_b16 v[60:61], v9 offset:9248
    v_mfma_f32_16x16x32_bf16 v[68:71], v[48:51], v[36:39], v[68:71]
    ds_read_b64_tr_b16 v[62:63], v9 offset:11552
    v_mfma_f32_16x16x32_bf16 v[72:75], v[48:51], v[40:43], v[72:75]
    s_add_u32 s44, s30, s47
    s_add_u32 s45, s29, s47
    v_mfma_f32_16x16x32_bf16 v[76:79], v[48:51], v[44:47], v[76:79]
    s_waitcnt lgkmcnt(4)
    v_mfma_f32_16x16x32_bf16 v[92:95], v[52:55], v[44:47], v[92:95]
    ds_read_b64_tr_b16 v[48:49], v9 offset:64
    s_add_u32 m0, s45, 0
    v_mfma_f32_16x16x32_bf16 v[88:91], v[52:55], v[40:43], v[88:91]
    ds_read_b64_tr_b16 v[50:51], v9 offset:2368
    v_mfma_f32_16x16x32_bf16 v[84:87], v[52:55], v[36:39], v[84:87]
    buffer_load_dwordx4 v2, s[12:15], s27 offen sc1 lds
    v_mfma_f32_16x16x32_bf16 v[80:83], v[52:55], v[32:35], v[80:83]
    s_waitcnt lgkmcnt(4)
    v_mfma_f32_16x16x32_bf16 v[96:99], v[56:59], v[32:35], v[96:99]
    ds_read_b64_tr_b16 v[52:53], v9 offset:9280
    s_add_u32 m0, s45, 1024
    v_mfma_f32_16x16x32_bf16 v[100:103], v[56:59], v[36:39], v[100:103]
    ds_read_b64_tr_b16 v[54:55], v9 offset:11584
    v_mfma_f32_16x16x32_bf16 v[104:107], v[56:59], v[40:43], v[104:107]
    buffer_load_dwordx4 v3, s[12:15], s27 offen sc1 lds
    v_mfma_f32_16x16x32_bf16 v[108:111], v[56:59], v[44:47], v[108:111]
    s_waitcnt lgkmcnt(4)
    v_mfma_f32_16x16x32_bf16 v[124:127], v[60:63], v[44:47], v[124:127]
    ds_read_b64_tr_b16 v[56:57], v9 offset:96
    s_add_u32 m0, s45, 2048
    v_mfma_f32_16x16x32_bf16 v[120:123], v[60:63], v[40:43], v[120:123]
    ds_read_b64_tr_b16 v[58:59], v9 offset:2400
    v_mfma_f32_16x16x32_bf16 v[116:119], v[60:63], v[36:39], v[116:119]
    buffer_load_dwordx4 v4, s[12:15], s27 offen sc1 lds
    s_add_u32 s27, s27, s28
    v_mfma_f32_16x16x32_bf16 v[112:115], v[60:63], v[32:35], v[112:115]
    s_waitcnt lgkmcnt(4)
    v_mfma_f32_16x16x32_bf16 v[128:131], v[48:51], v[32:35], v[128:131]
    ds_read_b64_tr_b16 v[60:61], v9 offset:9312
    s_add_u32 m0, s44, 0
    v_mfma_f32_16x16x32_bf16 v[132:135], v[48:51], v[36:39], v[132:135]
    ds_read_b64_tr_b16 v[62:63], v9 offset:11616
    v_mfma_f32_16x16x32_bf16 v[136:139], v[48:51], v[40:43], v[136:139]
    buffer_load_dwordx4 v1, s[20:23], s33 offen sc1 lds
    s_add_u32 s33, s33, 1024
    v_mfma_f32_16x16x32_bf16 v[140:143], v[48:51], v[44:47], v[140:143]
    s_waitcnt lgkmcnt(4)
    v_mfma_f32_16x16x32_bf16 v[156:159], v[52:55], v[44:47], v[156:159]
    ds_read_b64_tr_b16 v[48:49], v9 offset:128
    s_add_u32 m0, s44, 1024
    v_mfma_f32_16x16x32_bf16 v[152:155], v[52:55], v[40:43], v[152:155]
    ds_read_b64_tr_b16 v[50:51], v9 offset:2432
    v_mfma_f32_16x16x32_bf16 v[148:151], v[52:55], v[36:39], v[148:151]
    buffer_load_dwordx4 v1, s[20:23], s34 offen sc1 lds
    s_add_u32 s34, s34, 1024
    v_mfma_f32_16x16x32_bf16 v[144:147], v[52:55], v[32:35], v[144:147]
    s_waitcnt lgkmcnt(4)
    v_mfma_f32_16x16x32_bf16 v[160:163], v[56:59], v[32:35], v[160:163]
    ds_read_b64_tr_b16 v[52:53], v9 offset:9344
    v_mfma_f32_16x16x32_bf16 v[164:167], v[56:59], v[36:39], v[164:167]
    ds_read_b64_tr_b16 v[54:55], v9 offset:11648
    v_mfma_f32_16x16x32_bf16 v[168:171], v[56:59], v[40:43], v[168:171]
    v_mfma_f32_16x16x32_bf16 v[172:175], v[56:59], v[44:47], v[172:175]
    s_waitcnt lgkmcnt(4)
    v_mfma_f32_16x16x32_bf16 v[188:191], v[60:63], v[44:47], v[188:191]
    ds_read_b64_tr_b16 v[56:57], v9 offset:160
    v_mfma_f32_16x16x32_bf16 v[184:187], v[60:63], v[40:43], v[184:187]
    ds_read_b64_tr_b16 v[58:59], v9 offset:2464
    v_mfma_f32_16x16x32_bf16 v[180:183], v[60:63], v[36:39], v[180:183]
    v_mfma_f32_16x16x32_bf16 v[176:179], v[60:63], v[32:35], v[176:179]
    s_waitcnt lgkmcnt(4)
    v_mfma_f32_16x16x32_bf16 v[192:195], v[48:51], v[32:35], v[192:195]
    ds_read_b64_tr_b16 v[60:61], v9 offset:9376
    v_mfma_f32_16x16x32_bf16 v[196:199], v[48:51], v[36:39], v[196:199]
    ds_read_b64_tr_b16 v[62:63], v9 offset:11680
    v_mfma_f32_16x16x32_bf16 v[200:203], v[48:51], v[40:43], v[200:203]
    v_add_u32 v9, s46, v5
    v_add_u32 v10, s46, v6
    v_mfma_f32_16x16x32_bf16 v[204:207], v[48:51], v[44:47], v[204:207]
    s_waitcnt vmcnt(10) lgkmcnt(4)
    s_barrier
    v_mfma_f32_16x16x32_bf16 v[220:223], v[52:55], v[44:47], v[220:223]
    ds_read_b64_tr_b16 v[48:49], v9 offset:0
    v_mfma_f32_16x16x32_bf16 v[216:219], v[52:55], v[40:43], v[216:219]
    ds_read_b64_tr_b16 v[50:51], v9 offset:2304
    v_mfma_f32_16x16x32_bf16 v[212:215], v[52:55], v[36:39], v[212:215]
    ds_read_b128 v[16:19], v10 offset:18432
    v_mfma_f32_16x16x32_bf16 v[208:211], v[52:55], v[32:35], v[208:211]
    ds_read_b128 v[20:23], v10 offset:19456
    s_waitcnt lgkmcnt(6)
    v_mfma_f32_16x16x32_bf16 v[224:227], v[56:59], v[32:35], v[224:227]
    ds_read_b64_tr_b16 v[52:53], v9 offset:9216
    s_add_u32 s46, s46, 40960
    s_cmp_eq_u32 s46, 163840
    s_cselect_b32 s46, 0, s46
    v_mfma_f32_16x16x32_bf16 v[228:231], v[56:59], v[36:39], v[228:231]
    ds_read_b64_tr_b16 v[54:55], v9 offset:11520
    v_mfma_f32_16x16x32_bf16 v[232:235], v[56:59], v[40:43], v[232:235]
    ds_read_b128 v[24:27], v10 offset:20480
    v_mfma_f32_16x16x32_bf16 v[236:239], v[56:59], v[44:47], v[236:239]
    ds_read_b128 v[28:31], v10 offset:21504
    s_waitcnt lgkmcnt(8)
    v_mfma_f32_16x16x32_bf16 v[252:255], v[60:63], v[44:47], v[252:255]
    ds_read_b64_tr_b16 v[56:57], v9 offset:32
    v_mfma_f32_16x16x32_bf16 v[248:251], v[60:63], v[40:43], v[248:251]
    ds_read_b64_tr_b16 v[58:59], v9 offset:2336
    v_mfma_f32_16x16x32_bf16 v[244:247], v[60:63], v[36:39], v[244:247]
    v_mfma_f32_16x16x32_bf16 v[240:243], v[60:63], v[32:35], v[240:243]
    s_add_u32 s47, s47, 40960
    s_cmp_eq_u32 s47, 163840
    s_cselect_b32 s47, 0, s47
    s_add_u32 s35, s35, 1
    s_cmp_lt_u32 s35, 6
    s_cbranch_scc1 L_g1_loop0
L_g1_exit0:
    s_waitcnt lgkmcnt(2)
    v_mfma_f32_16x16x32_bf16 v[64:67], v[48:51], v[16:19], v[64:67]
    ds_read_b64_tr_b16 v[60:61], v9 offset:9248
    v_mfma_f32_16x16x32_bf16 v[68:71], v[48:51], v[20:23], v[68:71]
    ds_read_b64_tr_b16 v[62:63], v9 offset:11552
    v_mfma_f32_16x16x32_bf16 v[72:75], v[48:51], v[24:27], v[72:75]
    s_add_u32 s44, s30, s47
    s_add_u32 s45, s29, s47
    v_mfma_f32_16x16x32_bf16 v[76:79], v[48:51], v[28:31], v[76:79]
    s_waitcnt lgkmcnt(4)
    v_mfma_f32_16x16x32_bf16 v[92:95], v[52:55], v[28:31], v[92:95]
    ds_read_b64_tr_b16 v[48:49], v9 offset:64
    s_add_u32 m0, s45, 0
    v_mfma_f32_16x16x32_bf16 v[88:91], v[52:55], v[24:27], v[88:91]
    ds_read_b64_tr_b16 v[50:51], v9 offset:2368
    v_mfma_f32_16x16x32_bf16 v[84:87], v[52:55], v[20:23], v[84:87]
    buffer_load_dwordx4 v2, s[12:15], s27 offen sc1 lds
    v_mfma_f32_16x16x32_bf16 v[80:83], v[52:55], v[16:19], v[80:83]
    s_waitcnt lgkmcnt(4)
    v_mfma_f32_16x16x32_bf16 v[96:99], v[56:59], v[16:19], v[96:99]
    ds_read_b64_tr_b16 v[52:53], v9 offset:9280
    s_add_u32 m0, s45, 1024
    v_mfma_f32_16x16x32_bf16 v[100:103], v[56:59], v[20:23], v[100:103]
    ds_read_b64_tr_b16 v[54:55], v9 offset:11584
    v_mfma_f32_16x16x32_bf16 v[104:107], v[56:59], v[24:27], v[104:107]
    buffer_load_dwordx4 v3, s[12:15], s27 offen sc1 lds
    v_mfma_f32_16x16x32_bf16 v[108:111], v[56:59], v[28:31], v[108:111]
    s_waitcnt lgkmcnt(4)
    v_mfma_f32_16x16x32_bf16 v[124:127], v[60:63], v[28:31], v[124:127]
    ds_read_b64_tr_b16 v[56:57], v9 offset:96
    s_add_u32 m0, s45, 2048
    v_mfma_f32_16x16x32_bf16 v[120:123], v[60:63], v[24:27], v[120:123]
    ds_read_b64_tr_b16 v[58:59], v9 offset:2400
    v_mfma_f32_16x16x32_bf16 v[116:119], v[60:63], v[20:23], v[116:119]
    buffer_load_dwordx4 v4, s[12:15], s27 offen sc1 lds
    s_add_u32 s27, s27, s28
    v_mfma_f32_16x16x32_bf16 v[112:115], v[60:63], v[16:19], v[112:115]
    s_waitcnt lgkmcnt(4)
    v_mfma_f32_16x16x32_bf16 v[128:131], v[48:51], v[16:19], v[128:131]
    ds_read_b64_tr_b16 v[60:61], v9 offset:9312
    s_add_u32 m0, s44, 0
    v_mfma_f32_16x16x32_bf16 v[132:135], v[48:51], v[20:23], v[132:135]
    ds_read_b64_tr_b16 v[62:63], v9 offset:11616
    v_mfma_f32_16x16x32_bf16 v[136:139], v[48:51], v[24:27], v[136:139]
    buffer_load_dwordx4 v1, s[20:23], s33 offen sc1 lds
    s_add_u32 s33, s33, 1024
    v_mfma_f32_16x16x32_bf16 v[140:143], v[48:51], v[28:31], v[140:143]
    s_waitcnt lgkmcnt(4)
    v_mfma_f32_16x16x32_bf16 v[156:159], v[52:55], v[28:31], v[156:159]
    ds_read_b64_tr_b16 v[48:49], v9 offset:128
    s_add_u32 m0, s44, 1024
    v_mfma_f32_16x16x32_bf16 v[152:155], v[52:55], v[24:27], v[152:155]
    ds_read_b64_tr_b16 v[50:51], v9 offset:2432
    v_mfma_f32_16x16x32_bf16 v[148:151], v[52:55], v[20:23], v[148:151]
    buffer_load_dwordx4 v1, s[20:23], s34 offen sc1 lds
    s_add_u32 s34, s34, 1024
    v_mfma_f32_16x16x32_bf16 v[144:147], v[52:55], v[16:19], v[144:147]
    s_waitcnt lgkmcnt(4)
    v_mfma_f32_16x16x32_bf16 v[160:163], v[56:59], v[16:19], v[160:163]
    ds_read_b64_tr_b16 v[52:53], v9 offset:9344
    v_mfma_f32_16x16x32_bf16 v[164:167], v[56:59], v[20:23], v[164:167]
    ds_read_b64_tr_b16 v[54:55], v9 offset:11648
    v_mfma_f32_16x16x32_bf16 v[168:171], v[56:59], v[24:27], v[168:171]
    v_mfma_f32_16x16x32_bf16 v[172:175], v[56:59], v[28:31], v[172:175]
    s_waitcnt lgkmcnt(4)
    v_mfma_f32_16x16x32_bf16 v[188:191], v[60:63], v[28:31], v[188:191]
    ds_read_b64_tr_b16 v[56:57], v9 offset:160
    v_mfma_f32_16x16x32_bf16 v[184:187], v[60:63], v[24:27], v[184:187]
    ds_read_b64_tr_b16 v[58:59], v9 offset:2464
    v_mfma_f32_16x16x32_bf16 v[180:183], v[60:63], v[20:23], v[180:183]
    v_mfma_f32_16x16x32_bf16 v[176:179], v[60:63], v[16:19], v[176:179]
    s_waitcnt lgkmcnt(4)
    v_mfma_f32_16x16x32_bf16 v[192:195], v[48:51], v[16:19], v[192:195]
    ds_read_b64_tr_b16 v[60:61], v9 offset:9376
    v_mfma_f32_16x16x32_bf16 v[196:199], v[48:51], v[20:23], v[196:199]
    ds_read_b64_tr_b16 v[62:63], v9 offset:11680
    v_mfma_f32_16x16x32_bf16 v[200:203], v[48:51], v[24:27], v[200:203]
    v_add_u32 v9, s46, v5
    v_add_u32 v10, s46, v6
    v_mfma_f32_16x16x32_bf16 v[204:207], v[48:51], v[28:31], v[204:207]
    s_waitcnt vmcnt(10) lgkmcnt(4)
    s_barrier
    v_mfma_f32_16x16x32_bf16 v[220:223], v[52:55], v[28:31], v[220:223]
    ds_read_b64_tr_b16 v[48:49], v9 offset:0
    v_mfma_f32_16x16x32_bf16 v[216:219], v[52:55], v[24:27], v[216:219]
    ds_read_b64_tr_b16 v[50:51], v9 offset:2304
    v_mfma_f32_16x16x32_bf16 v[212:215], v[52:55], v[20:23], v[212:215]
    ds_read_b128 v[32:35], v10 offset:18432
    v_mfma_f32_16x16x32_bf16 v[208:211], v[52:55], v[16:19], v[208:211]
    ds_read_b128 v[36:39], v10 offset:19456
    s_waitcnt lgkmcnt(6)
    v_mfma_f32_16x16x32_bf16 v[224:227], v[56:59], v[16:19], v[224:227]
    ds_read_b64_tr_b16 v[52:53], v9 offset:9216
    s_add_u32 s46, s46, 40960
    s_cmp_eq_u32 s46, 163840
    s_cselect_b32 s46, 0, s46
    v_mfma_f32_16x16x32_bf16 v[228:231], v[56:59], v[20:23], v[228:231]
    ds_read_b64_tr_b16 v[54:55], v9 offset:11520
    v_mfma_f32_16x16x32_bf16 v[232:235], v[56:59], v[24:27], v[232:235]
    ds_read_b128 v[40:43], v10 offset:20480
    v_mfma_f32_16x16x32_bf16 v[236:239], v[56:59], v[28:31], v[236:239]
    ds_read_b128 v[44:47], v10 offset:21504
    s_waitcnt lgkmcnt(8)
    v_mfma_f32_16x16x32_bf16 v[252:255], v[60:63], v[28:31], v[252:255]
    ds_read_b64_tr_b16 v[56:57], v9 offset:32
    v_mfma_f32_16x16x32_bf16 v[248:251], v[60:63], v[24:27], v[248:251]
    ds_read_b64_tr_b16 v[58:59], v9 offset:2336
    v_mfma_f32_16x16x32_bf16 v[244:247], v[60:63], v[20:23], v[244:247]
    v_mfma_f32_16x16x32_bf16 v[240:243], v[60:63], v[16:19], v[240:243]
    s_add_u32 s47, s47, 40960
    s_cmp_eq_u32 s47, 163840
    s_cselect_b32 s47, 0, s47
    s_waitcnt lgkmcnt(2)
    v_mfma_f32_16x16x32_bf16 v[64:67], v[48:51], v[32:35], v[64:67]
    ds_read_b64_tr_b16 v[60:61], v9 offset:9248
    v_mfma_f32_16x16x32_bf16 v[68:71], v[48:51], v[36:39], v[68:71]
    ds_read_b64_tr_b16 v[62:63], v9 offset:11552
    v_mfma_f32_16x16x32_bf16 v[72:75], v[48:51], v[40:43], v[72:75]
    s_add_u32 m0, s64, 0
    v_mfma_f32_16x16x32_bf16 v[76:79], v[48:51], v[44:47], v[76:79]
    s_waitcnt lgkmcnt(4)
    v_mfma_f32_16x16x32_bf16 v[92:95], v[52:55], v[44:47], v[92:95]
    ds_read_b64_tr_b16 v[48:49], v9 offset:64
    buffer_load_dwordx4 v7, s[16:19], s56 offen  lds
    v_mfma_f32_16x16x32_bf16 v[88:91], v[52:55], v[40:43], v[88:91]
    ds_read_b64_tr_b16 v[50:51], v9 offset:2368
    v_mfma_f32_16x16x32_bf16 v[84:87], v[52:55], v[36:39], v[84:87]
    s_add_u32 m0, s64, 1024
    v_mfma_f32_16x16x32_bf16 v[80:83], v[52:55], v[32:35], v[80:83]
    s_waitcnt lgkmcnt(4)
    v_mfma_f32_16x16x32_bf16 v[96:99], v[56:59], v[32:35], v[96:99]
    ds_read_b64_tr_b16 v[52:53], v9 offset:9280
    buffer_load_dwordx4 v8, s[16:19], s56 offen  lds
    v_mfma_f32_16x16x32_bf16 v[100:103], v[56:59], v[36:39], v[100:103]
    ds_read_b64_tr_b16 v[54:55], v9 offset:11584
    v_mfma_f32_16x16x32_bf16 v[104:107], v[56:59], v[40:43], v[104:107]
    s_add_u32 m0, s64, 2048
    v_mfma_f32_16x16x32_bf16 v[108:111], v[56:59], v[44:47], v[108:111]
    s_waitcnt lgkmcnt(4)
    v_mfma_f32_16x16x32_bf16 v[124:127], v[60:63], v[44:47], v[124:127]
    ds_read_b64_tr_b16 v[56:57], v9 offset:96
    buffer_load_dwordx4 v11, s[16:19], s56 offen  lds
    v_mfma_f32_16x16x32_bf16 v[120:123], v[60:63], v[40:43], v[120:123]
    ds_read_b64_tr_b16 v[58:59], v9 offset:2400
    v_mfma_f32_16x16x32_bf16 v[116:119], v[60:63], v[36:39], v[116:119]
    s_add_u32 m0, s64, 3072
    v_mfma_f32_16x16x32_bf16 v[112:115], v[60:63], v[32:35], v[112:115]
    s_waitcnt lgkmcnt(4)
    v_mfma_f32_16x16x32_bf16 v[128:131], v[48:51], v[32:35], v[128:131]
    ds_read_b64_tr_b16 v[60:61], v9 offset:9312
    buffer_load_dwordx4 v12, s[16:19], s56 offen  lds
    v_mfma_f32_16x16x32_bf16 v[132:135], v[48:51], v[36:39], v[132:135]
    ds_read_b64_tr_b16 v[62:63], v9 offset:11616
    v_mfma_f32_16x16x32_bf16 v[136:139], v[48:51], v[40:43], v[136:139]
    s_add_u32 m0, s64, 4096
    v_mfma_f32_16x16x32_bf16 v[140:143], v[48:51], v[44:47], v[140:143]
    s_waitcnt lgkmcnt(4)
    v_mfma_f32_16x16x32_bf16 v[156:159], v[52:55], v[44:47], v[156:159]
    ds_read_b64_tr_b16 v[48:49], v9 offset:128
    buffer_load_dwordx4 v15, s[16:19], s56 offen  lds
    v_mfma_f32_16x16x32_bf16 v[152:155], v[52:55], v[40:43], v[152:155]
    ds_read_b64_tr_b16 v[50:51], v9 offset:2432
    v_mfma_f32_16x16x32_bf16 v[148:151], v[52:55], v[36:39], v[148:151]
    v_mfma_f32_16x16x32_bf16 v[144:147], v[52:55], v[32:35], v[144:147]
    s_waitcnt lgkmcnt(4)
    v_mfma_f32_16x16x32_bf16 v[160:163], v[56:59], v[32:35], v[160:163]
    ds_read_b64_tr_b16 v[52:53], v9 offset:9344
    v_mfma_f32_16x16x32_bf16 v[164:167], v[56:59], v[36:39], v[164:167]
    ds_read_b64_tr_b16 v[54:55], v9 offset:11648
    v_mfma_f32_16x16x32_bf16 v[168:171], v[56:59], v[40:43], v[168:171]
    v_mfma_f32_16x16x32_bf16 v[172:175], v[56:59], v[44:47], v[172:175]
    s_waitcnt lgkmcnt(4)
    v_mfma_f32_16x16x32_bf16 v[188:191], v[60:63], v[44:47], v[188:191]
    ds_read_b64_tr_b16 v[56:57], v9 offset:160
    v_mfma_f32_16x16x32_bf16 v[184:187], v[60:63], v[40:43], v[184:187]
    ds_read_b64_tr_b16 v[58:59], v9 offset:2464
    v_mfma_f32_16x16x32_bf16 v[180:183], v[60:63], v[36:39], v[180:183]
    v_mfma_f32_16x16x32_bf16 v[176:179], v[60:63], v[32:35], v[176:179]
    s_waitcnt lgkmcnt(4)
    v_mfma_f32_16x16x32_bf16 v[192:195], v[48:51], v[32:35], v[192:195]
    ds_read_b64_tr_b16 v[60:61], v9 offset:9376
    v_mfma_f32_16x16x32_bf16 v[196:199], v[48:51], v[36:39], v[196:199]
    ds_read_b64_tr_b16 v[62:63], v9 offset:11680
    v_mfma_f32_16x16x32_bf16 v[200:203], v[48:51], v[40:43], v[200:203]
    v_add_u32 v9, s46, v5
    v_add_u32 v10, s46, v6
    v_mfma_f32_16x16x32_bf16 v[204:207], v[48:51], v[44:47], v[204:207]
    s_waitcnt vmcnt(5) lgkmcnt(4)
    s_barrier
    v_mfma_f32_16x16x32_bf16 v[220:223], v[52:55], v[44:47], v[220:223]
    ds_read_b64_tr_b16 v[48:49], v9 offset:0
    v_mfma_f32_16x16x32_bf16 v[216:219], v[52:55], v[40:43], v[216:219]
    ds_read_b64_tr_b16 v[50:51], v9 offset:2304
    v_mfma_f32_16x16x32_bf16 v[212:215], v[52:55], v[36:39], v[212:215]
    ds_read_b128 v[16:19], v10 offset:18432
    v_mfma_f32_16x16x32_bf16 v[208:211], v[52:55], v[32:35], v[208:211]
    ds_read_b128 v[20:23], v10 offset:19456
    s_waitcnt lgkmcnt(6)
    v_mfma_f32_16x16x32_bf16 v[224:227], v[56:59], v[32:35], v[224:227]
    ds_read_b64_tr_b16 v[52:53], v9 offset:40960
    s_add_u32 s46, s46, 40960
    s_cmp_eq_u32 s46, 163840
    s_cselect_b32 s46, 0, s46
    v_mfma_f32_16x16x32_bf16 v[228:231], v[56:59], v[36:39], v[228:231]
    ds_read_b64_tr_b16 v[54:55], v9 offset:43264
    v_mfma_f32_16x16x32_bf16 v[232:235], v[56:59], v[40:43], v[232:235]
    ds_read_b128 v[24:27], v10 offset:20480
    v_mfma_f32_16x16x32_bf16 v[236:239], v[56:59], v[44:47], v[236:239]
    ds_read_b128 v[28:31], v10 offset:21504
    s_waitcnt lgkmcnt(8)
    v_mfma_f32_16x16x32_bf16 v[252:255], v[60:63], v[44:47], v[252:255]
    ds_read_b64_tr_b16 v[56:57], v9 offset:9216
    v_mfma_f32_16x16x32_bf16 v[248:251], v[60:63], v[40:43], v[248:251]
    ds_read_b64_tr_b16 v[58:59], v9 offset:11520
    v_mfma_f32_16x16x32_bf16 v[244:247], v[60:63], v[36:39], v[244:247]
    v_mfma_f32_16x16x32_bf16 v[240:243], v[60:63], v[32:35], v[240:243]
    ds_read_b128 v[32:35], v10 offset:59392
    ds_read_b128 v[36:39], v10 offset:60416
    ds_read_b128 v[40:43], v10 offset:61440
    ds_read_b128 v[44:47], v10 offset:62464
L_g1_postA:
    s_setprio 2
    s_waitcnt lgkmcnt(6)
    v_mfma_f32_16x16x32_bf16 v[64:67], v[48:51], v[16:19], v[64:67]
    ds_read_b64_tr_b16 v[60:61], v9 offset:50176
    v_mfma_f32_16x16x32_bf16 v[68:71], v[48:51], v[20:23], v[68:71]
    ds_read_b64_tr_b16 v[62:63], v9 offset:52480
    v_mfma_f32_16x16x32_bf16 v[72:75], v[48:51], v[24:27], v[72:75]
    v_mfma_f32_16x16x32_bf16 v[76:79], v[48:51], v[28:31], v[76:79]
    s_waitcnt lgkmcnt(2)
    v_mfma_f32_16x16x32_bf16 v[64:67], v[52:55], v[32:35], v[64:67]
    ds_read_b64_tr_b16 v[48:49], v9 offset:32
    v_mfma_f32_16x16x32_bf16 v[68:71], v[52:55], v[36:39], v[68:71]
    ds_read_b64_tr_b16 v[50:51], v9 offset:2336
    v_mfma_f32_16x16x32_bf16 v[72:75], v[52:55], v[40:43], v[72:75]
    v_mfma_f32_16x16x32_bf16 v[76:79], v[52:55], v[44:47], v[76:79]
    s_waitcnt lgkmcnt(4)
    v_mfma_f32_16x16x32_bf16 v[80:83], v[56:59], v[16:19], v[80:83]
    ds_read_b64_tr_b16 v[52:53], v9 offset:40992
    v_mfma_f32_16x16x32_bf16 v[84:87], v[56:59], v[20:23], v[84:87]
    ds_read_b64_tr_b16 v[54:55], v9 offset:43296
    v_mfma_f32_16x16x32_bf16 v[88:91], v[56:59], v[24:27], v[88:91]
    v_mfma_f32_16x16x32_bf16 v[92:95], v[56:59], v[28:31], v[92:95]
    s_waitcnt lgkmcnt(4)
    v_mfma_f32_16x16x32_bf16 v[80:83], v[60:63], v[32:35], v[80:83]
    ds_read_b64_tr_b16 v[56:57], v9 offset:9248
    v_mfma_f32_16x16x32_bf16 v[84:87], v[60:63], v[36:39], v[84:87]
    ds_read_b64_tr_b16 v[58:59], v9 offset:11552
    v_mfma_f32_16x16x32_bf16 v[88:91], v[60:63], v[40:43], v[88:91]
    v_mfma_f32_16x16x32_bf16 v[92:95], v[60:63], v[44:47], v[92:95]
    s_waitcnt lgkmcnt(4)
    v_mfma_f32_16x16x32_bf16 v[96:99], v[48:51], v[16:19], v[96:99]
    ds_read_b64_tr_b16 v[60:61], v9 offset:50208
    v_mfma_f32_16x16x32_bf16 v[100:103], v[48:51], v[20:23], v[100:103]
    ds_read_b64_tr_b16 v[62:63], v9 offset:52512
    v_mfma_f32_16x16x32_bf16 v[104:107], v[48:51], v[24:27], v[104:107]
    v_mfma_f32_16x16x32_bf16 v[108:111], v[48:51], v[28:31], v[108:111]
    s_waitcnt lgkmcnt(4)
    v_mfma_f32_16x16x32_bf16 v[96:99], v[52:55], v[32:35], v[96:99]
    ds_read_b64_tr_b16 v[48:49], v9 offset:64
    v_mfma_f32_16x16x32_bf16 v[100:103], v[52:55], v[36:39], v[100:103]
    ds_read_b64_tr_b16 v[50:51], v9 offset:2368
    v_mfma_f32_16x16x32_bf16 v[104:107], v[52:55], v[40:43], v[104:107]
    v_mfma_f32_16x16x32_bf16 v[108:111], v[52:55], v[44:47], v[108:111]
    s_waitcnt lgkmcnt(4)
    v_mfma_f32_16x16x32_bf16 v[112:115], v[56:59], v[16:19], v[112:115]
    ds_read_b64_tr_b16 v[52:53], v9 offset:41024
    v_mfma_f32_16x16x32_bf16 v[116:119], v[56:59], v[20:23], v[116:119]
    ds_read_b64_tr_b16 v[54:55], v9 offset:43328
    v_mfma_f32_16x16x32_bf16 v[120:123], v[56:59], v[24:27], v[120:123]
    v_mfma_f32_16x16x32_bf16 v[124:127], v[56:59], v[28:31], v[124:127]
    s_waitcnt lgkmcnt(4)
    v_mfma_f32_16x16x32_bf16 v[112:115], v[60:63], v[32:35], v[112:115]
    ds_read_b64_tr_b16 v[56:57], v9 offset:9280
    v_mfma_f32_16x16x32_bf16 v[116:119], v[60:63], v[36:39], v[116:119]
    ds_read_b64_tr_b16 v[58:59], v9 offset:11584
    v_mfma_f32_16x16x32_bf16 v[120:123], v[60:63], v[40:43], v[120:123]
    v_mfma_f32_16x16x32_bf16 v[124:127], v[60:63], v[44:47], v[124:127]
    s_mov_b32 s40, 0xbfb8aa3b
    s_mov_b32 s41, 0xbfb8aa3b
    s_mov_b32 s42, 1.0
    s_mov_b32 s43, 1.0
    s_lshl_b32 s48, s26, 4
    s_lshl_b32 s3, s31, 2
    s_add_u32 s48, s48, s3
    s_mul_i32 s48, s48, 147456
    s_lshr_b32 s3, s25, 1
    s_mul_i32 s3, s3, 9216
    s_add_u32 s48, s48, s3
    s_add_u32 s48, s48, 9699328
    s_and_b32 s3, s25, 1
    s_lshl_b32 s36, s3, 9
    s_add_u32 s36, s36, s48
    s_add_u32 s36, s36, 8192
    s_lshl_b32 s3, s3, 12
    s_add_u32 s48, s48, s3
    s_add_u32 s49, s48, 147456
    s_add_u32 s50, s48, 294912
    s_add_u32 s51, s48, 442368
    s_add_u32 s37, s36, 294912
    v_mov_b32 v15, 0x80000000
    v_cmp_eq_u32 vcc, 0, v0
    v_mov_b32 v14, s99
    s_lshl_b32 s38, s26, 2
    s_add_u32 s38, s38, s31
    v_cndmask_b32 v13, v15, 0, vcc
    s_lshl_b32 s39, s38, 8
    s_lshl_b32 s3, s25, 3
    s_add_u32 s39, s39, s3
    s_add_u32 s39, s39, 49295360
    s_lshl_b32 s3, s31, 2
    s_add_u32 s3, s3, 162832
    v_mov_b32 v10, s3
    v_lshrrev_b32 v7, 2, v0
    v_mul_u32_u24 v7, 1152, v7
    v_and_b32 v8, 3, v0
    v_lshl_add_u32 v7, v8, 3, v7
    s_lshl_b32 s3, s31, 5
    s_add_u32 s3, s3, 82944
    v_add_u32 v8, s3, v7
    s_lshl_b32 s3, s31, 8
    s_add_u32 s3, s3, 81920
    v_add_u32 v7, s3, v7
    s_add_u32 s62, s61, 4096
    s_add_u32 s63, s61, 8192
    s_lshl_b32 s64, s31, 10
    s_add_u32 s64, s64, s67
    s_add_u32 s64, s64, 49303552
    v_lshlrev_b32 v2, 2, v0
    v_cmp_gt_u32 vcc, 32, v0
    s_lshl_b32 s52, s25, 7
    s_add_u32 s52, s52, 49291264
    s_and_b32 s3, s26, 0
    s_mul_i32 s3, s3, 41216
    s_add_u32 s52, s52, s3
    v_cndmask_b32 v4, v15, v2, vcc
    s_mul_i32 s29, s31, 5120
    s_mul_i32 s28, s25, 163840
    s_add_u32 s28, s28, 4456448
    s_add_u32 s28, s28, s29
    s_mov_b32 s27, s26
    s_lshl_b32 s3, s26, 2
    s_add_u32 s3, s3, 4
    s_mov_b64 s[54:55], 0xff
    s_lshl_b64 s[54:55], s[54:55], s3
    s_or_b32 s54, s54, s55
    s_mov_b32 s55, 0
    s_mov_b32 s53, 0
    s_waitcnt lgkmcnt(4)
    v_mfma_f32_16x16x32_bf16 v[128:131], v[48:51], v[16:19], v[128:131]
    ds_read_b64_tr_b16 v[60:61], v9 offset:50240
    v_pk_mul_f32 v[64:65], v[64:65], s[40:41]
    v_pk_mul_f32 v[66:67], v[66:67], s[40:41]
    v_pk_mul_f32 v[96:97], v[96:97], s[40:41]
    v_pk_mul_f32 v[98:99], v[98:99], s[40:41]
    v_mfma_f32_16x16x32_bf16 v[132:135], v[48:51], v[20:23], v[132:135]
    ds_read_b64_tr_b16 v[62:63], v9 offset:52544
    v_exp_f32 v64, v64
    v_exp_f32 v65, v65
    v_exp_f32 v66, v66
    v_exp_f32 v67, v67
    v_mfma_f32_16x16x32_bf16 v[136:139], v[48:51], v[24:27], v[136:139]
    v_exp_f32 v96, v96
    v_exp_f32 v97, v97
    v_exp_f32 v98, v98
    v_exp_f32 v99, v99
    v_mfma_f32_16x16x32_bf16 v[140:143], v[48:51], v[28:31], v[140:143]
    v_pk_add_f32 v[64:65], v[64:65], s[42:43]
    v_pk_add_f32 v[66:67], v[66:67], s[42:43]
    v_pk_add_f32 v[96:97], v[96:97], s[42:43]
    v_pk_add_f32 v[98:99], v[98:99], s[42:43]
    s_waitcnt lgkmcnt(4)
    v_mfma_f32_16x16x32_bf16 v[128:131], v[52:55], v[32:35], v[128:131]
    ds_read_b64_tr_b16 v[48:49], v9 offset:96
    v_rcp_f32 v64, v64
    v_rcp_f32 v65, v65
    v_rcp_f32 v66, v66
    v_rcp_f32 v67, v67
    v_mfma_f32_16x16x32_bf16 v[132:135], v[52:55], v[36:39], v[132:135]
    ds_read_b64_tr_b16 v[50:51], v9 offset:2400
    v_rcp_f32 v96, v96
    v_rcp_f32 v97, v97
    v_rcp_f32 v98, v98
    v_rcp_f32 v99, v99
    v_mfma_f32_16x16x32_bf16 v[136:139], v[52:55], v[40:43], v[136:139]
    v_pk_mul_f32 v[64:65], v[64:65], v[80:81]
    v_pk_mul_f32 v[66:67], v[66:67], v[82:83]
    v_pk_mul_f32 v[96:97], v[96:97], v[112:113]
    v_pk_mul_f32 v[98:99], v[98:99], v[114:115]
    v_mfma_f32_16x16x32_bf16 v[140:143], v[52:55], v[44:47], v[140:143]
    v_cvt_pk_bf16_f32 v64, v64, v65
    v_cvt_pk_bf16_f32 v65, v66, v67
    v_cvt_pk_bf16_f32 v66, v96, v97
    v_cvt_pk_bf16_f32 v67, v98, v99
    s_waitcnt vmcnt(3)
    buffer_store_dwordx4 v[64:67], v1, s[20:23], s48 offen offset:0 sc1
    s_waitcnt lgkmcnt(4)
    v_mfma_f32_16x16x32_bf16 v[144:147], v[56:59], v[16:19], v[144:147]
    ds_read_b64_tr_b16 v[52:53], v9 offset:41056
    v_pk_mul_f32 v[68:69], v[68:69], s[40:41]
    v_pk_mul_f32 v[70:71], v[70:71], s[40:41]
    v_pk_mul_f32 v[100:101], v[100:101], s[40:41]
    v_pk_mul_f32 v[102:103], v[102:103], s[40:41]
    v_mfma_f32_16x16x32_bf16 v[148:151], v[56:59], v[20:23], v[148:151]
    ds_read_b64_tr_b16 v[54:55], v9 offset:43360
    v_exp_f32 v68, v68
    v_exp_f32 v69, v69
    v_exp_f32 v70, v70
    v_exp_f32 v71, v71
    v_mfma_f32_16x16x32_bf16 v[152:155], v[56:59], v[24:27], v[152:155]
    v_exp_f32 v100, v100
    v_exp_f32 v101, v101
    v_exp_f32 v102, v102
    v_exp_f32 v103, v103
    v_mfma_f32_16x16x32_bf16 v[156:159], v[56:59], v[28:31], v[156:159]
    v_pk_add_f32 v[68:69], v[68:69], s[42:43]
    v_pk_add_f32 v[70:71], v[70:71], s[42:43]
    v_pk_add_f32 v[100:101], v[100:101], s[42:43]
    v_pk_add_f32 v[102:103], v[102:103], s[42:43]
    s_waitcnt lgkmcnt(4)
    v_mfma_f32_16x16x32_bf16 v[144:147], v[60:63], v[32:35], v[144:147]
    ds_read_b64_tr_b16 v[56:57], v9 offset:9312
    v_rcp_f32 v68, v68
    v_rcp_f32 v69, v69
    v_rcp_f32 v70, v70
    v_rcp_f32 v71, v71
    v_mfma_f32_16x16x32_bf16 v[148:151], v[60:63], v[36:39], v[148:151]
    ds_read_b64_tr_b16 v[58:59], v9 offset:11616
    v_rcp_f32 v100, v100
    v_rcp_f32 v101, v101
    v_rcp_f32 v102, v102
    v_rcp_f32 v103, v103
    v_mfma_f32_16x16x32_bf16 v[152:155], v[60:63], v[40:43], v[152:155]
    v_pk_mul_f32 v[68:69], v[68:69], v[84:85]
    v_pk_mul_f32 v[70:71], v[70:71], v[86:87]
    v_pk_mul_f32 v[100:101], v[100:101], v[116:117]
    v_pk_mul_f32 v[102:103], v[102:103], v[118:119]
    v_mfma_f32_16x16x32_bf16 v[156:159], v[60:63], v[44:47], v[156:159]
    v_cvt_pk_bf16_f32 v68, v68, v69
    v_cvt_pk_bf16_f32 v69, v70, v71
    v_cvt_pk_bf16_f32 v70, v100, v101
    v_cvt_pk_bf16_f32 v71, v102, v103
    s_waitcnt vmcnt(3)
    buffer_store_dwordx4 v[68:71], v1, s[20:23], s49 offen offset:0 sc1
    s_waitcnt lgkmcnt(4)
    v_mfma_f32_16x16x32_bf16 v[160:163], v[48:51], v[16:19], v[160:163]
    ds_read_b64_tr_b16 v[60:61], v9 offset:50272
    v_pk_mul_f32 v[72:73], v[72:73], s[40:41]
    v_pk_mul_f32 v[74:75], v[74:75], s[40:41]
    v_pk_mul_f32 v[104:105], v[104:105], s[40:41]
    v_pk_mul_f32 v[106:107], v[106:107], s[40:41]
    v_mfma_f32_16x16x32_bf16 v[164:167], v[48:51], v[20:23], v[164:167]
    ds_read_b64_tr_b16 v[62:63], v9 offset:52576
    v_exp_f32 v72, v72
    v_exp_f32 v73, v73
    v_exp_f32 v74, v74
    v_exp_f32 v75, v75
    v_mfma_f32_16x16x32_bf16 v[168:171], v[48:51], v[24:27], v[168:171]
    v_exp_f32 v104, v104
    v_exp_f32 v105, v105
    v_exp_f32 v106, v106
    v_exp_f32 v107, v107
    v_mfma_f32_16x16x32_bf16 v[172:175], v[48:51], v[28:31], v[172:175]
    v_pk_add_f32 v[72:73], v[72:73], s[42:43]
    v_pk_add_f32 v[74:75], v[74:75], s[42:43]
    v_pk_add_f32 v[104:105], v[104:105], s[42:43]
    v_pk_add_f32 v[106:107], v[106:107], s[42:43]
    s_waitcnt lgkmcnt(4)
    v_mfma_f32_16x16x32_bf16 v[160:163], v[52:55], v[32:35], v[160:163]
    ds_read_b64_tr_b16 v[48:49], v9 offset:128
    v_rcp_f32 v72, v72
    v_rcp_f32 v73, v73
    v_rcp_f32 v74, v74
    v_rcp_f32 v75, v75
    v_mfma_f32_16x16x32_bf16 v[164:167], v[52:55], v[36:39], v[164:167]
    ds_read_b64_tr_b16 v[50:51], v9 offset:2432
    v_rcp_f32 v104, v104
    v_rcp_f32 v105, v105
    v_rcp_f32 v106, v106
    v_rcp_f32 v107, v107
    v_mfma_f32_16x16x32_bf16 v[168:171], v[52:55], v[40:43], v[168:171]
    v_pk_mul_f32 v[72:73], v[72:73], v[88:89]
    v_pk_mul_f32 v[74:75], v[74:75], v[90:91]
    v_pk_mul_f32 v[104:105], v[104:105], v[120:121]
    v_pk_mul_f32 v[106:107], v[106:107], v[122:123]
    v_mfma_f32_16x16x32_bf16 v[172:175], v[52:55], v[44:47], v[172:175]
    v_cvt_pk_bf16_f32 v72, v72, v73
    v_cvt_pk_bf16_f32 v73, v74, v75
    v_cvt_pk_bf16_f32 v74, v104, v105
    v_cvt_pk_bf16_f32 v75, v106, v107
    s_waitcnt vmcnt(3)
    buffer_store_dwordx4 v[72:75], v1, s[20:23], s50 offen offset:0 sc1
    s_waitcnt lgkmcnt(4)
    v_mfma_f32_16x16x32_bf16 v[176:179], v[56:59], v[16:19], v[176:179]
    ds_read_b64_tr_b16 v[52:53], v9 offset:41088
    v_pk_mul_f32 v[76:77], v[76:77], s[40:41]
    v_pk_mul_f32 v[78:79], v[78:79], s[40:41]
    v_pk_mul_f32 v[108:109], v[108:109], s[40:41]
    v_pk_mul_f32 v[110:111], v[110:111], s[40:41]
    v_mfma_f32_16x16x32_bf16 v[180:183], v[56:59], v[20:23], v[180:183]
    ds_read_b64_tr_b16 v[54:55], v9 offset:43392
    v_exp_f32 v76, v76
    v_exp_f32 v77, v77
    v_exp_f32 v78, v78
    v_exp_f32 v79, v79
    v_mfma_f32_16x16x32_bf16 v[184:187], v[56:59], v[24:27], v[184:187]
    v_exp_f32 v108, v108
    v_exp_f32 v109, v109
    v_exp_f32 v110, v110
    v_exp_f32 v111, v111
    v_mfma_f32_16x16x32_bf16 v[188:191], v[56:59], v[28:31], v[188:191]
    v_pk_add_f32 v[76:77], v[76:77], s[42:43]
    v_pk_add_f32 v[78:79], v[78:79], s[42:43]
    v_pk_add_f32 v[108:109], v[108:109], s[42:43]
    v_pk_add_f32 v[110:111], v[110:111], s[42:43]
    s_waitcnt lgkmcnt(4)
    v_mfma_f32_16x16x32_bf16 v[176:179], v[60:63], v[32:35], v[176:179]
    ds_read_b64_tr_b16 v[56:57], v9 offset:9344
    v_rcp_f32 v76, v76
    v_rcp_f32 v77, v77
    v_rcp_f32 v78, v78
    v_rcp_f32 v79, v79
    v_mfma_f32_16x16x32_bf16 v[180:183], v[60:63], v[36:39], v[180:183]
    ds_read_b64_tr_b16 v[58:59], v9 offset:11648
    v_rcp_f32 v108, v108
    v_rcp_f32 v109, v109
    v_rcp_f32 v110, v110
    v_rcp_f32 v111, v111
    v_mfma_f32_16x16x32_bf16 v[184:187], v[60:63], v[40:43], v[184:187]
    v_pk_mul_f32 v[76:77], v[76:77], v[92:93]
    v_pk_mul_f32 v[78:79], v[78:79], v[94:95]
    v_pk_mul_f32 v[108:109], v[108:109], v[124:125]
    v_pk_mul_f32 v[110:111], v[110:111], v[126:127]
    v_mfma_f32_16x16x32_bf16 v[188:191], v[60:63], v[44:47], v[188:191]
    v_cvt_pk_bf16_f32 v76, v76, v77
    v_cvt_pk_bf16_f32 v77, v78, v79
    v_cvt_pk_bf16_f32 v78, v108, v109
    v_cvt_pk_bf16_f32 v79, v110, v111
    s_waitcnt vmcnt(3)
    buffer_store_dwordx4 v[76:79], v1, s[20:23], s51 offen offset:0 sc1
    s_waitcnt lgkmcnt(4)
    v_mfma_f32_16x16x32_bf16 v[192:195], v[48:51], v[16:19], v[192:195]
    ds_read_b64_tr_b16 v[60:61], v9 offset:50304
    v_pk_mul_f32 v[128:129], v[128:129], s[40:41]
    v_pk_mul_f32 v[130:131], v[130:131], s[40:41]
    v_pk_mul_f32 v[160:161], v[160:161], s[40:41]
    v_pk_mul_f32 v[162:163], v[162:163], s[40:41]
    v_mfma_f32_16x16x32_bf16 v[196:199], v[48:51], v[20:23], v[196:199]
    ds_read_b64_tr_b16 v[62:63], v9 offset:52608
    v_exp_f32 v128, v128
    v_exp_f32 v129, v129
    v_exp_f32 v130, v130
    v_exp_f32 v131, v131
    v_mfma_f32_16x16x32_bf16 v[200:203], v[48:51], v[24:27], v[200:203]
    v_exp_f32 v160, v160
    v_exp_f32 v161, v161
    v_exp_f32 v162, v162
    v_exp_f32 v163, v163
    v_mfma_f32_16x16x32_bf16 v[204:207], v[48:51], v[28:31], v[204:207]
    v_pk_add_f32 v[128:129], v[128:129], s[42:43]
    v_pk_add_f32 v[130:131], v[130:131], s[42:43]
    v_pk_add_f32 v[160:161], v[160:161], s[42:43]
    v_pk_add_f32 v[162:163], v[162:163], s[42:43]
    s_waitcnt lgkmcnt(4)
    v_mfma_f32_16x16x32_bf16 v[192:195], v[52:55], v[32:35], v[192:195]
    ds_read_b64_tr_b16 v[48:49], v9 offset:160
    v_rcp_f32 v128, v128
    v_rcp_f32 v129, v129
    v_rcp_f32 v130, v130
    v_rcp_f32 v131, v131
    v_mfma_f32_16x16x32_bf16 v[196:199], v[52:55], v[36:39], v[196:199]
    ds_read_b64_tr_b16 v[50:51], v9 offset:2464
    v_rcp_f32 v160, v160
    v_rcp_f32 v161, v161
    v_rcp_f32 v162, v162
    v_rcp_f32 v163, v163
    v_mfma_f32_16x16x32_bf16 v[200:203], v[52:55], v[40:43], v[200:203]
    v_pk_mul_f32 v[128:129], v[128:129], v[144:145]
    v_pk_mul_f32 v[130:131], v[130:131], v[146:147]
    v_pk_mul_f32 v[160:161], v[160:161], v[176:177]
    v_pk_mul_f32 v[162:163], v[162:163], v[178:179]
    v_mfma_f32_16x16x32_bf16 v[204:207], v[52:55], v[44:47], v[204:207]
    v_cvt_pk_bf16_f32 v128, v128, v129
    v_cvt_pk_bf16_f32 v129, v130, v131
    v_cvt_pk_bf16_f32 v130, v160, v161
    v_cvt_pk_bf16_f32 v131, v162, v163
    s_waitcnt vmcnt(3)
    buffer_store_dwordx4 v[128:131], v1, s[20:23], s48 offen offset:1024 sc1
    s_waitcnt lgkmcnt(4)
    v_mfma_f32_16x16x32_bf16 v[208:211], v[56:59], v[16:19], v[208:211]
    ds_read_b64_tr_b16 v[52:53], v9 offset:41120
    v_pk_mul_f32 v[132:133], v[132:133], s[40:41]
    v_pk_mul_f32 v[134:135], v[134:135], s[40:41]
    v_pk_mul_f32 v[164:165], v[164:165], s[40:41]
    v_pk_mul_f32 v[166:167], v[166:167], s[40:41]
    v_mfma_f32_16x16x32_bf16 v[212:215], v[56:59], v[20:23], v[212:215]
    ds_read_b64_tr_b16 v[54:55], v9 offset:43424
    v_exp_f32 v132, v132
    v_exp_f32 v133, v133
    v_exp_f32 v134, v134
    v_exp_f32 v135, v135
    v_mfma_f32_16x16x32_bf16 v[216:219], v[56:59], v[24:27], v[216:219]
    v_exp_f32 v164, v164
    v_exp_f32 v165, v165
    v_exp_f32 v166, v166
    v_exp_f32 v167, v167
    v_mfma_f32_16x16x32_bf16 v[220:223], v[56:59], v[28:31], v[220:223]
    v_pk_add_f32 v[132:133], v[132:133], s[42:43]
    v_pk_add_f32 v[134:135], v[134:135], s[42:43]
    v_pk_add_f32 v[164:165], v[164:165], s[42:43]
    v_pk_add_f32 v[166:167], v[166:167], s[42:43]
    s_waitcnt lgkmcnt(4)
    v_mfma_f32_16x16x32_bf16 v[208:211], v[60:63], v[32:35], v[208:211]
    ds_read_b64_tr_b16 v[56:57], v9 offset:9376
    v_rcp_f32 v132, v132
    v_rcp_f32 v133, v133
    v_rcp_f32 v134, v134
    v_rcp_f32 v135, v135
    v_mfma_f32_16x16x32_bf16 v[212:215], v[60:63], v[36:39], v[212:215]
    ds_read_b64_tr_b16 v[58:59], v9 offset:11680
    v_rcp_f32 v164, v164
    v_rcp_f32 v165, v165
    v_rcp_f32 v166, v166
    v_rcp_f32 v167, v167
    v_mfma_f32_16x16x32_bf16 v[216:219], v[60:63], v[40:43], v[216:219]
    v_pk_mul_f32 v[132:133], v[132:133], v[148:149]
    v_pk_mul_f32 v[134:135], v[134:135], v[150:151]
    v_pk_mul_f32 v[164:165], v[164:165], v[180:181]
    v_pk_mul_f32 v[166:167], v[166:167], v[182:183]
    v_mfma_f32_16x16x32_bf16 v[220:223], v[60:63], v[44:47], v[220:223]
    v_cvt_pk_bf16_f32 v132, v132, v133
    v_cvt_pk_bf16_f32 v133, v134, v135
    v_cvt_pk_bf16_f32 v134, v164, v165
    v_cvt_pk_bf16_f32 v135, v166, v167
    s_waitcnt vmcnt(3)
    buffer_store_dwordx4 v[132:135], v1, s[20:23], s49 offen offset:1024 sc1
    s_waitcnt lgkmcnt(4)
    v_mfma_f32_16x16x32_bf16 v[224:227], v[48:51], v[16:19], v[224:227]
    ds_read_b64_tr_b16 v[60:61], v9 offset:50336
    v_pk_mul_f32 v[136:137], v[136:137], s[40:41]
    v_pk_mul_f32 v[138:139], v[138:139], s[40:41]
    v_pk_mul_f32 v[168:169], v[168:169], s[40:41]
    v_pk_mul_f32 v[170:171], v[170:171], s[40:41]
    v_mfma_f32_16x16x32_bf16 v[228:231], v[48:51], v[20:23], v[228:231]
    ds_read_b64_tr_b16 v[62:63], v9 offset:52640
    v_exp_f32 v136, v136
    v_exp_f32 v137, v137
    v_exp_f32 v138, v138
    v_exp_f32 v139, v139
    v_mfma_f32_16x16x32_bf16 v[232:235], v[48:51], v[24:27], v[232:235]
    v_exp_f32 v168, v168
    v_exp_f32 v169, v169
    v_exp_f32 v170, v170
    v_exp_f32 v171, v171
    v_mfma_f32_16x16x32_bf16 v[236:239], v[48:51], v[28:31], v[236:239]
    v_pk_add_f32 v[136:137], v[136:137], s[42:43]
    v_pk_add_f32 v[138:139], v[138:139], s[42:43]
    v_pk_add_f32 v[168:169], v[168:169], s[42:43]
    v_pk_add_f32 v[170:171], v[170:171], s[42:43]
    s_waitcnt lgkmcnt(4)
    v_mfma_f32_16x16x32_bf16 v[224:227], v[52:55], v[32:35], v[224:227]
    v_rcp_f32 v136, v136
    v_rcp_f32 v137, v137
    v_rcp_f32 v138, v138
    v_rcp_f32 v139, v139
    v_mfma_f32_16x16x32_bf16 v[228:231], v[52:55], v[36:39], v[228:231]
    v_rcp_f32 v168, v168
    v_rcp_f32 v169, v169
    v_rcp_f32 v170, v170
    v_rcp_f32 v171, v171
    v_mfma_f32_16x16x32_bf16 v[232:235], v[52:55], v[40:43], v[232:235]
    v_pk_mul_f32 v[136:137], v[136:137], v[152:153]
    v_pk_mul_f32 v[138:139], v[138:139], v[154:155]
    v_pk_mul_f32 v[168:169], v[168:169], v[184:185]
    v_pk_mul_f32 v[170:171], v[170:171], v[186:187]
    v_mfma_f32_16x16x32_bf16 v[236:239], v[52:55], v[44:47], v[236:239]
    v_cvt_pk_bf16_f32 v136, v136, v137
    v_cvt_pk_bf16_f32 v137, v138, v139
    v_cvt_pk_bf16_f32 v138, v168, v169
    v_cvt_pk_bf16_f32 v139, v170, v171
    s_waitcnt vmcnt(3)
    buffer_store_dwordx4 v[136:139], v1, s[20:23], s50 offen offset:1024 sc1
    s_waitcnt lgkmcnt(2)
    v_mfma_f32_16x16x32_bf16 v[240:243], v[56:59], v[16:19], v[240:243]
    v_pk_mul_f32 v[140:141], v[140:141], s[40:41]
    v_pk_mul_f32 v[142:143], v[142:143], s[40:41]
    v_pk_mul_f32 v[172:173], v[172:173], s[40:41]
    v_pk_mul_f32 v[174:175], v[174:175], s[40:41]
    v_mfma_f32_16x16x32_bf16 v[244:247], v[56:59], v[20:23], v[244:247]
    v_exp_f32 v140, v140
    v_exp_f32 v141, v141
    v_exp_f32 v142, v142
    v_exp_f32 v143, v143
    v_mfma_f32_16x16x32_bf16 v[248:251], v[56:59], v[24:27], v[248:251]
    v_exp_f32 v172, v172
    v_exp_f32 v173, v173
    v_exp_f32 v174, v174
    v_exp_f32 v175, v175
    v_mfma_f32_16x16x32_bf16 v[252:255], v[56:59], v[28:31], v[252:255]
    v_pk_add_f32 v[140:141], v[140:141], s[42:43]
    v_pk_add_f32 v[142:143], v[142:143], s[42:43]
    v_pk_add_f32 v[172:173], v[172:173], s[42:43]
    v_pk_add_f32 v[174:175], v[174:175], s[42:43]
    s_waitcnt lgkmcnt(0)
    v_mfma_f32_16x16x32_bf16 v[240:243], v[60:63], v[32:35], v[240:243]
    v_rcp_f32 v140, v140
    v_rcp_f32 v141, v141
    v_rcp_f32 v142, v142
    v_rcp_f32 v143, v143
    v_mfma_f32_16x16x32_bf16 v[244:247], v[60:63], v[36:39], v[244:247]
    v_rcp_f32 v172, v172
    v_rcp_f32 v173, v173
    v_rcp_f32 v174, v174
    v_rcp_f32 v175, v175
    v_mfma_f32_16x16x32_bf16 v[248:251], v[60:63], v[40:43], v[248:251]
    v_pk_mul_f32 v[140:141], v[140:141], v[156:157]
    v_pk_mul_f32 v[142:143], v[142:143], v[158:159]
    v_pk_mul_f32 v[172:173], v[172:173], v[188:189]
    v_pk_mul_f32 v[174:175], v[174:175], v[190:191]
    v_mfma_f32_16x16x32_bf16 v[252:255], v[60:63], v[44:47], v[252:255]
    v_cvt_pk_bf16_f32 v140, v140, v141
    v_cvt_pk_bf16_f32 v141, v142, v143
    v_cvt_pk_bf16_f32 v142, v172, v173
    v_cvt_pk_bf16_f32 v143, v174, v175
    s_waitcnt vmcnt(3)
    buffer_store_dwordx4 v[140:143], v1, s[20:23], s51 offen offset:1024 sc1
    v_mov_b32 v84, 1
    ds_write_b32 v10, v84
    s_load_dwordx2 s[12:13], s[0:1], 0
    s_load_dwordx2 s[8:9], s[0:1], 56
    v_pk_mul_f32 v[192:193], v[192:193], s[40:41]
    v_pk_mul_f32 v[194:195], v[194:195], s[40:41]
    v_pk_mul_f32 v[224:225], v[224:225], s[40:41]
    v_pk_mul_f32 v[226:227], v[226:227], s[40:41]
    v_exp_f32 v192, v192
    v_exp_f32 v193, v193
    v_exp_f32 v194, v194
    v_exp_f32 v195, v195
    v_exp_f32 v224, v224
    v_exp_f32 v225, v225
    v_exp_f32 v226, v226
    v_exp_f32 v227, v227
    v_pk_add_f32 v[192:193], v[192:193], s[42:43]
    v_pk_add_f32 v[194:195], v[194:195], s[42:43]
    v_pk_add_f32 v[224:225], v[224:225], s[42:43]
    v_pk_add_f32 v[226:227], v[226:227], s[42:43]
    v_rcp_f32 v192, v192
    v_rcp_f32 v193, v193
    v_rcp_f32 v194, v194
    v_rcp_f32 v195, v195
    v_rcp_f32 v224, v224
    v_rcp_f32 v225, v225
    v_rcp_f32 v226, v226
    v_rcp_f32 v227, v227
    v_pk_mul_f32 v[192:193], v[192:193], v[208:209]
    v_pk_mul_f32 v[194:195], v[194:195], v[210:211]
    v_pk_mul_f32 v[224:225], v[224:225], v[240:241]
    v_pk_mul_f32 v[226:227], v[226:227], v[242:243]
    v_cvt_pk_bf16_f32 v192, v192, v193
    v_cvt_pk_bf16_f32 v193, v194, v195
    v_cvt_pk_bf16_f32 v194, v224, v225
    v_cvt_pk_bf16_f32 v195, v226, v227
    s_waitcnt vmcnt(3)
    buffer_store_dwordx4 v[192:195], v1, s[20:23], s48 offen offset:2048 sc1
    s_mov_b32 s100, 1600000
    v_mov_b32 v88, 162832
L_parall_lw_2:
    ds_read_b128 v[84:87], v88
    s_waitcnt lgkmcnt(0)
    v_min3_u32 v84, v84, v85, v86
    v_min_u32 v84, v84, v87
    s_nop 0
    v_readfirstlane_b32 s101, v84
    s_cmp_ge_u32 s101, 1
    s_cbranch_scc1 L_parall_lw_2_ok
    s_sleep 1
    s_sub_u32 s100, s100, 1
    s_cbranch_scc0 L_parall_lw_2
L_parall_lw_2_ok:
    s_mov_b32 s100, 1600000
    v_mov_b32 v88, 162816
L_parall_lw_3:
    ds_read_b128 v[84:87], v88
    s_waitcnt lgkmcnt(0)
    v_min3_u32 v84, v84, v85, v86
    v_min_u32 v84, v84, v87
    s_nop 0
    v_readfirstlane_b32 s101, v84
    s_cmp_ge_u32 s101, 2
    s_cbranch_scc1 L_parall_lw_3_ok
    s_sleep 1
    s_sub_u32 s100, s100, 1
    s_cbranch_scc0 L_parall_lw_3
L_parall_lw_3_ok:
    ds_read_b64_tr_b16 v[16:17], v7 offset:0
    ds_read_b64_tr_b16 v[18:19], v7 offset:18432
    ds_read_b64_tr_b16 v[20:21], v7 offset:32
    ds_read_b64_tr_b16 v[22:23], v7 offset:18464
    ds_read_b64_tr_b16 v[24:25], v7 offset:64
    ds_read_b64_tr_b16 v[26:27], v7 offset:18496
    ds_read_b64_tr_b16 v[28:29], v7 offset:96
    ds_read_b64_tr_b16 v[30:31], v7 offset:18528
    ds_read_b64_tr_b16 v[32:33], v7 offset:128
    ds_read_b64_tr_b16 v[34:35], v7 offset:18560
    ds_read_b64_tr_b16 v[36:37], v7 offset:160
    ds_read_b64_tr_b16 v[38:39], v7 offset:18592
    s_waitcnt lgkmcnt(4)
    ds_read_b64_tr_b16 v[40:41], v7 offset:192
    ds_read_b64_tr_b16 v[42:43], v7 offset:18624
    ds_read_b64_tr_b16 v[44:45], v7 offset:224
    ds_read_b64_tr_b16 v[46:47], v7 offset:18656
    ds_read_b64_tr_b16 v[48:49], v8 offset:0
    ds_read_b64_tr_b16 v[50:51], v8 offset:18432
    v_pk_mul_f32 v[196:197], v[196:197], s[40:41]
    v_pk_mul_f32 v[198:199], v[198:199], s[40:41]
    v_pk_mul_f32 v[228:229], v[228:229], s[40:41]
    v_pk_mul_f32 v[230:231], v[230:231], s[40:41]
    v_exp_f32 v196, v196
    v_exp_f32 v197, v197
    v_exp_f32 v198, v198
    v_exp_f32 v199, v199
    v_exp_f32 v228, v228
    v_exp_f32 v229, v229
    v_exp_f32 v230, v230
    v_exp_f32 v231, v231
    v_pk_add_f32 v[196:197], v[196:197], s[42:43]
    v_pk_add_f32 v[198:199], v[198:199], s[42:43]
    v_pk_add_f32 v[228:229], v[228:229], s[42:43]
    v_pk_add_f32 v[230:231], v[230:231], s[42:43]
    v_rcp_f32 v196, v196
    v_rcp_f32 v197, v197
    v_rcp_f32 v198, v198
    v_rcp_f32 v199, v199
    v_rcp_f32 v228, v228
    v_rcp_f32 v229, v229
    v_rcp_f32 v230, v230
    v_rcp_f32 v231, v231
    v_pk_mul_f32 v[196:197], v[196:197], v[212:213]
    v_pk_mul_f32 v[198:199], v[198:199], v[214:215]
    v_pk_mul_f32 v[228:229], v[228:229], v[244:245]
    v_pk_mul_f32 v[230:231], v[230:231], v[246:247]
    v_cvt_pk_bf16_f32 v196, v196, v197
    v_cvt_pk_bf16_f32 v197, v198, v199
    v_cvt_pk_bf16_f32 v198, v228, v229
    v_cvt_pk_bf16_f32 v199, v230, v231
    s_waitcnt vmcnt(3)
    buffer_store_dwordx4 v[196:199], v1, s[20:23], s49 offen offset:2048 sc1
    s_waitcnt lgkmcnt(0)
    buffer_load_dword v3, v4, s[20:23], s52 offen sc0 sc1
    v_pk_mul_f32 v[200:201], v[200:201], s[40:41]
    v_pk_mul_f32 v[202:203], v[202:203], s[40:41]
    v_pk_mul_f32 v[232:233], v[232:233], s[40:41]
    v_pk_mul_f32 v[234:235], v[234:235], s[40:41]
    v_exp_f32 v200, v200
    v_exp_f32 v201, v201
    v_exp_f32 v202, v202
    v_exp_f32 v203, v203
    v_exp_f32 v232, v232
    v_exp_f32 v233, v233
    v_exp_f32 v234, v234
    v_exp_f32 v235, v235
    v_pk_add_f32 v[200:201], v[200:201], s[42:43]
    v_pk_add_f32 v[202:203], v[202:203], s[42:43]
    v_pk_add_f32 v[232:233], v[232:233], s[42:43]
    v_pk_add_f32 v[234:235], v[234:235], s[42:43]
    v_rcp_f32 v200, v200
    v_rcp_f32 v201, v201
    v_rcp_f32 v202, v202
    v_rcp_f32 v203, v203
    v_rcp_f32 v232, v232
    v_rcp_f32 v233, v233
    v_rcp_f32 v234, v234
    v_rcp_f32 v235, v235
    v_pk_mul_f32 v[200:201], v[200:201], v[216:217]
    v_pk_mul_f32 v[202:203], v[202:203], v[218:219]
    v_pk_mul_f32 v[232:233], v[232:233], v[248:249]
    v_pk_mul_f32 v[234:235], v[234:235], v[250:251]
    v_cvt_pk_bf16_f32 v200, v200, v201
    v_cvt_pk_bf16_f32 v201, v202, v203
    v_cvt_pk_bf16_f32 v202, v232, v233
    v_cvt_pk_bf16_f32 v203, v234, v235
    s_waitcnt vmcnt(3)
    buffer_store_dwordx4 v[16:19], v1, s[20:23], s61 offen offset:0 sc1
    v_pk_mul_f32 v[204:205], v[204:205], s[40:41]
    v_pk_mul_f32 v[206:207], v[206:207], s[40:41]
    v_pk_mul_f32 v[236:237], v[236:237], s[40:41]
    v_pk_mul_f32 v[238:239], v[238:239], s[40:41]
    v_exp_f32 v204, v204
    v_exp_f32 v205, v205
    v_exp_f32 v206, v206
    v_exp_f32 v207, v207
    v_exp_f32 v236, v236
    v_exp_f32 v237, v237
    v_exp_f32 v238, v238
    v_exp_f32 v239, v239
    v_pk_add_f32 v[204:205], v[204:205], s[42:43]
    v_pk_add_f32 v[206:207], v[206:207], s[42:43]
    v_pk_add_f32 v[236:237], v[236:237], s[42:43]
    v_pk_add_f32 v[238:239], v[238:239], s[42:43]
    v_rcp_f32 v204, v204
    v_rcp_f32 v205, v205
    v_rcp_f32 v206, v206
    v_rcp_f32 v207, v207
    v_rcp_f32 v236, v236
    v_rcp_f32 v237, v237
    v_rcp_f32 v238, v238
    v_rcp_f32 v239, v239
    v_pk_mul_f32 v[204:205], v[204:205], v[220:221]
    v_pk_mul_f32 v[206:207], v[206:207], v[222:223]
    v_pk_mul_f32 v[236:237], v[236:237], v[252:253]
    v_pk_mul_f32 v[238:239], v[238:239], v[254:255]
    v_cvt_pk_bf16_f32 v204, v204, v205
    v_cvt_pk_bf16_f32 v205, v206, v207
    v_cvt_pk_bf16_f32 v206, v236, v237
    v_cvt_pk_bf16_f32 v207, v238, v239
    s_waitcnt vmcnt(3)
    buffer_store_dwordx4 v[20:23], v1, s[20:23], s61 offen offset:1024 sc1
    s_waitcnt vmcnt(2)
    s_cmp_lg_u32 s53, 0
    s_cbranch_scc1 L_a_kv12_done
    s_mov_b32 s100, 100000
L_a_kv12:
    v_cmp_eq_u32 vcc, s99, v3
    s_nop 3
    s_and_b64 s[56:57], vcc, s[54:55]
    s_cmp_eq_u64 s[56:57], s[54:55]
    s_cbranch_scc1 L_a_kv12_ok
    s_sub_u32 s100, s100, 1
    s_cbranch_scc1 L_a_kv12_ok
    s_sleep 2
    buffer_load_dword v3, v4, s[20:23], s52 offen sc0 sc1
    s_waitcnt vmcnt(0)
    s_branch L_a_kv12
L_a_kv12_ok:
    s_add_u32 s27, s27, 1
    s_and_b32 s27, s27, 7
    s_mul_i32 s30, s27, 20480
    s_add_u32 s30, s30, s28
    s_add_u32 m0, s29, 40960
    s_add_u32 s3, s30, 4096
    buffer_load_dwordx4 v1, s[20:23], s30 offen offset:0 sc1 lds
    buffer_load_dwordx4 v1, s[20:23], s30 offen offset:1024 sc1 lds
    buffer_load_dwordx4 v1, s[20:23], s30 offen offset:2048 sc1 lds
    buffer_load_dwordx4 v1, s[20:23], s30 offen offset:3072 sc1 lds
    s_add_u32 m0, m0, 4096
    s_nop 0
    buffer_load_dwordx4 v1, s[20:23], s3 offen sc1 lds
    s_add_u32 s27, s27, 1
    s_and_b32 s27, s27, 7
    s_mul_i32 s30, s27, 20480
    s_add_u32 s30, s30, s28
    s_add_u32 m0, s29, 61440
    s_add_u32 s3, s30, 4096
    buffer_load_dwordx4 v1, s[20:23], s30 offen offset:0 sc1 lds
    buffer_load_dwordx4 v1, s[20:23], s30 offen offset:1024 sc1 lds
    buffer_load_dwordx4 v1, s[20:23], s30 offen offset:2048 sc1 lds
    buffer_load_dwordx4 v1, s[20:23], s30 offen offset:3072 sc1 lds
    s_add_u32 m0, m0, 4096
    s_nop 0
    buffer_load_dwordx4 v1, s[20:23], s3 offen sc1 lds
    s_waitcnt vmcnt(0)
    v_mov_b32 v54, 2
    ds_write_b32 v10, v54
    s_mov_b32 s53, 1
L_a_kv12_done:
    buffer_store_dwordx4 v[24:27], v1, s[20:23], s61 offen offset:2048 sc1
    buffer_store_dwordx4 v[28:31], v1, s[20:23], s61 offen offset:3072 sc1
    s_waitcnt vmcnt(3)
    buffer_store_dwordx4 v[32:35], v1, s[20:23], s62 offen offset:0 sc1
    s_waitcnt vmcnt(3)
    buffer_store_dwordx4 v[36:39], v1, s[20:23], s62 offen offset:1024 sc1
    s_waitcnt vmcnt(3)
    buffer_store_dwordx4 v[40:43], v1, s[20:23], s62 offen offset:2048 sc1
    s_waitcnt vmcnt(3)
    buffer_store_dwordx4 v[44:47], v1, s[20:23], s62 offen offset:3072 sc1
    s_waitcnt vmcnt(3)
    buffer_store_dwordx4 v[48:51], v1, s[20:23], s63 offen offset:0 sc1
    s_waitcnt vmcnt(3)
    buffer_store_dwordx4 v[200:203], v1, s[20:23], s50 offen offset:2048 sc1
    s_waitcnt vmcnt(3)
    buffer_store_dwordx4 v[204:207], v1, s[20:23], s51 offen offset:2048 sc1
    s_waitcnt vmcnt(2)
    buffer_store_dword v14, v13, s[20:23], s64 offen offset:0 sc0 sc1
    s_and_b32 s56, s2, 1
    s_bfe_u32 s57, s2, 0x20003
    s_bfe_u32 s58, s2, 0x20001
    s_lshl_b32 s58, s58, 3
    s_lshr_b32 s3, s2, 5
    s_add_u32 s58, s58, s3
    s_mul_i32 s59, s31, 36
    s_mul_i32 s44, s59, 36864
    s_mul_i32 s48, s57, 9216
    s_add_u32 s44, s44, s48
    s_add_u32 s44, s44, 40370176
    s_add_u32 s46, s44, 8192
    s_lshl_b32 s3, s56, 12
    s_sub_u32 s45, s44, s3
    s_add_u32 s45, s45, 4096
    s_add_u32 s44, s44, s3
    s_add_u32 s48, s48, 45678592
    s_mul_i32 s32, s58, 589824
    s_lshl_b32 s3, s59, 10
    s_add_u32 s32, s32, s3
    s_add_u32 s32, s32, 9699328
    s_mul_i32 s3, s56, 294912
    s_sub_u32 s34, s32, s3
    s_add_u32 s34, s34, 294912
    s_add_u32 s32, s32, s3
    s_add_u32 s33, s32, 147456
    s_add_u32 s35, s34, 147456
    s_lshl_b32 s54, s58, 8
    s_lshl_b32 s3, s31, 6
    s_add_u32 s54, s54, s3
    s_add_u32 s54, s54, 49295360
    s_and_b32 s3, s57, 0
    s_mul_i32 s3, s3, 41216
    s_add_u32 s54, s54, s3
    s_lshl_b32 s55, s57, 10
    s_add_u32 s41, s55, 49304128
    s_lshl_b32 s3, s59, 2
    s_add_u32 s55, s55, s3
    s_add_u32 s55, s55, 49303488
    v_add_u32 v3, s54, v2
    v_add_u32 v5, s55, v2
    v_cmp_gt_u32 vcc, 16, v0
    v_cmp_gt_u32 s[60:61], 52, v0
    s_nop 0
    v_cndmask_b32 v3, v5, v3, vcc
    v_cndmask_b32 v3, v15, v3, s[60:61]
    s_mul_i32 s40, s31, 27648
    s_add_u32 s40, s40, 40960
    v_add_u32 v5, s40, v1
    s_lshl_b32 s50, s58, 2
    s_add_u32 s50, s50, s57
    s_lshl_b32 s50, s50, 1
    s_add_u32 s49, s50, s56
    s_xor_b32 s3, s56, 1
    s_add_u32 s50, s50, s3
    s_lshl_b32 s51, s49, 4
    s_lshl_b32 s3, s31, 2
    s_add_u32 s51, s51, s3
    s_add_u32 s51, s51, 49307648
    s_lshl_b32 s47, s50, 4
    s_add_u32 s47, s47, 49307648
    s_mul_i32 s42, s49, 20480
    s_add_u32 s42, s42, s29
    s_add_u32 s42, s42, 30932992
    s_add_u32 s43, s42, 4096
    s_mul_i32 s52, s50, 20480
    s_add_u32 s52, s52, 30932992
    s_xor_b32 s3, s31, 2
    s_lshl_b32 s53, s3, 2
    s_add_u32 s47, s47, s53
    s_mul_i32 s3, s3, 5120
    s_add_u32 s52, s52, s3
    s_add_u32 s53, s52, 4096
    s_lshl_b32 s3, s56, 1
    s_xor_b32 s60, s31, s3
    s_lshl_b32 s3, s58, 2
    s_add_u32 s60, s60, s3
    v_and_b32 v6, 15, v0
    v_mul_u32_u24 v9, 1152, v6
    v_lshrrev_b32 v6, 4, v0
    v_lshl_add_u32 v9, v6, 3, v9
    s_mul_i32 s62, s60, 18432
    s_lshl_b32 s3, s57, 5
    s_add_u32 s64, s62, s3
    s_add_u32 s64, s64, 1024
    s_lshl_b32 s3, s57, 8
    s_add_u32 s62, s62, s3
    s_lshl_b32 s3, s56, 7
    s_add_u32 s62, s62, s3
    s_cmp_lt_u32 s31, 2
    s_cselect_b32 s64, s64, 0x7fff0000
    s_lshr_b32 s54, s60, 1
    s_lshl_b32 s54, s54, 7
    s_add_u32 s54, s54, 49311744
    s_mul_i32 s55, s60, 18432
    s_add_u32 s55, s55, 28573696
    s_lshl_b32 s65, s25, 7
    s_add_u32 s65, s65, 49291264
    s_and_b32 s3, s26, 0
    s_mul_i32 s3, s3, 41216
    s_add_u32 s65, s65, s3
    s_waitcnt lgkmcnt(0)
    s_and_b32 s9, s9, 0xffff
    s_mov_b32 s10, 2359296
    s_mov_b32 s11, 0x20000
    s_mov_b32 s16, s12
    s_and_b32 s17, s13, 0xffff
    s_mov_b32 s18, 2359296
    s_mov_b32 s19, 0x20000
    s_sub_u32 s3, s31, 1
    s_and_b32 s3, s3, 3
    s_mul_i32 s3, s3, 27648
    s_add_u32 s3, s3, 40960
    v_add_u32 v6, s3, v1
    s_sub_u32 s3, s31, 2
    s_and_b32 s3, s3, 3
    s_mul_i32 s3, s3, 27648
    s_add_u32 s3, s3, 50176
    v_add_u32 v7, s3, v1
    s_sub_u32 s3, s31, 3
    s_and_b32 s3, s3, 3
    s_mul_i32 s3, s3, 27648
    s_add_u32 s3, s3, 59392
    v_add_u32 v8, s3, v1
    s_waitcnt vmcnt(1)
    buffer_store_dword v14, v13, s[20:23], s39 offen offset:0 sc0 sc1
    s_mov_b32 s100, 100000
L_parall_poll_4:
    buffer_load_dword v84, v4, s[20:23], s65 offen sc0 sc1
    s_waitcnt vmcnt(0)
    v_cmp_eq_u32 vcc, s99, v84
    s_nop 3
    s_bcnt1_i32_b64 s101, vcc
    s_cmp_eq_u32 s101, 32
    s_cbranch_scc1 L_parall_poll_4_ok
    s_sub_u32 s100, s100, 1
    s_cbranch_scc1 L_parall_poll_4_ok
    s_sleep 8
    s_branch L_parall_poll_4
L_parall_poll_4_ok:
    s_mov_b32 s100, 1600000
    v_mov_b32 v88, 162832
L_parall_lw_5:
    ds_read_b128 v[84:87], v88
    s_waitcnt lgkmcnt(0)
    v_min3_u32 v84, v84, v85, v86
    v_min_u32 v84, v84, v87
    s_nop 0
    v_readfirstlane_b32 s101, v84
    s_cmp_ge_u32 s101, 2
    s_cbranch_scc1 L_parall_lw_5_ok
    s_sleep 1
    s_sub_u32 s100, s100, 1
    s_cbranch_scc0 L_parall_lw_5
L_parall_lw_5_ok:
    s_add_u32 s27, s27, 1
    s_and_b32 s27, s27, 7
    s_mul_i32 s30, s27, 20480
    s_add_u32 s30, s30, s28
    s_add_u32 m0, s29, 81920
    s_add_u32 s3, s30, 4096
    buffer_load_dwordx4 v1, s[20:23], s30 offen offset:0 sc1 lds
    buffer_load_dwordx4 v1, s[20:23], s30 offen offset:1024 sc1 lds
    buffer_load_dwordx4 v1, s[20:23], s30 offen offset:2048 sc1 lds
    buffer_load_dwordx4 v1, s[20:23], s30 offen offset:3072 sc1 lds
    s_add_u32 m0, m0, 4096
    s_nop 0
    buffer_load_dwordx4 v1, s[20:23], s3 offen sc1 lds
    s_add_u32 s27, s27, 1
    s_and_b32 s27, s27, 7
    s_mul_i32 s30, s27, 20480
    s_add_u32 s30, s30, s28
    s_add_u32 m0, s29, 102400
    s_add_u32 s3, s30, 4096
    buffer_load_dwordx4 v1, s[20:23], s30 offen offset:0 sc1 lds
    buffer_load_dwordx4 v1, s[20:23], s30 offen offset:1024 sc1 lds
    buffer_load_dwordx4 v1, s[20:23], s30 offen offset:2048 sc1 lds
    buffer_load_dwordx4 v1, s[20:23], s30 offen offset:3072 sc1 lds
    s_add_u32 m0, m0, 4096
    s_nop 0
    buffer_load_dwordx4 v1, s[20:23], s3 offen sc1 lds
    s_mov_b32 s65, 0xffff0000
    buffer_load_dwordx2 v[100:101], v9, s[16:19], s62 offen offset:0
    buffer_load_dwordx2 v[102:103], v9, s[16:19], s62 offen offset:32
    buffer_load_dwordx2 v[104:105], v9, s[16:19], s62 offen offset:64
    buffer_load_dwordx2 v[106:107], v9, s[16:19], s62 offen offset:96
    buffer_load_dwordx2 v[108:109], v9, s[16:19], s64 offen
    s_waitcnt vmcnt(5)
    v_mov_b32 v84, 4
    ds_write_b32 v10, v84
    s_mov_b32 s3, -1
    s_lshl_b32 s3, s3, 1
    s_sub_u32 s67, 18, s3
    s_sub_u32 s63, 36, s67
    s_cmp_eq_u32 s56, 0
    s_cselect_b32 s63, s67, s63
    s_cselect_b32 s66, 0, s67
    s_mul_i32 s3, s66, 36864
    s_add_u32 s44, s44, s3
    s_add_u32 s45, s45, s3
    s_add_u32 s46, s46, s3
    s_lshl_b32 s3, s66, 10
    s_add_u32 s32, s32, s3
    s_add_u32 s33, s33, s3
    s_add_u32 s34, s34, s3
    s_add_u32 s35, s35, s3
    s_mul_i32 s61, s66, 57
    s_lshr_b32 s61, s61, 9
    s_lshl_b32 s61, s61, 2
    s_add_u32 s3, s66, s63
    s_add_u32 s3, s3, 8
    s_mul_i32 s3, s3, 57
    s_lshr_b32 s3, s3, 9
    s_lshl_b32 s3, s3, 2
    v_cmp_gt_u32 vcc, s61, v0
    v_cmp_le_u32 s[6:7], s3, v0
    s_sub_u32 s61, s3, s61
    s_add_u32 s61, s61, 36
    s_and_b32 s6, s6, 0xffff
    s_mov_b32 s7, 0
    s_or_b64 vcc, vcc, s[6:7]
    v_cndmask_b32 v3, v3, v15, vcc
    s_sub_u32 s63, s63, 8
    s_lshr_b32 s63, s63, 1
    s_mov_b32 s100, 100000
L_parall_poll_6:
    s_sleep 14
    buffer_load_dword v84, v3, s[20:23], 0 offen sc0 sc1
    s_waitcnt vmcnt(0)
    v_cmp_eq_u32 vcc, s99, v84
    s_nop 3
    s_bcnt1_i32_b64 s101, vcc
    s_cmp_eq_u32 s101, s61
    s_cbranch_scc1 L_parall_poll_6_ok
    s_sub_u32 s100, s100, 1
    s_cbranch_scc1 L_parall_poll_6_ok
    s_branch L_parall_poll_6
L_parall_poll_6_ok:
    buffer_load_dwordx4 v[52:55], v1, s[20:23], s32 offen offset:0 sc1
    buffer_load_dwordx4 v[56:59], v1, s[20:23], s33 offen offset:0 sc1
    buffer_load_dwordx4 v[60:63], v1, s[20:23], s34 offen offset:0 sc1
    buffer_load_dwordx4 v[64:67], v1, s[20:23], s35 offen offset:0 sc1
    buffer_load_dwordx4 v[16:19], v1, s[20:23], s44 offen offset:0 sc1
    buffer_load_dwordx4 v[20:23], v1, s[20:23], s44 offen offset:1024 sc1
    buffer_load_dwordx4 v[24:27], v1, s[20:23], s44 offen offset:2048 sc1
    buffer_load_dwordx4 v[28:31], v1, s[20:23], s44 offen offset:3072 sc1
    s_add_u32 s44, s44, 36864
    buffer_load_dwordx4 v[32:35], v1, s[20:23], s45 offen offset:0 sc1
    buffer_load_dwordx4 v[36:39], v1, s[20:23], s45 offen offset:1024 sc1
    buffer_load_dwordx4 v[40:43], v1, s[20:23], s45 offen offset:2048 sc1
    buffer_load_dwordx4 v[44:47], v1, s[20:23], s45 offen offset:3072 sc1
    s_add_u32 s45, s45, 36864
    buffer_load_dwordx4 v[48:51], v1, s[20:23], s46 offen offset:0 sc1
    s_add_u32 s46, s46, 36864
    buffer_load_dwordx4 v[68:71], v1, s[20:23], s32 offen offset:1024 sc1
    buffer_load_dwordx4 v[72:75], v1, s[20:23], s33 offen offset:1024 sc1
    buffer_load_dwordx4 v[76:79], v1, s[20:23], s34 offen offset:1024 sc1
    buffer_load_dwordx4 v[80:83], v1, s[20:23], s35 offen offset:1024 sc1
    s_add_u32 s32, s32, 2048
    s_add_u32 s33, s33, 2048
    s_add_u32 s34, s34, 2048
    s_add_u32 s35, s35, 2048
    s_waitcnt vmcnt(12)
    v_mfma_f32_16x16x32_bf16 v[112:115], v[16:19], v[52:55], 0
    v_mfma_f32_16x16x32_bf16 v[148:151], v[16:19], v[56:59], 0
    v_mfma_f32_16x16x32_bf16 v[184:187], v[16:19], v[60:63], 0
    v_mfma_f32_16x16x32_bf16 v[220:223], v[16:19], v[64:67], 0
    buffer_load_dwordx4 v[16:19], v1, s[20:23], s44 offen offset:0 sc1
    s_waitcnt vmcnt(12)
    v_mfma_f32_16x16x32_bf16 v[224:227], v[20:23], v[64:67], 0
    v_mfma_f32_16x16x32_bf16 v[188:191], v[20:23], v[60:63], 0
    v_mfma_f32_16x16x32_bf16 v[152:155], v[20:23], v[56:59], 0
    v_mfma_f32_16x16x32_bf16 v[116:119], v[20:23], v[52:55], 0
    buffer_load_dwordx4 v[20:23], v1, s[20:23], s44 offen offset:1024 sc1
    s_waitcnt vmcnt(12)
    v_mfma_f32_16x16x32_bf16 v[120:123], v[24:27], v[52:55], 0
    v_mfma_f32_16x16x32_bf16 v[156:159], v[24:27], v[56:59], 0
    v_mfma_f32_16x16x32_bf16 v[192:195], v[24:27], v[60:63], 0
    v_mfma_f32_16x16x32_bf16 v[228:231], v[24:27], v[64:67], 0
    buffer_load_dwordx4 v[24:27], v1, s[20:23], s44 offen offset:2048 sc1
    s_waitcnt vmcnt(12)
    v_mfma_f32_16x16x32_bf16 v[232:235], v[28:31], v[64:67], 0
    v_mfma_f32_16x16x32_bf16 v[196:199], v[28:31], v[60:63], 0
    v_mfma_f32_16x16x32_bf16 v[160:163], v[28:31], v[56:59], 0
    v_mfma_f32_16x16x32_bf16 v[124:127], v[28:31], v[52:55], 0
    buffer_load_dwordx4 v[28:31], v1, s[20:23], s44 offen offset:3072 sc1
    s_add_u32 s44, s44, 36864
    s_waitcnt vmcnt(12)
    v_mfma_f32_16x16x32_bf16 v[128:131], v[32:35], v[52:55], 0
    v_mfma_f32_16x16x32_bf16 v[164:167], v[32:35], v[56:59], 0
    v_mfma_f32_16x16x32_bf16 v[200:203], v[32:35], v[60:63], 0
    v_mfma_f32_16x16x32_bf16 v[236:239], v[32:35], v[64:67], 0
    buffer_load_dwordx4 v[32:35], v1, s[20:23], s45 offen offset:0 sc1
    s_waitcnt vmcnt(12)
    v_mfma_f32_16x16x32_bf16 v[240:243], v[36:39], v[64:67], 0
    v_mfma_f32_16x16x32_bf16 v[204:207], v[36:39], v[60:63], 0
    v_mfma_f32_16x16x32_bf16 v[168:171], v[36:39], v[56:59], 0
    v_mfma_f32_16x16x32_bf16 v[132:135], v[36:39], v[52:55], 0
    buffer_load_dwordx4 v[36:39], v1, s[20:23], s45 offen offset:1024 sc1
    s_waitcnt vmcnt(12)
    v_mfma_f32_16x16x32_bf16 v[136:139], v[40:43], v[52:55], 0
    v_mfma_f32_16x16x32_bf16 v[172:175], v[40:43], v[56:59], 0
    v_mfma_f32_16x16x32_bf16 v[208:211], v[40:43], v[60:63], 0
    v_mfma_f32_16x16x32_bf16 v[244:247], v[40:43], v[64:67], 0
    buffer_load_dwordx4 v[40:43], v1, s[20:23], s45 offen offset:2048 sc1
    s_waitcnt vmcnt(12)
    v_mfma_f32_16x16x32_bf16 v[248:251], v[44:47], v[64:67], 0
    v_mfma_f32_16x16x32_bf16 v[212:215], v[44:47], v[60:63], 0
    v_mfma_f32_16x16x32_bf16 v[176:179], v[44:47], v[56:59], 0
    v_mfma_f32_16x16x32_bf16 v[140:143], v[44:47], v[52:55], 0
    buffer_load_dwordx4 v[44:47], v1, s[20:23], s45 offen offset:3072 sc1
    s_add_u32 s45, s45, 36864
    s_waitcnt vmcnt(12)
    v_mfma_f32_16x16x32_bf16 v[144:147], v[48:51], v[52:55], 0
    v_mfma_f32_16x16x32_bf16 v[180:183], v[48:51], v[56:59], 0
    v_mfma_f32_16x16x32_bf16 v[216:219], v[48:51], v[60:63], 0
    v_mfma_f32_16x16x32_bf16 v[252:255], v[48:51], v[64:67], 0
    buffer_load_dwordx4 v[48:51], v1, s[20:23], s46 offen offset:0 sc1
    s_add_u32 s46, s46, 36864
    buffer_load_dwordx4 v[52:55], v1, s[20:23], s32 offen offset:0 sc1
    buffer_load_dwordx4 v[56:59], v1, s[20:23], s33 offen offset:0 sc1
    buffer_load_dwordx4 v[60:63], v1, s[20:23], s34 offen offset:0 sc1
    buffer_load_dwordx4 v[64:67], v1, s[20:23], s35 offen offset:0 sc1
    s_mov_b32 s100, 1600000
    v_mov_b32 v88, 162816
L_parall_lw_7:
    ds_read_b128 v[84:87], v88
    s_waitcnt lgkmcnt(0)
    v_min3_u32 v84, v84, v85, v86
    v_min_u32 v84, v84, v87
    s_nop 0
    v_readfirstlane_b32 s101, v84
    s_cmp_ge_u32 s101, 3
    s_cbranch_scc1 L_parall_lw_7_ok
    s_sleep 1
    s_sub_u32 s100, s100, 1
    s_cbranch_scc0 L_parall_lw_7
L_parall_lw_7_ok:
    s_add_u32 s27, s27, 1
    s_and_b32 s27, s27, 7
    s_mul_i32 s30, s27, 20480
    s_add_u32 s30, s30, s28
    s_add_u32 m0, s29, 122880
    s_add_u32 s3, s30, 4096
    buffer_load_dwordx4 v1, s[20:23], s30 offen offset:0 sc1 lds
    buffer_load_dwordx4 v1, s[20:23], s30 offen offset:1024 sc1 lds
    buffer_load_dwordx4 v1, s[20:23], s30 offen offset:2048 sc1 lds
    buffer_load_dwordx4 v1, s[20:23], s30 offen offset:3072 sc1 lds
    s_add_u32 m0, m0, 4096
    s_nop 0
    buffer_load_dwordx4 v1, s[20:23], s3 offen sc1 lds
    s_waitcnt vmcnt(17)
    v_mfma_f32_16x16x32_bf16 v[112:115], v[16:19], v[68:71], v[112:115]
    v_mfma_f32_16x16x32_bf16 v[148:151], v[16:19], v[72:75], v[148:151]
    v_mfma_f32_16x16x32_bf16 v[184:187], v[16:19], v[76:79], v[184:187]
    v_mfma_f32_16x16x32_bf16 v[220:223], v[16:19], v[80:83], v[220:223]
    buffer_load_dwordx4 v[16:19], v1, s[20:23], s44 offen offset:0 sc1
    s_waitcnt vmcnt(17)
    v_mfma_f32_16x16x32_bf16 v[224:227], v[20:23], v[80:83], v[224:227]
    v_mfma_f32_16x16x32_bf16 v[188:191], v[20:23], v[76:79], v[188:191]
    v_mfma_f32_16x16x32_bf16 v[152:155], v[20:23], v[72:75], v[152:155]
    v_mfma_f32_16x16x32_bf16 v[116:119], v[20:23], v[68:71], v[116:119]
    buffer_load_dwordx4 v[20:23], v1, s[20:23], s44 offen offset:1024 sc1
    s_waitcnt vmcnt(17)
    v_mfma_f32_16x16x32_bf16 v[120:123], v[24:27], v[68:71], v[120:123]
    v_mfma_f32_16x16x32_bf16 v[156:159], v[24:27], v[72:75], v[156:159]
    v_mfma_f32_16x16x32_bf16 v[192:195], v[24:27], v[76:79], v[192:195]
    v_mfma_f32_16x16x32_bf16 v[228:231], v[24:27], v[80:83], v[228:231]
    buffer_load_dwordx4 v[24:27], v1, s[20:23], s44 offen offset:2048 sc1
    s_waitcnt vmcnt(17)
    v_mfma_f32_16x16x32_bf16 v[232:235], v[28:31], v[80:83], v[232:235]
    v_mfma_f32_16x16x32_bf16 v[196:199], v[28:31], v[76:79], v[196:199]
    v_mfma_f32_16x16x32_bf16 v[160:163], v[28:31], v[72:75], v[160:163]
    v_mfma_f32_16x16x32_bf16 v[124:127], v[28:31], v[68:71], v[124:127]
    buffer_load_dwordx4 v[28:31], v1, s[20:23], s44 offen offset:3072 sc1
    s_add_u32 s44, s44, 36864
    s_waitcnt vmcnt(17)
    v_mfma_f32_16x16x32_bf16 v[128:131], v[32:35], v[68:71], v[128:131]
    v_mfma_f32_16x16x32_bf16 v[164:167], v[32:35], v[72:75], v[164:167]
    v_mfma_f32_16x16x32_bf16 v[200:203], v[32:35], v[76:79], v[200:203]
    v_mfma_f32_16x16x32_bf16 v[236:239], v[32:35], v[80:83], v[236:239]
    buffer_load_dwordx4 v[32:35], v1, s[20:23], s45 offen offset:0 sc1
    s_waitcnt vmcnt(17)
    v_mfma_f32_16x16x32_bf16 v[240:243], v[36:39], v[80:83], v[240:243]
    v_mfma_f32_16x16x32_bf16 v[204:207], v[36:39], v[76:79], v[204:207]
    v_mfma_f32_16x16x32_bf16 v[168:171], v[36:39], v[72:75], v[168:171]
    v_mfma_f32_16x16x32_bf16 v[132:135], v[36:39], v[68:71], v[132:135]
    buffer_load_dwordx4 v[36:39], v1, s[20:23], s45 offen offset:1024 sc1
    s_waitcnt vmcnt(17)
    v_mfma_f32_16x16x32_bf16 v[136:139], v[40:43], v[68:71], v[136:139]
    v_mfma_f32_16x16x32_bf16 v[172:175], v[40:43], v[72:75], v[172:175]
    v_mfma_f32_16x16x32_bf16 v[208:211], v[40:43], v[76:79], v[208:211]
    v_mfma_f32_16x16x32_bf16 v[244:247], v[40:43], v[80:83], v[244:247]
    buffer_load_dwordx4 v[40:43], v1, s[20:23], s45 offen offset:2048 sc1
    s_waitcnt vmcnt(17)
    v_mfma_f32_16x16x32_bf16 v[248:251], v[44:47], v[80:83], v[248:251]
    v_mfma_f32_16x16x32_bf16 v[212:215], v[44:47], v[76:79], v[212:215]
    v_mfma_f32_16x16x32_bf16 v[176:179], v[44:47], v[72:75], v[176:179]
    v_mfma_f32_16x16x32_bf16 v[140:143], v[44:47], v[68:71], v[140:143]
    buffer_load_dwordx4 v[44:47], v1, s[20:23], s45 offen offset:3072 sc1
    s_add_u32 s45, s45, 36864
    s_waitcnt vmcnt(17)
    v_mfma_f32_16x16x32_bf16 v[144:147], v[48:51], v[68:71], v[144:147]
    v_mfma_f32_16x16x32_bf16 v[180:183], v[48:51], v[72:75], v[180:183]
    v_mfma_f32_16x16x32_bf16 v[216:219], v[48:51], v[76:79], v[216:219]
    v_mfma_f32_16x16x32_bf16 v[252:255], v[48:51], v[80:83], v[252:255]
    buffer_load_dwordx4 v[48:51], v1, s[20:23], s46 offen offset:0 sc1
    s_add_u32 s46, s46, 36864
    buffer_load_dwordx4 v[68:71], v1, s[20:23], s32 offen offset:1024 sc1
    buffer_load_dwordx4 v[72:75], v1, s[20:23], s33 offen offset:1024 sc1
    buffer_load_dwordx4 v[76:79], v1, s[20:23], s34 offen offset:1024 sc1
    buffer_load_dwordx4 v[80:83], v1, s[20:23], s35 offen offset:1024 sc1
    s_add_u32 s32, s32, 2048
    s_add_u32 s33, s33, 2048
    s_add_u32 s34, s34, 2048
    s_add_u32 s35, s35, 2048
    s_add_u32 s27, s27, 1
    s_and_b32 s27, s27, 7
    s_mul_i32 s30, s27, 20480
    s_add_u32 s30, s30, s28
    s_add_u32 m0, s29, 20480
    s_add_u32 s3, s30, 4096
    buffer_load_dwordx4 v1, s[20:23], s30 offen offset:0 sc1 lds
    buffer_load_dwordx4 v1, s[20:23], s30 offen offset:1024 sc1 lds
    buffer_load_dwordx4 v1, s[20:23], s30 offen offset:2048 sc1 lds
    buffer_load_dwordx4 v1, s[20:23], s30 offen offset:3072 sc1 lds
    s_add_u32 m0, m0, 4096
    s_nop 0
    buffer_load_dwordx4 v1, s[20:23], s3 offen sc1 lds
    v_cmp_gt_u32 vcc, 18, v0
    s_nop 1
    v_cndmask_b32 v3, v15, v2, vcc
    buffer_load_dword v90, v3, s[20:23], s41 offen sc0 sc1
    s_waitcnt vmcnt(18)
    v_mfma_f32_16x16x32_bf16 v[112:115], v[16:19], v[52:55], v[112:115]
    v_mfma_f32_16x16x32_bf16 v[148:151], v[16:19], v[56:59], v[148:151]
    v_mfma_f32_16x16x32_bf16 v[184:187], v[16:19], v[60:63], v[184:187]
    v_mfma_f32_16x16x32_bf16 v[220:223], v[16:19], v[64:67], v[220:223]
    buffer_load_dwordx4 v[16:19], v1, s[20:23], s44 offen offset:0 sc1
    s_waitcnt vmcnt(18)
    v_mfma_f32_16x16x32_bf16 v[224:227], v[20:23], v[64:67], v[224:227]
    v_mfma_f32_16x16x32_bf16 v[188:191], v[20:23], v[60:63], v[188:191]
    v_mfma_f32_16x16x32_bf16 v[152:155], v[20:23], v[56:59], v[152:155]
    v_mfma_f32_16x16x32_bf16 v[116:119], v[20:23], v[52:55], v[116:119]
    buffer_load_dwordx4 v[20:23], v1, s[20:23], s44 offen offset:1024 sc1
    s_waitcnt vmcnt(18)
    v_mfma_f32_16x16x32_bf16 v[120:123], v[24:27], v[52:55], v[120:123]
    v_mfma_f32_16x16x32_bf16 v[156:159], v[24:27], v[56:59], v[156:159]
    v_mfma_f32_16x16x32_bf16 v[192:195], v[24:27], v[60:63], v[192:195]
    v_mfma_f32_16x16x32_bf16 v[228:231], v[24:27], v[64:67], v[228:231]
    buffer_load_dwordx4 v[24:27], v1, s[20:23], s44 offen offset:2048 sc1
    s_waitcnt vmcnt(18)
    v_mfma_f32_16x16x32_bf16 v[232:235], v[28:31], v[64:67], v[232:235]
    v_mfma_f32_16x16x32_bf16 v[196:199], v[28:31], v[60:63], v[196:199]
    v_mfma_f32_16x16x32_bf16 v[160:163], v[28:31], v[56:59], v[160:163]
    v_mfma_f32_16x16x32_bf16 v[124:127], v[28:31], v[52:55], v[124:127]
    buffer_load_dwordx4 v[28:31], v1, s[20:23], s44 offen offset:3072 sc1
    s_add_u32 s44, s44, 36864
    s_waitcnt vmcnt(18)
    v_mfma_f32_16x16x32_bf16 v[128:131], v[32:35], v[52:55], v[128:131]
    v_mfma_f32_16x16x32_bf16 v[164:167], v[32:35], v[56:59], v[164:167]
    v_mfma_f32_16x16x32_bf16 v[200:203], v[32:35], v[60:63], v[200:203]
    v_mfma_f32_16x16x32_bf16 v[236:239], v[32:35], v[64:67], v[236:239]
    buffer_load_dwordx4 v[32:35], v1, s[20:23], s45 offen offset:0 sc1
    s_waitcnt vmcnt(18)
    v_mfma_f32_16x16x32_bf16 v[240:243], v[36:39], v[64:67], v[240:243]
    v_mfma_f32_16x16x32_bf16 v[204:207], v[36:39], v[60:63], v[204:207]
    v_mfma_f32_16x16x32_bf16 v[168:171], v[36:39], v[56:59], v[168:171]
    v_mfma_f32_16x16x32_bf16 v[132:135], v[36:39], v[52:55], v[132:135]
    buffer_load_dwordx4 v[36:39], v1, s[20:23], s45 offen offset:1024 sc1
    s_waitcnt vmcnt(18)
    v_mfma_f32_16x16x32_bf16 v[136:139], v[40:43], v[52:55], v[136:139]
    v_mfma_f32_16x16x32_bf16 v[172:175], v[40:43], v[56:59], v[172:175]
    v_mfma_f32_16x16x32_bf16 v[208:211], v[40:43], v[60:63], v[208:211]
    v_mfma_f32_16x16x32_bf16 v[244:247], v[40:43], v[64:67], v[244:247]
    buffer_load_dwordx4 v[40:43], v1, s[20:23], s45 offen offset:2048 sc1
    s_waitcnt vmcnt(18)
    v_mfma_f32_16x16x32_bf16 v[248:251], v[44:47], v[64:67], v[248:251]
    v_mfma_f32_16x16x32_bf16 v[212:215], v[44:47], v[60:63], v[212:215]
    v_mfma_f32_16x16x32_bf16 v[176:179], v[44:47], v[56:59], v[176:179]
    v_mfma_f32_16x16x32_bf16 v[140:143], v[44:47], v[52:55], v[140:143]
    buffer_load_dwordx4 v[44:47], v1, s[20:23], s45 offen offset:3072 sc1
    s_add_u32 s45, s45, 36864
    s_waitcnt vmcnt(18)
    v_mfma_f32_16x16x32_bf16 v[144:147], v[48:51], v[52:55], v[144:147]
    v_mfma_f32_16x16x32_bf16 v[180:183], v[48:51], v[56:59], v[180:183]
    v_mfma_f32_16x16x32_bf16 v[216:219], v[48:51], v[60:63], v[216:219]
    v_mfma_f32_16x16x32_bf16 v[252:255], v[48:51], v[64:67], v[252:255]
    buffer_load_dwordx4 v[48:51], v1, s[20:23], s46 offen offset:0 sc1
    s_add_u32 s46, s46, 36864
    buffer_load_dwordx4 v[52:55], v1, s[20:23], s32 offen offset:0 sc1
    buffer_load_dwordx4 v[56:59], v1, s[20:23], s33 offen offset:0 sc1
    buffer_load_dwordx4 v[60:63], v1, s[20:23], s34 offen offset:0 sc1
    buffer_load_dwordx4 v[64:67], v1, s[20:23], s35 offen offset:0 sc1
    v_mov_b32 v84, 5
    ds_write_b32 v10, v84
    s_add_u32 s27, s27, 1
    s_and_b32 s27, s27, 7
    s_mul_i32 s30, s27, 20480
    s_add_u32 s30, s30, s28
    s_add_u32 m0, s29, 0
    s_add_u32 s3, s30, 4096
    buffer_load_dwordx4 v1, s[20:23], s30 offen offset:0 sc1 lds
    buffer_load_dwordx4 v1, s[20:23], s30 offen offset:1024 sc1 lds
    buffer_load_dwordx4 v1, s[20:23], s30 offen offset:2048 sc1 lds
    buffer_load_dwordx4 v1, s[20:23], s30 offen offset:3072 sc1 lds
    s_add_u32 m0, m0, 4096
    s_nop 0
    buffer_load_dwordx4 v1, s[20:23], s3 offen sc1 lds
    s_waitcnt vmcnt(17)
    v_mfma_f32_16x16x32_bf16 v[112:115], v[16:19], v[68:71], v[112:115]
    v_mfma_f32_16x16x32_bf16 v[148:151], v[16:19], v[72:75], v[148:151]
    v_mfma_f32_16x16x32_bf16 v[184:187], v[16:19], v[76:79], v[184:187]
    v_mfma_f32_16x16x32_bf16 v[220:223], v[16:19], v[80:83], v[220:223]
    buffer_load_dwordx4 v[16:19], v1, s[20:23], s44 offen offset:0 sc1
    s_waitcnt vmcnt(17)
    v_mfma_f32_16x16x32_bf16 v[224:227], v[20:23], v[80:83], v[224:227]
    v_mfma_f32_16x16x32_bf16 v[188:191], v[20:23], v[76:79], v[188:191]
    v_mfma_f32_16x16x32_bf16 v[152:155], v[20:23], v[72:75], v[152:155]
    v_mfma_f32_16x16x32_bf16 v[116:119], v[20:23], v[68:71], v[116:119]
    buffer_load_dwordx4 v[20:23], v1, s[20:23], s44 offen offset:1024 sc1
    s_waitcnt vmcnt(17)
    v_mfma_f32_16x16x32_bf16 v[120:123], v[24:27], v[68:71], v[120:123]
    v_mfma_f32_16x16x32_bf16 v[156:159], v[24:27], v[72:75], v[156:159]
    v_mfma_f32_16x16x32_bf16 v[192:195], v[24:27], v[76:79], v[192:195]
    v_mfma_f32_16x16x32_bf16 v[228:231], v[24:27], v[80:83], v[228:231]
    buffer_load_dwordx4 v[24:27], v1, s[20:23], s44 offen offset:2048 sc1
    s_waitcnt vmcnt(17)
    v_mfma_f32_16x16x32_bf16 v[232:235], v[28:31], v[80:83], v[232:235]
    v_mfma_f32_16x16x32_bf16 v[196:199], v[28:31], v[76:79], v[196:199]
    v_mfma_f32_16x16x32_bf16 v[160:163], v[28:31], v[72:75], v[160:163]
    v_mfma_f32_16x16x32_bf16 v[124:127], v[28:31], v[68:71], v[124:127]
    buffer_load_dwordx4 v[28:31], v1, s[20:23], s44 offen offset:3072 sc1
    s_add_u32 s44, s44, 36864
    s_waitcnt vmcnt(17)
    v_mfma_f32_16x16x32_bf16 v[128:131], v[32:35], v[68:71], v[128:131]
    v_mfma_f32_16x16x32_bf16 v[164:167], v[32:35], v[72:75], v[164:167]
    v_mfma_f32_16x16x32_bf16 v[200:203], v[32:35], v[76:79], v[200:203]
    v_mfma_f32_16x16x32_bf16 v[236:239], v[32:35], v[80:83], v[236:239]
    buffer_load_dwordx4 v[32:35], v1, s[20:23], s45 offen offset:0 sc1
    s_waitcnt vmcnt(17)
    v_mfma_f32_16x16x32_bf16 v[240:243], v[36:39], v[80:83], v[240:243]
    v_mfma_f32_16x16x32_bf16 v[204:207], v[36:39], v[76:79], v[204:207]
    v_mfma_f32_16x16x32_bf16 v[168:171], v[36:39], v[72:75], v[168:171]
    v_mfma_f32_16x16x32_bf16 v[132:135], v[36:39], v[68:71], v[132:135]
    buffer_load_dwordx4 v[36:39], v1, s[20:23], s45 offen offset:1024 sc1
    s_waitcnt vmcnt(17)
    v_mfma_f32_16x16x32_bf16 v[136:139], v[40:43], v[68:71], v[136:139]
    v_mfma_f32_16x16x32_bf16 v[172:175], v[40:43], v[72:75], v[172:175]
    v_mfma_f32_16x16x32_bf16 v[208:211], v[40:43], v[76:79], v[208:211]
    v_mfma_f32_16x16x32_bf16 v[244:247], v[40:43], v[80:83], v[244:247]
    buffer_load_dwordx4 v[40:43], v1, s[20:23], s45 offen offset:2048 sc1
    s_waitcnt vmcnt(17)
    v_mfma_f32_16x16x32_bf16 v[248:251], v[44:47], v[80:83], v[248:251]
    v_mfma_f32_16x16x32_bf16 v[212:215], v[44:47], v[76:79], v[212:215]
    v_mfma_f32_16x16x32_bf16 v[176:179], v[44:47], v[72:75], v[176:179]
    v_mfma_f32_16x16x32_bf16 v[140:143], v[44:47], v[68:71], v[140:143]
    buffer_load_dwordx4 v[44:47], v1, s[20:23], s45 offen offset:3072 sc1
    s_add_u32 s45, s45, 36864
    s_waitcnt vmcnt(17)
    v_mfma_f32_16x16x32_bf16 v[144:147], v[48:51], v[68:71], v[144:147]
    v_mfma_f32_16x16x32_bf16 v[180:183], v[48:51], v[72:75], v[180:183]
    v_mfma_f32_16x16x32_bf16 v[216:219], v[48:51], v[76:79], v[216:219]
    v_mfma_f32_16x16x32_bf16 v[252:255], v[48:51], v[80:83], v[252:255]
    buffer_load_dwordx4 v[48:51], v1, s[20:23], s46 offen offset:0 sc1
    s_add_u32 s46, s46, 36864
    buffer_load_dwordx4 v[68:71], v1, s[20:23], s32 offen offset:1024 sc1
    buffer_load_dwordx4 v[72:75], v1, s[20:23], s33 offen offset:1024 sc1
    buffer_load_dwordx4 v[76:79], v1, s[20:23], s34 offen offset:1024 sc1
    buffer_load_dwordx4 v[80:83], v1, s[20:23], s35 offen offset:1024 sc1
    s_add_u32 s32, s32, 2048
    s_add_u32 s33, s33, 2048
    s_add_u32 s34, s34, 2048
    s_add_u32 s35, s35, 2048
    v_mov_b32 v84, 6
    ds_write_b32 v10, v84
    s_waitcnt vmcnt(12)
    v_mfma_f32_16x16x32_bf16 v[112:115], v[16:19], v[52:55], v[112:115]
    v_mfma_f32_16x16x32_bf16 v[148:151], v[16:19], v[56:59], v[148:151]
    v_mfma_f32_16x16x32_bf16 v[184:187], v[16:19], v[60:63], v[184:187]
    v_mfma_f32_16x16x32_bf16 v[220:223], v[16:19], v[64:67], v[220:223]
    buffer_load_dwordx4 v[16:19], v1, s[20:23], s44 offen offset:0 sc1
    s_waitcnt vmcnt(12)
    v_mfma_f32_16x16x32_bf16 v[224:227], v[20:23], v[64:67], v[224:227]
    v_mfma_f32_16x16x32_bf16 v[188:191], v[20:23], v[60:63], v[188:191]
    v_mfma_f32_16x16x32_bf16 v[152:155], v[20:23], v[56:59], v[152:155]
    v_mfma_f32_16x16x32_bf16 v[116:119], v[20:23], v[52:55], v[116:119]
    buffer_load_dwordx4 v[20:23], v1, s[20:23], s44 offen offset:1024 sc1
    s_waitcnt vmcnt(12)
    v_mfma_f32_16x16x32_bf16 v[120:123], v[24:27], v[52:55], v[120:123]
    v_mfma_f32_16x16x32_bf16 v[156:159], v[24:27], v[56:59], v[156:159]
    v_mfma_f32_16x16x32_bf16 v[192:195], v[24:27], v[60:63], v[192:195]
    v_mfma_f32_16x16x32_bf16 v[228:231], v[24:27], v[64:67], v[228:231]
    buffer_load_dwordx4 v[24:27], v1, s[20:23], s44 offen offset:2048 sc1
    s_waitcnt vmcnt(12)
    v_mfma_f32_16x16x32_bf16 v[232:235], v[28:31], v[64:67], v[232:235]
    v_mfma_f32_16x16x32_bf16 v[196:199], v[28:31], v[60:63], v[196:199]
    v_mfma_f32_16x16x32_bf16 v[160:163], v[28:31], v[56:59], v[160:163]
    v_mfma_f32_16x16x32_bf16 v[124:127], v[28:31], v[52:55], v[124:127]
    buffer_load_dwordx4 v[28:31], v1, s[20:23], s44 offen offset:3072 sc1
    s_add_u32 s44, s44, 36864
    s_waitcnt vmcnt(12)
    v_mfma_f32_16x16x32_bf16 v[128:131], v[32:35], v[52:55], v[128:131]
    v_mfma_f32_16x16x32_bf16 v[164:167], v[32:35], v[56:59], v[164:167]
    v_mfma_f32_16x16x32_bf16 v[200:203], v[32:35], v[60:63], v[200:203]
    v_mfma_f32_16x16x32_bf16 v[236:239], v[32:35], v[64:67], v[236:239]
    buffer_load_dwordx4 v[32:35], v1, s[20:23], s45 offen offset:0 sc1
    s_waitcnt vmcnt(12)
    v_mfma_f32_16x16x32_bf16 v[240:243], v[36:39], v[64:67], v[240:243]
    v_mfma_f32_16x16x32_bf16 v[204:207], v[36:39], v[60:63], v[204:207]
    v_mfma_f32_16x16x32_bf16 v[168:171], v[36:39], v[56:59], v[168:171]
    v_mfma_f32_16x16x32_bf16 v[132:135], v[36:39], v[52:55], v[132:135]
    buffer_load_dwordx4 v[36:39], v1, s[20:23], s45 offen offset:1024 sc1
    s_waitcnt vmcnt(12)
    v_mfma_f32_16x16x32_bf16 v[136:139], v[40:43], v[52:55], v[136:139]
    v_mfma_f32_16x16x32_bf16 v[172:175], v[40:43], v[56:59], v[172:175]
    v_mfma_f32_16x16x32_bf16 v[208:211], v[40:43], v[60:63], v[208:211]
    v_mfma_f32_16x16x32_bf16 v[244:247], v[40:43], v[64:67], v[244:247]
    buffer_load_dwordx4 v[40:43], v1, s[20:23], s45 offen offset:2048 sc1
    s_waitcnt vmcnt(12)
    v_mfma_f32_16x16x32_bf16 v[248:251], v[44:47], v[64:67], v[248:251]
    v_mfma_f32_16x16x32_bf16 v[212:215], v[44:47], v[60:63], v[212:215]
    v_mfma_f32_16x16x32_bf16 v[176:179], v[44:47], v[56:59], v[176:179]
    v_mfma_f32_16x16x32_bf16 v[140:143], v[44:47], v[52:55], v[140:143]
    buffer_load_dwordx4 v[44:47], v1, s[20:23], s45 offen offset:3072 sc1
    s_add_u32 s45, s45, 36864
    s_waitcnt vmcnt(12)
    v_mfma_f32_16x16x32_bf16 v[144:147], v[48:51], v[52:55], v[144:147]
    v_mfma_f32_16x16x32_bf16 v[180:183], v[48:51], v[56:59], v[180:183]
    v_mfma_f32_16x16x32_bf16 v[216:219], v[48:51], v[60:63], v[216:219]
    v_mfma_f32_16x16x32_bf16 v[252:255], v[48:51], v[64:67], v[252:255]
    buffer_load_dwordx4 v[48:51], v1, s[20:23], s46 offen offset:0 sc1
    s_add_u32 s46, s46, 36864
    buffer_load_dwordx4 v[52:55], v1, s[20:23], s32 offen offset:0 sc1
    buffer_load_dwordx4 v[56:59], v1, s[20:23], s33 offen offset:0 sc1
    buffer_load_dwordx4 v[60:63], v1, s[20:23], s34 offen offset:0 sc1
    buffer_load_dwordx4 v[64:67], v1, s[20:23], s35 offen offset:0 sc1
    v_mov_b32 v84, 7
    ds_write_b32 v10, v84
    s_nop 0
    v_cmp_eq_u32 vcc, s99, v90
    s_nop 3
    s_bcnt1_i32_b64 s101, vcc
    s_cmp_eq_u32 s101, 18
    s_cbranch_scc1 L_f2_wook
    s_mov_b32 s100, 100000
L_parall_poll_8:
    buffer_load_dword v90, v3, s[20:23], s41 offen sc0 sc1
    s_waitcnt vmcnt(0)
    v_cmp_eq_u32 vcc, s99, v90
    s_nop 3
    s_bcnt1_i32_b64 s101, vcc
    s_cmp_eq_u32 s101, 18
    s_cbranch_scc1 L_parall_poll_8_ok
    s_sub_u32 s100, s100, 1
    s_cbranch_scc1 L_parall_poll_8_ok
    s_sleep 8
    s_branch L_parall_poll_8
L_parall_poll_8_ok:
L_f2_wook:
    s_waitcnt vmcnt(12)
    v_mfma_f32_16x16x32_bf16 v[112:115], v[16:19], v[68:71], v[112:115]
    v_mfma_f32_16x16x32_bf16 v[148:151], v[16:19], v[72:75], v[148:151]
    v_mfma_f32_16x16x32_bf16 v[184:187], v[16:19], v[76:79], v[184:187]
    v_mfma_f32_16x16x32_bf16 v[220:223], v[16:19], v[80:83], v[220:223]
    buffer_load_dwordx4 v[16:19], v1, s[20:23], s44 offen offset:0 sc1
    s_waitcnt vmcnt(12)
    v_mfma_f32_16x16x32_bf16 v[224:227], v[20:23], v[80:83], v[224:227]
    v_mfma_f32_16x16x32_bf16 v[188:191], v[20:23], v[76:79], v[188:191]
    v_mfma_f32_16x16x32_bf16 v[152:155], v[20:23], v[72:75], v[152:155]
    v_mfma_f32_16x16x32_bf16 v[116:119], v[20:23], v[68:71], v[116:119]
    buffer_load_dwordx4 v[20:23], v1, s[20:23], s44 offen offset:1024 sc1
    s_waitcnt vmcnt(12)
    v_mfma_f32_16x16x32_bf16 v[120:123], v[24:27], v[68:71], v[120:123]
    v_mfma_f32_16x16x32_bf16 v[156:159], v[24:27], v[72:75], v[156:159]
    v_mfma_f32_16x16x32_bf16 v[192:195], v[24:27], v[76:79], v[192:195]
    v_mfma_f32_16x16x32_bf16 v[228:231], v[24:27], v[80:83], v[228:231]
    buffer_load_dwordx4 v[24:27], v1, s[20:23], s44 offen offset:2048 sc1
    s_waitcnt vmcnt(12)
    v_mfma_f32_16x16x32_bf16 v[232:235], v[28:31], v[80:83], v[232:235]
    v_mfma_f32_16x16x32_bf16 v[196:199], v[28:31], v[76:79], v[196:199]
    v_mfma_f32_16x16x32_bf16 v[160:163], v[28:31], v[72:75], v[160:163]
    v_mfma_f32_16x16x32_bf16 v[124:127], v[28:31], v[68:71], v[124:127]
    buffer_load_dwordx4 v[28:31], v1, s[20:23], s44 offen offset:3072 sc1
    s_add_u32 s44, s44, 36864
    s_waitcnt vmcnt(12)
    v_mfma_f32_16x16x32_bf16 v[128:131], v[32:35], v[68:71], v[128:131]
    v_mfma_f32_16x16x32_bf16 v[164:167], v[32:35], v[72:75], v[164:167]
    v_mfma_f32_16x16x32_bf16 v[200:203], v[32:35], v[76:79], v[200:203]
    v_mfma_f32_16x16x32_bf16 v[236:239], v[32:35], v[80:83], v[236:239]
    buffer_load_dwordx4 v[32:35], v1, s[20:23], s45 offen offset:0 sc1
    s_waitcnt vmcnt(12)
    v_mfma_f32_16x16x32_bf16 v[240:243], v[36:39], v[80:83], v[240:243]
    v_mfma_f32_16x16x32_bf16 v[204:207], v[36:39], v[76:79], v[204:207]
    v_mfma_f32_16x16x32_bf16 v[168:171], v[36:39], v[72:75], v[168:171]
    v_mfma_f32_16x16x32_bf16 v[132:135], v[36:39], v[68:71], v[132:135]
    buffer_load_dwordx4 v[36:39], v1, s[20:23], s45 offen offset:1024 sc1
    s_waitcnt vmcnt(12)
    v_mfma_f32_16x16x32_bf16 v[136:139], v[40:43], v[68:71], v[136:139]
    v_mfma_f32_16x16x32_bf16 v[172:175], v[40:43], v[72:75], v[172:175]
    v_mfma_f32_16x16x32_bf16 v[208:211], v[40:43], v[76:79], v[208:211]
    v_mfma_f32_16x16x32_bf16 v[244:247], v[40:43], v[80:83], v[244:247]
    buffer_load_dwordx4 v[40:43], v1, s[20:23], s45 offen offset:2048 sc1
    s_waitcnt vmcnt(12)
    v_mfma_f32_16x16x32_bf16 v[248:251], v[44:47], v[80:83], v[248:251]
    v_mfma_f32_16x16x32_bf16 v[212:215], v[44:47], v[76:79], v[212:215]
    v_mfma_f32_16x16x32_bf16 v[176:179], v[44:47], v[72:75], v[176:179]
    v_mfma_f32_16x16x32_bf16 v[140:143], v[44:47], v[68:71], v[140:143]
    buffer_load_dwordx4 v[44:47], v1, s[20:23], s45 offen offset:3072 sc1
    s_add_u32 s45, s45, 36864
    s_waitcnt vmcnt(12)
    v_mfma_f32_16x16x32_bf16 v[144:147], v[48:51], v[68:71], v[144:147]
    v_mfma_f32_16x16x32_bf16 v[180:183], v[48:51], v[72:75], v[180:183]
    v_mfma_f32_16x16x32_bf16 v[216:219], v[48:51], v[76:79], v[216:219]
    v_mfma_f32_16x16x32_bf16 v[252:255], v[48:51], v[80:83], v[252:255]
    buffer_load_dwordx4 v[48:51], v1, s[20:23], s46 offen offset:0 sc1
    s_add_u32 s46, s46, 36864
    buffer_load_dwordx4 v[68:71], v1, s[20:23], s32 offen offset:1024 sc1
    buffer_load_dwordx4 v[72:75], v1, s[20:23], s33 offen offset:1024 sc1
    buffer_load_dwordx4 v[76:79], v1, s[20:23], s34 offen offset:1024 sc1
    buffer_load_dwordx4 v[80:83], v1, s[20:23], s35 offen offset:1024 sc1
    s_add_u32 s32, s32, 2048
    s_add_u32 s33, s33, 2048
    s_add_u32 s34, s34, 2048
    s_add_u32 s35, s35, 2048
.p2align 6
L_f2_loop:
    s_cmp_gt_u32 s63, 4
    s_cbranch_scc1 L_f2_hi
    s_setprio 0
L_f2_hi:
    s_waitcnt vmcnt(12)
    v_mfma_f32_16x16x32_bf16 v[112:115], v[16:19], v[52:55], v[112:115]
    v_mfma_f32_16x16x32_bf16 v[148:151], v[16:19], v[56:59], v[148:151]
    v_mfma_f32_16x16x32_bf16 v[184:187], v[16:19], v[60:63], v[184:187]
    v_mfma_f32_16x16x32_bf16 v[220:223], v[16:19], v[64:67], v[220:223]
    buffer_load_dwordx4 v[16:19], v1, s[20:23], s44 offen offset:0 sc1
    s_waitcnt vmcnt(12)
    v_mfma_f32_16x16x32_bf16 v[224:227], v[20:23], v[64:67], v[224:227]
    v_mfma_f32_16x16x32_bf16 v[188:191], v[20:23], v[60:63], v[188:191]
    v_mfma_f32_16x16x32_bf16 v[152:155], v[20:23], v[56:59], v[152:155]
    v_mfma_f32_16x16x32_bf16 v[116:119], v[20:23], v[52:55], v[116:119]
    buffer_load_dwordx4 v[20:23], v1, s[20:23], s44 offen offset:1024 sc1
    s_waitcnt vmcnt(12)
    v_mfma_f32_16x16x32_bf16 v[120:123], v[24:27], v[52:55], v[120:123]
    v_mfma_f32_16x16x32_bf16 v[156:159], v[24:27], v[56:59], v[156:159]
    v_mfma_f32_16x16x32_bf16 v[192:195], v[24:27], v[60:63], v[192:195]
    v_mfma_f32_16x16x32_bf16 v[228:231], v[24:27], v[64:67], v[228:231]
    buffer_load_dwordx4 v[24:27], v1, s[20:23], s44 offen offset:2048 sc1
    s_waitcnt vmcnt(12)
    v_mfma_f32_16x16x32_bf16 v[232:235], v[28:31], v[64:67], v[232:235]
    v_mfma_f32_16x16x32_bf16 v[196:199], v[28:31], v[60:63], v[196:199]
    v_mfma_f32_16x16x32_bf16 v[160:163], v[28:31], v[56:59], v[160:163]
    v_mfma_f32_16x16x32_bf16 v[124:127], v[28:31], v[52:55], v[124:127]
    buffer_load_dwordx4 v[28:31], v1, s[20:23], s44 offen offset:3072 sc1
    s_add_u32 s44, s44, 36864
    s_waitcnt vmcnt(12)
    v_mfma_f32_16x16x32_bf16 v[128:131], v[32:35], v[52:55], v[128:131]
    v_mfma_f32_16x16x32_bf16 v[164:167], v[32:35], v[56:59], v[164:167]
    v_mfma_f32_16x16x32_bf16 v[200:203], v[32:35], v[60:63], v[200:203]
    v_mfma_f32_16x16x32_bf16 v[236:239], v[32:35], v[64:67], v[236:239]
    buffer_load_dwordx4 v[32:35], v1, s[20:23], s45 offen offset:0 sc1
    s_waitcnt vmcnt(12)
    v_mfma_f32_16x16x32_bf16 v[240:243], v[36:39], v[64:67], v[240:243]
    v_mfma_f32_16x16x32_bf16 v[204:207], v[36:39], v[60:63], v[204:207]
    v_mfma_f32_16x16x32_bf16 v[168:171], v[36:39], v[56:59], v[168:171]
    v_mfma_f32_16x16x32_bf16 v[132:135], v[36:39], v[52:55], v[132:135]
    buffer_load_dwordx4 v[36:39], v1, s[20:23], s45 offen offset:1024 sc1
    s_waitcnt vmcnt(12)
    v_mfma_f32_16x16x32_bf16 v[136:139], v[40:43], v[52:55], v[136:139]
    v_mfma_f32_16x16x32_bf16 v[172:175], v[40:43], v[56:59], v[172:175]
    v_mfma_f32_16x16x32_bf16 v[208:211], v[40:43], v[60:63], v[208:211]
    v_mfma_f32_16x16x32_bf16 v[244:247], v[40:43], v[64:67], v[244:247]
    buffer_load_dwordx4 v[40:43], v1, s[20:23], s45 offen offset:2048 sc1
    s_waitcnt vmcnt(12)
    v_mfma_f32_16x16x32_bf16 v[248:251], v[44:47], v[64:67], v[248:251]
    v_mfma_f32_16x16x32_bf16 v[212:215], v[44:47], v[60:63], v[212:215]
    v_mfma_f32_16x16x32_bf16 v[176:179], v[44:47], v[56:59], v[176:179]
    v_mfma_f32_16x16x32_bf16 v[140:143], v[44:47], v[52:55], v[140:143]
    buffer_load_dwordx4 v[44:47], v1, s[20:23], s45 offen offset:3072 sc1
    s_add_u32 s45, s45, 36864
    s_waitcnt vmcnt(12)
    v_mfma_f32_16x16x32_bf16 v[144:147], v[48:51], v[52:55], v[144:147]
    v_mfma_f32_16x16x32_bf16 v[180:183], v[48:51], v[56:59], v[180:183]
    v_mfma_f32_16x16x32_bf16 v[216:219], v[48:51], v[60:63], v[216:219]
    v_mfma_f32_16x16x32_bf16 v[252:255], v[48:51], v[64:67], v[252:255]
    buffer_load_dwordx4 v[48:51], v1, s[20:23], s46 offen offset:0 sc1
    s_add_u32 s46, s46, 36864
    buffer_load_dwordx4 v[52:55], v1, s[20:23], s32 offen offset:0 sc1
    buffer_load_dwordx4 v[56:59], v1, s[20:23], s33 offen offset:0 sc1
    buffer_load_dwordx4 v[60:63], v1, s[20:23], s34 offen offset:0 sc1
    buffer_load_dwordx4 v[64:67], v1, s[20:23], s35 offen offset:0 sc1
    s_waitcnt vmcnt(12)
    v_mfma_f32_16x16x32_bf16 v[112:115], v[16:19], v[68:71], v[112:115]
    v_mfma_f32_16x16x32_bf16 v[148:151], v[16:19], v[72:75], v[148:151]
    v_mfma_f32_16x16x32_bf16 v[184:187], v[16:19], v[76:79], v[184:187]
    v_mfma_f32_16x16x32_bf16 v[220:223], v[16:19], v[80:83], v[220:223]
    buffer_load_dwordx4 v[16:19], v1, s[20:23], s44 offen offset:0 sc1
    s_waitcnt vmcnt(12)
    v_mfma_f32_16x16x32_bf16 v[224:227], v[20:23], v[80:83], v[224:227]
    v_mfma_f32_16x16x32_bf16 v[188:191], v[20:23], v[76:79], v[188:191]
    v_mfma_f32_16x16x32_bf16 v[152:155], v[20:23], v[72:75], v[152:155]
    v_mfma_f32_16x16x32_bf16 v[116:119], v[20:23], v[68:71], v[116:119]
    buffer_load_dwordx4 v[20:23], v1, s[20:23], s44 offen offset:1024 sc1
    s_waitcnt vmcnt(12)
    v_mfma_f32_16x16x32_bf16 v[120:123], v[24:27], v[68:71], v[120:123]
    v_mfma_f32_16x16x32_bf16 v[156:159], v[24:27], v[72:75], v[156:159]
    v_mfma_f32_16x16x32_bf16 v[192:195], v[24:27], v[76:79], v[192:195]
    v_mfma_f32_16x16x32_bf16 v[228:231], v[24:27], v[80:83], v[228:231]
    buffer_load_dwordx4 v[24:27], v1, s[20:23], s44 offen offset:2048 sc1
    s_waitcnt vmcnt(12)
    v_mfma_f32_16x16x32_bf16 v[232:235], v[28:31], v[80:83], v[232:235]
    v_mfma_f32_16x16x32_bf16 v[196:199], v[28:31], v[76:79], v[196:199]
    v_mfma_f32_16x16x32_bf16 v[160:163], v[28:31], v[72:75], v[160:163]
    v_mfma_f32_16x16x32_bf16 v[124:127], v[28:31], v[68:71], v[124:127]
    buffer_load_dwordx4 v[28:31], v1, s[20:23], s44 offen offset:3072 sc1
    s_add_u32 s44, s44, 36864
    s_waitcnt vmcnt(12)
    v_mfma_f32_16x16x32_bf16 v[128:131], v[32:35], v[68:71], v[128:131]
    v_mfma_f32_16x16x32_bf16 v[164:167], v[32:35], v[72:75], v[164:167]
    v_mfma_f32_16x16x32_bf16 v[200:203], v[32:35], v[76:79], v[200:203]
    v_mfma_f32_16x16x32_bf16 v[236:239], v[32:35], v[80:83], v[236:239]
    buffer_load_dwordx4 v[32:35], v1, s[20:23], s45 offen offset:0 sc1
    s_waitcnt vmcnt(12)
    v_mfma_f32_16x16x32_bf16 v[240:243], v[36:39], v[80:83], v[240:243]
    v_mfma_f32_16x16x32_bf16 v[204:207], v[36:39], v[76:79], v[204:207]
    v_mfma_f32_16x16x32_bf16 v[168:171], v[36:39], v[72:75], v[168:171]
    v_mfma_f32_16x16x32_bf16 v[132:135], v[36:39], v[68:71], v[132:135]
    buffer_load_dwordx4 v[36:39], v1, s[20:23], s45 offen offset:1024 sc1
    s_waitcnt vmcnt(12)
    v_mfma_f32_16x16x32_bf16 v[136:139], v[40:43], v[68:71], v[136:139]
    v_mfma_f32_16x16x32_bf16 v[172:175], v[40:43], v[72:75], v[172:175]
    v_mfma_f32_16x16x32_bf16 v[208:211], v[40:43], v[76:79], v[208:211]
    v_mfma_f32_16x16x32_bf16 v[244:247], v[40:43], v[80:83], v[244:247]
    buffer_load_dwordx4 v[40:43], v1, s[20:23], s45 offen offset:2048 sc1
    s_waitcnt vmcnt(12)
    v_mfma_f32_16x16x32_bf16 v[248:251], v[44:47], v[80:83], v[248:251]
    v_mfma_f32_16x16x32_bf16 v[212:215], v[44:47], v[76:79], v[212:215]
    v_mfma_f32_16x16x32_bf16 v[176:179], v[44:47], v[72:75], v[176:179]
    v_mfma_f32_16x16x32_bf16 v[140:143], v[44:47], v[68:71], v[140:143]
    buffer_load_dwordx4 v[44:47], v1, s[20:23], s45 offen offset:3072 sc1
    s_add_u32 s45, s45, 36864
    s_waitcnt vmcnt(12)
    v_mfma_f32_16x16x32_bf16 v[144:147], v[48:51], v[68:71], v[144:147]
    v_mfma_f32_16x16x32_bf16 v[180:183], v[48:51], v[72:75], v[180:183]
    v_mfma_f32_16x16x32_bf16 v[216:219], v[48:51], v[76:79], v[216:219]
    v_mfma_f32_16x16x32_bf16 v[252:255], v[48:51], v[80:83], v[252:255]
    buffer_load_dwordx4 v[48:51], v1, s[20:23], s46 offen offset:0 sc1
    s_add_u32 s46, s46, 36864
    buffer_load_dwordx4 v[68:71], v1, s[20:23], s32 offen offset:1024 sc1
    buffer_load_dwordx4 v[72:75], v1, s[20:23], s33 offen offset:1024 sc1
    buffer_load_dwordx4 v[76:79], v1, s[20:23], s34 offen offset:1024 sc1
    buffer_load_dwordx4 v[80:83], v1, s[20:23], s35 offen offset:1024 sc1
    s_add_u32 s32, s32, 2048
    s_add_u32 s33, s33, 2048
    s_add_u32 s34, s34, 2048
    s_add_u32 s35, s35, 2048
    s_sub_u32 s63, s63, 1
    s_cmp_lg_u32 s63, 0
    s_cbranch_scc1 L_f2_loop
    s_waitcnt vmcnt(12)
    v_mfma_f32_16x16x32_bf16 v[112:115], v[16:19], v[52:55], v[112:115]
    v_mfma_f32_16x16x32_bf16 v[148:151], v[16:19], v[56:59], v[148:151]
    v_mfma_f32_16x16x32_bf16 v[184:187], v[16:19], v[60:63], v[184:187]
    v_mfma_f32_16x16x32_bf16 v[220:223], v[16:19], v[64:67], v[220:223]
    buffer_load_dwordx4 v[16:19], v1, s[20:23], s44 offen offset:0 sc1
    s_waitcnt vmcnt(12)
    v_mfma_f32_16x16x32_bf16 v[224:227], v[20:23], v[64:67], v[224:227]
    v_mfma_f32_16x16x32_bf16 v[188:191], v[20:23], v[60:63], v[188:191]
    v_mfma_f32_16x16x32_bf16 v[152:155], v[20:23], v[56:59], v[152:155]
    v_mfma_f32_16x16x32_bf16 v[116:119], v[20:23], v[52:55], v[116:119]
    buffer_load_dwordx4 v[20:23], v1, s[20:23], s44 offen offset:1024 sc1
    s_waitcnt vmcnt(12)
    v_mfma_f32_16x16x32_bf16 v[120:123], v[24:27], v[52:55], v[120:123]
    v_mfma_f32_16x16x32_bf16 v[156:159], v[24:27], v[56:59], v[156:159]
    v_mfma_f32_16x16x32_bf16 v[192:195], v[24:27], v[60:63], v[192:195]
    v_mfma_f32_16x16x32_bf16 v[228:231], v[24:27], v[64:67], v[228:231]
    buffer_load_dwordx4 v[24:27], v1, s[20:23], s44 offen offset:2048 sc1
    s_waitcnt vmcnt(12)
    v_mfma_f32_16x16x32_bf16 v[232:235], v[28:31], v[64:67], v[232:235]
    v_mfma_f32_16x16x32_bf16 v[196:199], v[28:31], v[60:63], v[196:199]
    v_mfma_f32_16x16x32_bf16 v[160:163], v[28:31], v[56:59], v[160:163]
    v_mfma_f32_16x16x32_bf16 v[124:127], v[28:31], v[52:55], v[124:127]
    buffer_load_dwordx4 v[28:31], v1, s[20:23], s44 offen offset:3072 sc1
    s_add_u32 s44, s44, 36864
    s_waitcnt vmcnt(12)
    v_mfma_f32_16x16x32_bf16 v[128:131], v[32:35], v[52:55], v[128:131]
    v_mfma_f32_16x16x32_bf16 v[164:167], v[32:35], v[56:59], v[164:167]
    v_mfma_f32_16x16x32_bf16 v[200:203], v[32:35], v[60:63], v[200:203]
    v_mfma_f32_16x16x32_bf16 v[236:239], v[32:35], v[64:67], v[236:239]
    buffer_load_dwordx4 v[32:35], v1, s[20:23], s45 offen offset:0 sc1
    s_waitcnt vmcnt(12)
    v_mfma_f32_16x16x32_bf16 v[240:243], v[36:39], v[64:67], v[240:243]
    v_mfma_f32_16x16x32_bf16 v[204:207], v[36:39], v[60:63], v[204:207]
    v_mfma_f32_16x16x32_bf16 v[168:171], v[36:39], v[56:59], v[168:171]
    v_mfma_f32_16x16x32_bf16 v[132:135], v[36:39], v[52:55], v[132:135]
    buffer_load_dwordx4 v[36:39], v1, s[20:23], s45 offen offset:1024 sc1
    s_waitcnt vmcnt(12)
    v_mfma_f32_16x16x32_bf16 v[136:139], v[40:43], v[52:55], v[136:139]
    v_mfma_f32_16x16x32_bf16 v[172:175], v[40:43], v[56:59], v[172:175]
    v_mfma_f32_16x16x32_bf16 v[208:211], v[40:43], v[60:63], v[208:211]
    v_mfma_f32_16x16x32_bf16 v[244:247], v[40:43], v[64:67], v[244:247]
    buffer_load_dwordx4 v[40:43], v1, s[20:23], s45 offen offset:2048 sc1
    s_waitcnt vmcnt(12)
    v_mfma_f32_16x16x32_bf16 v[248:251], v[44:47], v[64:67], v[248:251]
    v_mfma_f32_16x16x32_bf16 v[212:215], v[44:47], v[60:63], v[212:215]
    v_mfma_f32_16x16x32_bf16 v[176:179], v[44:47], v[56:59], v[176:179]
    v_mfma_f32_16x16x32_bf16 v[140:143], v[44:47], v[52:55], v[140:143]
    buffer_load_dwordx4 v[44:47], v1, s[20:23], s45 offen offset:3072 sc1
    s_add_u32 s45, s45, 36864
    s_waitcnt vmcnt(12)
    v_mfma_f32_16x16x32_bf16 v[144:147], v[48:51], v[52:55], v[144:147]
    v_mfma_f32_16x16x32_bf16 v[180:183], v[48:51], v[56:59], v[180:183]
    v_mfma_f32_16x16x32_bf16 v[216:219], v[48:51], v[60:63], v[216:219]
    v_mfma_f32_16x16x32_bf16 v[252:255], v[48:51], v[64:67], v[252:255]
    buffer_load_dwordx4 v[48:51], v1, s[20:23], s46 offen offset:0 sc1
    s_add_u32 s46, s46, 36864
    s_waitcnt vmcnt(8)
    v_mfma_f32_16x16x32_bf16 v[112:115], v[16:19], v[68:71], v[112:115]
    v_mfma_f32_16x16x32_bf16 v[148:151], v[16:19], v[72:75], v[148:151]
    v_mfma_f32_16x16x32_bf16 v[184:187], v[16:19], v[76:79], v[184:187]
    v_mfma_f32_16x16x32_bf16 v[220:223], v[16:19], v[80:83], v[220:223]
    s_waitcnt vmcnt(7)
    v_mfma_f32_16x16x32_bf16 v[224:227], v[20:23], v[80:83], v[224:227]
    v_mfma_f32_16x16x32_bf16 v[188:191], v[20:23], v[76:79], v[188:191]
    v_mfma_f32_16x16x32_bf16 v[152:155], v[20:23], v[72:75], v[152:155]
    v_mfma_f32_16x16x32_bf16 v[116:119], v[20:23], v[68:71], v[116:119]
    s_waitcnt vmcnt(6)
    v_mfma_f32_16x16x32_bf16 v[120:123], v[24:27], v[68:71], v[120:123]
    v_mfma_f32_16x16x32_bf16 v[156:159], v[24:27], v[72:75], v[156:159]
    v_mfma_f32_16x16x32_bf16 v[192:195], v[24:27], v[76:79], v[192:195]
    v_mfma_f32_16x16x32_bf16 v[228:231], v[24:27], v[80:83], v[228:231]
    s_waitcnt vmcnt(5)
    v_mfma_f32_16x16x32_bf16 v[232:235], v[28:31], v[80:83], v[232:235]
    v_mfma_f32_16x16x32_bf16 v[196:199], v[28:31], v[76:79], v[196:199]
    v_mfma_f32_16x16x32_bf16 v[160:163], v[28:31], v[72:75], v[160:163]
    v_mfma_f32_16x16x32_bf16 v[124:127], v[28:31], v[68:71], v[124:127]
    s_waitcnt vmcnt(4)
    v_mfma_f32_16x16x32_bf16 v[128:131], v[32:35], v[68:71], v[128:131]
    v_mfma_f32_16x16x32_bf16 v[164:167], v[32:35], v[72:75], v[164:167]
    v_mfma_f32_16x16x32_bf16 v[200:203], v[32:35], v[76:79], v[200:203]
    v_mfma_f32_16x16x32_bf16 v[236:239], v[32:35], v[80:83], v[236:239]
    s_waitcnt vmcnt(3)
    v_mfma_f32_16x16x32_bf16 v[240:243], v[36:39], v[80:83], v[240:243]
    v_mfma_f32_16x16x32_bf16 v[204:207], v[36:39], v[76:79], v[204:207]
    v_mfma_f32_16x16x32_bf16 v[168:171], v[36:39], v[72:75], v[168:171]
    v_mfma_f32_16x16x32_bf16 v[132:135], v[36:39], v[68:71], v[132:135]
    s_waitcnt vmcnt(2)
    v_mfma_f32_16x16x32_bf16 v[136:139], v[40:43], v[68:71], v[136:139]
    v_mfma_f32_16x16x32_bf16 v[172:175], v[40:43], v[72:75], v[172:175]
    v_mfma_f32_16x16x32_bf16 v[208:211], v[40:43], v[76:79], v[208:211]
    v_mfma_f32_16x16x32_bf16 v[244:247], v[40:43], v[80:83], v[244:247]
    s_waitcnt vmcnt(1)
    v_mfma_f32_16x16x32_bf16 v[248:251], v[44:47], v[80:83], v[248:251]
    v_mfma_f32_16x16x32_bf16 v[212:215], v[44:47], v[76:79], v[212:215]
    v_mfma_f32_16x16x32_bf16 v[176:179], v[44:47], v[72:75], v[176:179]
    v_mfma_f32_16x16x32_bf16 v[140:143], v[44:47], v[68:71], v[140:143]
    s_waitcnt vmcnt(0)
    v_mfma_f32_16x16x32_bf16 v[144:147], v[48:51], v[68:71], v[144:147]
    v_mfma_f32_16x16x32_bf16 v[180:183], v[48:51], v[72:75], v[180:183]
    v_mfma_f32_16x16x32_bf16 v[216:219], v[48:51], v[76:79], v[216:219]
    v_mfma_f32_16x16x32_bf16 v[252:255], v[48:51], v[80:83], v[252:255]
L_f2_tail:
    s_setprio 2
    s_mov_b32 s100, 1600000
    v_mov_b32 v88, 162816
L_parall_lw_9:
    ds_read_b128 v[84:87], v88
    s_waitcnt lgkmcnt(0)
    v_min3_u32 v84, v84, v85, v86
    v_min_u32 v84, v84, v87
    s_nop 0
    v_readfirstlane_b32 s101, v84
    s_cmp_ge_u32 s101, 4
    s_cbranch_scc1 L_parall_lw_9_ok
    s_sleep 1
    s_sub_u32 s100, s100, 1
    s_cbranch_scc0 L_parall_lw_9
L_parall_lw_9_ok:
    v_mov_b32 v84, 8
    s_cmp_lg_u32 s31, 0
    s_cbranch_scc1 L_f2_w0
    ds_write_b128 v5, v[148:151] offset:0
    ds_write_b128 v5, v[152:155] offset:1024
    ds_write_b128 v5, v[156:159] offset:2048
    ds_write_b128 v5, v[160:163] offset:3072
    ds_write_b128 v5, v[164:167] offset:4096
    ds_write_b128 v5, v[168:171] offset:5120
    ds_write_b128 v5, v[172:175] offset:6144
    ds_write_b128 v5, v[176:179] offset:7168
    ds_write_b128 v5, v[180:183] offset:8192
    ds_write_b128 v5, v[184:187] offset:9216
    ds_write_b128 v5, v[188:191] offset:10240
    ds_write_b128 v5, v[192:195] offset:11264
    ds_write_b128 v5, v[196:199] offset:12288
    ds_write_b128 v5, v[200:203] offset:13312
    ds_write_b128 v5, v[204:207] offset:14336
    ds_write_b128 v5, v[208:211] offset:15360
    ds_write_b128 v5, v[212:215] offset:16384
    ds_write_b128 v5, v[216:219] offset:17408
    ds_write_b128 v5, v[220:223] offset:18432
    ds_write_b128 v5, v[224:227] offset:19456
    ds_write_b128 v5, v[228:231] offset:20480
    ds_write_b128 v5, v[232:235] offset:21504
    ds_write_b128 v5, v[236:239] offset:22528
    ds_write_b128 v5, v[240:243] offset:23552
    ds_write_b128 v5, v[244:247] offset:24576
    ds_write_b128 v5, v[248:251] offset:25600
    ds_write_b128 v5, v[252:255] offset:26624
    ds_write_b32 v10, v84
    v_pk_mov_b32 v[16:17], v[112:113], v[112:113] op_sel:[0,1]
    v_pk_mov_b32 v[18:19], v[114:115], v[114:115] op_sel:[0,1]
    v_pk_mov_b32 v[20:21], v[116:117], v[116:117] op_sel:[0,1]
    v_pk_mov_b32 v[22:23], v[118:119], v[118:119] op_sel:[0,1]
    v_pk_mov_b32 v[24:25], v[120:121], v[120:121] op_sel:[0,1]
    v_pk_mov_b32 v[26:27], v[122:123], v[122:123] op_sel:[0,1]
    v_pk_mov_b32 v[28:29], v[124:125], v[124:125] op_sel:[0,1]
    v_pk_mov_b32 v[30:31], v[126:127], v[126:127] op_sel:[0,1]
    v_pk_mov_b32 v[32:33], v[128:129], v[128:129] op_sel:[0,1]
    v_pk_mov_b32 v[34:35], v[130:131], v[130:131] op_sel:[0,1]
    v_pk_mov_b32 v[36:37], v[132:133], v[132:133] op_sel:[0,1]
    v_pk_mov_b32 v[38:39], v[134:135], v[134:135] op_sel:[0,1]
    v_pk_mov_b32 v[40:41], v[136:137], v[136:137] op_sel:[0,1]
    v_pk_mov_b32 v[42:43], v[138:139], v[138:139] op_sel:[0,1]
    v_pk_mov_b32 v[44:45], v[140:141], v[140:141] op_sel:[0,1]
    v_pk_mov_b32 v[46:47], v[142:143], v[142:143] op_sel:[0,1]
    v_pk_mov_b32 v[48:49], v[144:145], v[144:145] op_sel:[0,1]
    v_pk_mov_b32 v[50:51], v[146:147], v[146:147] op_sel:[0,1]
L_f2_w0:
    s_cmp_lg_u32 s31, 1
    s_cbranch_scc1 L_f2_w1
    ds_write_b128 v5, v[184:187] offset:0
    ds_write_b128 v5, v[188:191] offset:1024
    ds_write_b128 v5, v[192:195] offset:2048
    ds_write_b128 v5, v[196:199] offset:3072
    ds_write_b128 v5, v[200:203] offset:4096
    ds_write_b128 v5, v[204:207] offset:5120
    ds_write_b128 v5, v[208:211] offset:6144
    ds_write_b128 v5, v[212:215] offset:7168
    ds_write_b128 v5, v[216:219] offset:8192
    ds_write_b128 v5, v[220:223] offset:9216
    ds_write_b128 v5, v[224:227] offset:10240
    ds_write_b128 v5, v[228:231] offset:11264
    ds_write_b128 v5, v[232:235] offset:12288
    ds_write_b128 v5, v[236:239] offset:13312
    ds_write_b128 v5, v[240:243] offset:14336
    ds_write_b128 v5, v[244:247] offset:15360
    ds_write_b128 v5, v[248:251] offset:16384
    ds_write_b128 v5, v[252:255] offset:17408
    ds_write_b128 v5, v[112:115] offset:18432
    ds_write_b128 v5, v[116:119] offset:19456
    ds_write_b128 v5, v[120:123] offset:20480
    ds_write_b128 v5, v[124:127] offset:21504
    ds_write_b128 v5, v[128:131] offset:22528
    ds_write_b128 v5, v[132:135] offset:23552
    ds_write_b128 v5, v[136:139] offset:24576
    ds_write_b128 v5, v[140:143] offset:25600
    ds_write_b128 v5, v[144:147] offset:26624
    ds_write_b32 v10, v84
    v_pk_mov_b32 v[16:17], v[148:149], v[148:149] op_sel:[0,1]
    v_pk_mov_b32 v[18:19], v[150:151], v[150:151] op_sel:[0,1]
    v_pk_mov_b32 v[20:21], v[152:153], v[152:153] op_sel:[0,1]
    v_pk_mov_b32 v[22:23], v[154:155], v[154:155] op_sel:[0,1]
    v_pk_mov_b32 v[24:25], v[156:157], v[156:157] op_sel:[0,1]
    v_pk_mov_b32 v[26:27], v[158:159], v[158:159] op_sel:[0,1]
    v_pk_mov_b32 v[28:29], v[160:161], v[160:161] op_sel:[0,1]
    v_pk_mov_b32 v[30:31], v[162:163], v[162:163] op_sel:[0,1]
    v_pk_mov_b32 v[32:33], v[164:165], v[164:165] op_sel:[0,1]
    v_pk_mov_b32 v[34:35], v[166:167], v[166:167] op_sel:[0,1]
    v_pk_mov_b32 v[36:37], v[168:169], v[168:169] op_sel:[0,1]
    v_pk_mov_b32 v[38:39], v[170:171], v[170:171] op_sel:[0,1]
    v_pk_mov_b32 v[40:41], v[172:173], v[172:173] op_sel:[0,1]
    v_pk_mov_b32 v[42:43], v[174:175], v[174:175] op_sel:[0,1]
    v_pk_mov_b32 v[44:45], v[176:177], v[176:177] op_sel:[0,1]
    v_pk_mov_b32 v[46:47], v[178:179], v[178:179] op_sel:[0,1]
    v_pk_mov_b32 v[48:49], v[180:181], v[180:181] op_sel:[0,1]
    v_pk_mov_b32 v[50:51], v[182:183], v[182:183] op_sel:[0,1]
L_f2_w1:
    s_cmp_lg_u32 s31, 2
    s_cbranch_scc1 L_f2_w2
    ds_write_b128 v5, v[220:223] offset:0
    ds_write_b128 v5, v[224:227] offset:1024
    ds_write_b128 v5, v[228:231] offset:2048
    ds_write_b128 v5, v[232:235] offset:3072
    ds_write_b128 v5, v[236:239] offset:4096
    ds_write_b128 v5, v[240:243] offset:5120
    ds_write_b128 v5, v[244:247] offset:6144
    ds_write_b128 v5, v[248:251] offset:7168
    ds_write_b128 v5, v[252:255] offset:8192
    ds_write_b128 v5, v[112:115] offset:9216
    ds_write_b128 v5, v[116:119] offset:10240
    ds_write_b128 v5, v[120:123] offset:11264
    ds_write_b128 v5, v[124:127] offset:12288
    ds_write_b128 v5, v[128:131] offset:13312
    ds_write_b128 v5, v[132:135] offset:14336
    ds_write_b128 v5, v[136:139] offset:15360
    ds_write_b128 v5, v[140:143] offset:16384
    ds_write_b128 v5, v[144:147] offset:17408
    ds_write_b128 v5, v[148:151] offset:18432
    ds_write_b128 v5, v[152:155] offset:19456
    ds_write_b128 v5, v[156:159] offset:20480
    ds_write_b128 v5, v[160:163] offset:21504
    ds_write_b128 v5, v[164:167] offset:22528
    ds_write_b128 v5, v[168:171] offset:23552
    ds_write_b128 v5, v[172:175] offset:24576
    ds_write_b128 v5, v[176:179] offset:25600
    ds_write_b128 v5, v[180:183] offset:26624
    ds_write_b32 v10, v84
    v_pk_mov_b32 v[16:17], v[184:185], v[184:185] op_sel:[0,1]
    v_pk_mov_b32 v[18:19], v[186:187], v[186:187] op_sel:[0,1]
    v_pk_mov_b32 v[20:21], v[188:189], v[188:189] op_sel:[0,1]
    v_pk_mov_b32 v[22:23], v[190:191], v[190:191] op_sel:[0,1]
    v_pk_mov_b32 v[24:25], v[192:193], v[192:193] op_sel:[0,1]
    v_pk_mov_b32 v[26:27], v[194:195], v[194:195] op_sel:[0,1]
    v_pk_mov_b32 v[28:29], v[196:197], v[196:197] op_sel:[0,1]
    v_pk_mov_b32 v[30:31], v[198:199], v[198:199] op_sel:[0,1]
    v_pk_mov_b32 v[32:33], v[200:201], v[200:201] op_sel:[0,1]
    v_pk_mov_b32 v[34:35], v[202:203], v[202:203] op_sel:[0,1]
    v_pk_mov_b32 v[36:37], v[204:205], v[204:205] op_sel:[0,1]
    v_pk_mov_b32 v[38:39], v[206:207], v[206:207] op_sel:[0,1]
    v_pk_mov_b32 v[40:41], v[208:209], v[208:209] op_sel:[0,1]
    v_pk_mov_b32 v[42:43], v[210:211], v[210:211] op_sel:[0,1]
    v_pk_mov_b32 v[44:45], v[212:213], v[212:213] op_sel:[0,1]
    v_pk_mov_b32 v[46:47], v[214:215], v[214:215] op_sel:[0,1]
    v_pk_mov_b32 v[48:49], v[216:217], v[216:217] op_sel:[0,1]
    v_pk_mov_b32 v[50:51], v[218:219], v[218:219] op_sel:[0,1]
L_f2_w2:
    s_cmp_lg_u32 s31, 3
    s_cbranch_scc1 L_f2_w3
    ds_write_b128 v5, v[112:115] offset:0
    ds_write_b128 v5, v[116:119] offset:1024
    ds_write_b128 v5, v[120:123] offset:2048
    ds_write_b128 v5, v[124:127] offset:3072
    ds_write_b128 v5, v[128:131] offset:4096
    ds_write_b128 v5, v[132:135] offset:5120
    ds_write_b128 v5, v[136:139] offset:6144
    ds_write_b128 v5, v[140:143] offset:7168
    ds_write_b128 v5, v[144:147] offset:8192
    ds_write_b128 v5, v[148:151] offset:9216
    ds_write_b128 v5, v[152:155] offset:10240
    ds_write_b128 v5, v[156:159] offset:11264
    ds_write_b128 v5, v[160:163] offset:12288
    ds_write_b128 v5, v[164:167] offset:13312
    ds_write_b128 v5, v[168:171] offset:14336
    ds_write_b128 v5, v[172:175] offset:15360
    ds_write_b128 v5, v[176:179] offset:16384
    ds_write_b128 v5, v[180:183] offset:17408
    ds_write_b128 v5, v[184:187] offset:18432
    ds_write_b128 v5, v[188:191] offset:19456
    ds_write_b128 v5, v[192:195] offset:20480
    ds_write_b128 v5, v[196:199] offset:21504
    ds_write_b128 v5, v[200:203] offset:22528
    ds_write_b128 v5, v[204:207] offset:23552
    ds_write_b128 v5, v[208:211] offset:24576
    ds_write_b128 v5, v[212:215] offset:25600
    ds_write_b128 v5, v[216:219] offset:26624
    ds_write_b32 v10, v84
    v_pk_mov_b32 v[16:17], v[220:221], v[220:221] op_sel:[0,1]
    v_pk_mov_b32 v[18:19], v[222:223], v[222:223] op_sel:[0,1]
    v_pk_mov_b32 v[20:21], v[224:225], v[224:225] op_sel:[0,1]
    v_pk_mov_b32 v[22:23], v[226:227], v[226:227] op_sel:[0,1]
    v_pk_mov_b32 v[24:25], v[228:229], v[228:229] op_sel:[0,1]
    v_pk_mov_b32 v[26:27], v[230:231], v[230:231] op_sel:[0,1]
    v_pk_mov_b32 v[28:29], v[232:233], v[232:233] op_sel:[0,1]
    v_pk_mov_b32 v[30:31], v[234:235], v[234:235] op_sel:[0,1]
    v_pk_mov_b32 v[32:33], v[236:237], v[236:237] op_sel:[0,1]
    v_pk_mov_b32 v[34:35], v[238:239], v[238:239] op_sel:[0,1]
    v_pk_mov_b32 v[36:37], v[240:241], v[240:241] op_sel:[0,1]
    v_pk_mov_b32 v[38:39], v[242:243], v[242:243] op_sel:[0,1]
    v_pk_mov_b32 v[40:41], v[244:245], v[244:245] op_sel:[0,1]
    v_pk_mov_b32 v[42:43], v[246:247], v[246:247] op_sel:[0,1]
    v_pk_mov_b32 v[44:45], v[248:249], v[248:249] op_sel:[0,1]
    v_pk_mov_b32 v[46:47], v[250:251], v[250:251] op_sel:[0,1]
    v_pk_mov_b32 v[48:49], v[252:253], v[252:253] op_sel:[0,1]
    v_pk_mov_b32 v[50:51], v[254:255], v[254:255] op_sel:[0,1]
L_f2_w3:
    v_lshlrev_b32 v96, 16, v100
    v_and_b32 v97, s65, v100
    v_lshlrev_b32 v98, 16, v101
    v_and_b32 v99, s65, v101
    v_pk_add_f32 v[16:17], v[16:17], v[96:97]
    v_pk_add_f32 v[18:19], v[18:19], v[98:99]
    v_lshlrev_b32 v96, 16, v102
    v_and_b32 v97, s65, v102
    v_lshlrev_b32 v98, 16, v103
    v_and_b32 v99, s65, v103
    v_pk_add_f32 v[20:21], v[20:21], v[96:97]
    v_pk_add_f32 v[22:23], v[22:23], v[98:99]
    v_lshlrev_b32 v96, 16, v104
    v_and_b32 v97, s65, v104
    v_lshlrev_b32 v98, 16, v105
    v_and_b32 v99, s65, v105
    v_pk_add_f32 v[24:25], v[24:25], v[96:97]
    v_pk_add_f32 v[26:27], v[26:27], v[98:99]
    v_lshlrev_b32 v96, 16, v106
    v_and_b32 v97, s65, v106
    v_lshlrev_b32 v98, 16, v107
    v_and_b32 v99, s65, v107
    v_pk_add_f32 v[28:29], v[28:29], v[96:97]
    v_pk_add_f32 v[30:31], v[30:31], v[98:99]
    v_lshlrev_b32 v96, 16, v108
    v_and_b32 v97, s65, v108
    v_lshlrev_b32 v98, 16, v109
    v_and_b32 v99, s65, v109
    v_pk_add_f32 v[48:49], v[48:49], v[96:97]
    v_pk_add_f32 v[50:51], v[50:51], v[98:99]
    s_setprio 2
    s_mov_b32 s100, 1600000
    v_mov_b32 v88, 162832
L_parall_lw_10:
    ds_read_b128 v[84:87], v88
    s_waitcnt lgkmcnt(0)
    v_min3_u32 v84, v84, v85, v86
    v_min_u32 v84, v84, v87
    s_nop 0
    v_readfirstlane_b32 s101, v84
    s_cmp_ge_u32 s101, 8
    s_cbranch_scc1 L_parall_lw_10_ok
    s_sleep 1
    s_sub_u32 s100, s100, 1
    s_cbranch_scc0 L_parall_lw_10
L_parall_lw_10_ok:
    ds_read_b128 v[112:115], v6 offset:4096
    ds_read_b128 v[116:119], v7 offset:4096
    ds_read_b128 v[120:123], v8 offset:4096
    ds_read_b128 v[124:127], v6 offset:5120
    ds_read_b128 v[128:131], v7 offset:5120
    ds_read_b128 v[132:135], v8 offset:5120
    ds_read_b128 v[136:139], v6 offset:6144
    ds_read_b128 v[140:143], v7 offset:6144
    ds_read_b128 v[144:147], v8 offset:6144
    ds_read_b128 v[148:151], v6 offset:7168
    ds_read_b128 v[152:155], v7 offset:7168
    ds_read_b128 v[156:159], v8 offset:7168
    ds_read_b128 v[160:163], v6 offset:8192
    ds_read_b128 v[164:167], v7 offset:8192
    ds_read_b128 v[168:171], v8 offset:8192
    s_waitcnt lgkmcnt(12)
    v_pk_add_f32 v[32:33], v[32:33], v[112:113]
    v_pk_add_f32 v[34:35], v[34:35], v[114:115]
    v_pk_add_f32 v[32:33], v[32:33], v[116:117]
    v_pk_add_f32 v[34:35], v[34:35], v[118:119]
    v_pk_add_f32 v[32:33], v[32:33], v[120:121]
    v_pk_add_f32 v[34:35], v[34:35], v[122:123]
    buffer_store_dwordx4 v[32:35], v1, s[20:23], s42 offen offset:0 sc1
    ds_read_b128 v[172:175], v6 offset:0
    ds_read_b128 v[176:179], v7 offset:0
    ds_read_b128 v[180:183], v8 offset:0
    s_waitcnt lgkmcnt(12)
    v_pk_add_f32 v[36:37], v[36:37], v[124:125]
    v_pk_add_f32 v[38:39], v[38:39], v[126:127]
    v_pk_add_f32 v[36:37], v[36:37], v[128:129]
    v_pk_add_f32 v[38:39], v[38:39], v[130:131]
    v_pk_add_f32 v[36:37], v[36:37], v[132:133]
    v_pk_add_f32 v[38:39], v[38:39], v[134:135]
    buffer_store_dwordx4 v[36:39], v1, s[20:23], s42 offen offset:1024 sc1
    ds_read_b128 v[184:187], v6 offset:1024
    ds_read_b128 v[188:191], v7 offset:1024
    ds_read_b128 v[192:195], v8 offset:1024
    s_waitcnt lgkmcnt(12)
    v_pk_add_f32 v[40:41], v[40:41], v[136:137]
    v_pk_add_f32 v[42:43], v[42:43], v[138:139]
    v_pk_add_f32 v[40:41], v[40:41], v[140:141]
    v_pk_add_f32 v[42:43], v[42:43], v[142:143]
    v_pk_add_f32 v[40:41], v[40:41], v[144:145]
    v_pk_add_f32 v[42:43], v[42:43], v[146:147]
    buffer_store_dwordx4 v[40:43], v1, s[20:23], s42 offen offset:2048 sc1
    ds_read_b128 v[196:199], v6 offset:2048
    ds_read_b128 v[200:203], v7 offset:2048
    ds_read_b128 v[204:207], v8 offset:2048
    s_waitcnt lgkmcnt(12)
    v_pk_add_f32 v[44:45], v[44:45], v[148:149]
    v_pk_add_f32 v[46:47], v[46:47], v[150:151]
    v_pk_add_f32 v[44:45], v[44:45], v[152:153]
    v_pk_add_f32 v[46:47], v[46:47], v[154:155]
    v_pk_add_f32 v[44:45], v[44:45], v[156:157]
    v_pk_add_f32 v[46:47], v[46:47], v[158:159]
    buffer_store_dwordx4 v[44:47], v1, s[20:23], s42 offen offset:3072 sc1
    ds_read_b128 v[208:211], v6 offset:3072
    ds_read_b128 v[212:215], v7 offset:3072
    ds_read_b128 v[216:219], v8 offset:3072
    s_waitcnt lgkmcnt(12)
    v_pk_add_f32 v[48:49], v[48:49], v[160:161]
    v_pk_add_f32 v[50:51], v[50:51], v[162:163]
    v_pk_add_f32 v[48:49], v[48:49], v[164:165]
    v_pk_add_f32 v[50:51], v[50:51], v[166:167]
    v_pk_add_f32 v[48:49], v[48:49], v[168:169]
    v_pk_add_f32 v[50:51], v[50:51], v[170:171]
    buffer_store_dwordx4 v[48:51], v1, s[20:23], s43 offen sc1
    s_waitcnt lgkmcnt(9)
    v_pk_add_f32 v[16:17], v[16:17], v[172:173]
    v_pk_add_f32 v[18:19], v[18:19], v[174:175]
    v_pk_add_f32 v[16:17], v[16:17], v[176:177]
    v_pk_add_f32 v[18:19], v[18:19], v[178:179]
    v_pk_add_f32 v[16:17], v[16:17], v[180:181]
    v_pk_add_f32 v[18:19], v[18:19], v[182:183]
    s_waitcnt lgkmcnt(6)
    v_pk_add_f32 v[20:21], v[20:21], v[184:185]
    v_pk_add_f32 v[22:23], v[22:23], v[186:187]
    v_pk_add_f32 v[20:21], v[20:21], v[188:189]
    v_pk_add_f32 v[22:23], v[22:23], v[190:191]
    v_pk_add_f32 v[20:21], v[20:21], v[192:193]
    v_pk_add_f32 v[22:23], v[22:23], v[194:195]
    s_waitcnt lgkmcnt(3)
    v_pk_add_f32 v[24:25], v[24:25], v[196:197]
    v_pk_add_f32 v[26:27], v[26:27], v[198:199]
    v_pk_add_f32 v[24:25], v[24:25], v[200:201]
    v_pk_add_f32 v[26:27], v[26:27], v[202:203]
    v_pk_add_f32 v[24:25], v[24:25], v[204:205]
    v_pk_add_f32 v[26:27], v[26:27], v[206:207]
    s_waitcnt lgkmcnt(0)
    v_pk_add_f32 v[28:29], v[28:29], v[208:209]
    v_pk_add_f32 v[30:31], v[30:31], v[210:211]
    v_pk_add_f32 v[28:29], v[28:29], v[212:213]
    v_pk_add_f32 v[30:31], v[30:31], v[214:215]
    v_pk_add_f32 v[28:29], v[28:29], v[216:217]
    v_pk_add_f32 v[30:31], v[30:31], v[218:219]
    s_sub_u32 s3, s31, 1
    s_and_b32 s3, s3, 3
    s_mul_i32 s50, s3, 3
    s_add_u32 s50, s50, 0
    s_mul_i32 s49, s50, 9216
    s_add_u32 s49, s49, 40960
    s_lshr_b32 s3, s50, 1
    s_lshl_b32 s61, s56, 2
    s_add_u32 s61, s61, s3
    s_cmp_eq_u32 s3, 4
    s_cselect_b32 s61, 8, s61
    s_lshl_b32 s61, s61, 10
    s_add_u32 s61, s61, s48
    s_and_b32 s3, s50, 1
    s_mul_i32 s3, s3, 331776
    s_add_u32 s61, s61, s3
    s_cmp_lt_u32 s50, 10
    s_cselect_b32 s61, s61, 0x7f000000
    s_add_u32 m0, s49, 0
    s_nop 0
    buffer_load_dwordx4 v1, s[20:23], s61 offen sc1 lds
    s_add_u32 s61, s61, 36864
    s_waitcnt vmcnt(4)
    s_add_u32 m0, s49, 1024
    s_nop 0
    buffer_load_dwordx4 v1, s[20:23], s61 offen sc1 lds
    s_add_u32 s61, s61, 36864
    s_waitcnt vmcnt(4)
    s_add_u32 m0, s49, 2048
    s_nop 0
    buffer_load_dwordx4 v1, s[20:23], s61 offen sc1 lds
    s_add_u32 s61, s61, 36864
    s_waitcnt vmcnt(4)
    s_add_u32 m0, s49, 3072
    s_nop 0
    buffer_load_dwordx4 v1, s[20:23], s61 offen sc1 lds
    s_add_u32 s61, s61, 36864
    s_waitcnt vmcnt(4)
    s_waitcnt vmcnt(4)
    buffer_store_dword v14, v13, s[20:23], s51 offen offset:0 sc0 sc1
    s_add_u32 m0, s49, 4096
    s_nop 0
    buffer_load_dwordx4 v1, s[20:23], s61 offen sc1 lds
    s_add_u32 s61, s61, 36864
    s_waitcnt vmcnt(4)
    s_add_u32 m0, s49, 5120
    s_nop 0
    buffer_load_dwordx4 v1, s[20:23], s61 offen sc1 lds
    s_add_u32 s61, s61, 36864
    s_waitcnt vmcnt(4)
    s_add_u32 m0, s49, 6144
    s_nop 0
    buffer_load_dwordx4 v1, s[20:23], s61 offen sc1 lds
    s_add_u32 s61, s61, 36864
    s_waitcnt vmcnt(4)
    s_add_u32 m0, s49, 7168
    s_nop 0
    buffer_load_dwordx4 v1, s[20:23], s61 offen sc1 lds
    s_add_u32 s61, s61, 36864
    s_waitcnt vmcnt(4)
    s_add_u32 m0, s49, 8192
    s_nop 0
    buffer_load_dwordx4 v1, s[20:23], s61 offen sc1 lds
    s_add_u32 s61, s61, 36864
    s_waitcnt vmcnt(4)
    s_sub_u32 s3, s31, 2
    s_and_b32 s3, s3, 3
    s_mul_i32 s50, s3, 3
    s_add_u32 s50, s50, 1
    s_mul_i32 s49, s50, 9216
    s_add_u32 s49, s49, 40960
    s_lshr_b32 s3, s50, 1
    s_lshl_b32 s61, s56, 2
    s_add_u32 s61, s61, s3
    s_cmp_eq_u32 s3, 4
    s_cselect_b32 s61, 8, s61
    s_lshl_b32 s61, s61, 10
    s_add_u32 s61, s61, s48
    s_and_b32 s3, s50, 1
    s_mul_i32 s3, s3, 331776
    s_add_u32 s61, s61, s3
    s_cmp_lt_u32 s50, 10
    s_cselect_b32 s61, s61, 0x7f000000
    s_add_u32 m0, s49, 0
    s_nop 0
    buffer_load_dwordx4 v1, s[20:23], s61 offen sc1 lds
    s_add_u32 s61, s61, 36864
    s_waitcnt vmcnt(4)
    s_add_u32 m0, s49, 1024
    s_nop 0
    buffer_load_dwordx4 v1, s[20:23], s61 offen sc1 lds
    s_add_u32 s61, s61, 36864
    s_waitcnt vmcnt(4)
    s_add_u32 m0, s49, 2048
    s_nop 0
    buffer_load_dwordx4 v1, s[20:23], s61 offen sc1 lds
    s_add_u32 s61, s61, 36864
    s_waitcnt vmcnt(4)
    s_add_u32 m0, s49, 3072
    s_nop 0
    buffer_load_dwordx4 v1, s[20:23], s61 offen sc1 lds
    s_add_u32 s61, s61, 36864
    s_waitcnt vmcnt(4)
    s_add_u32 m0, s49, 4096
    s_nop 0
    buffer_load_dwordx4 v1, s[20:23], s61 offen sc1 lds
    s_add_u32 s61, s61, 36864
    s_waitcnt vmcnt(4)
    s_add_u32 m0, s49, 5120
    s_nop 0
    buffer_load_dwordx4 v1, s[20:23], s61 offen sc1 lds
    s_add_u32 s61, s61, 36864
    s_waitcnt vmcnt(4)
    s_add_u32 m0, s49, 6144
    s_nop 0
    buffer_load_dwordx4 v1, s[20:23], s61 offen sc1 lds
    s_add_u32 s61, s61, 36864
    s_waitcnt vmcnt(4)
    s_add_u32 m0, s49, 7168
    s_nop 0
    buffer_load_dwordx4 v1, s[20:23], s61 offen sc1 lds
    s_add_u32 s61, s61, 36864
    s_waitcnt vmcnt(4)
    s_add_u32 m0, s49, 8192
    s_nop 0
    buffer_load_dwordx4 v1, s[20:23], s61 offen sc1 lds
    s_add_u32 s61, s61, 36864
    s_waitcnt vmcnt(4)
    s_sub_u32 s3, s31, 3
    s_and_b32 s3, s3, 3
    s_mul_i32 s50, s3, 3
    s_add_u32 s50, s50, 2
    s_mul_i32 s49, s50, 9216
    s_add_u32 s49, s49, 40960
    s_lshr_b32 s3, s50, 1
    s_lshl_b32 s61, s56, 2
    s_add_u32 s61, s61, s3
    s_cmp_eq_u32 s3, 4
    s_cselect_b32 s61, 8, s61
    s_lshl_b32 s61, s61, 10
    s_add_u32 s61, s61, s48
    s_and_b32 s3, s50, 1
    s_mul_i32 s3, s3, 331776
    s_add_u32 s61, s61, s3
    s_cmp_lt_u32 s50, 10
    s_cselect_b32 s61, s61, 0x7f000000
    s_add_u32 m0, s49, 0
    s_nop 0
    buffer_load_dwordx4 v1, s[20:23], s61 offen sc1 lds
    s_add_u32 s61, s61, 36864
    s_waitcnt vmcnt(4)
    s_add_u32 m0, s49, 1024
    s_nop 0
    buffer_load_dwordx4 v1, s[20:23], s61 offen sc1 lds
    s_add_u32 s61, s61, 36864
    s_waitcnt vmcnt(4)
    s_add_u32 m0, s49, 2048
    s_nop 0
    buffer_load_dwordx4 v1, s[20:23], s61 offen sc1 lds
    s_add_u32 s61, s61, 36864
    s_waitcnt vmcnt(4)
    s_add_u32 m0, s49, 3072
    s_nop 0
    buffer_load_dwordx4 v1, s[20:23], s61 offen sc1 lds
    s_add_u32 s61, s61, 36864
    s_waitcnt vmcnt(4)
    s_add_u32 m0, s49, 4096
    s_nop 0
    buffer_load_dwordx4 v1, s[20:23], s61 offen sc1 lds
    s_add_u32 s61, s61, 36864
    s_waitcnt vmcnt(4)
    s_add_u32 m0, s49, 5120
    s_nop 0
    buffer_load_dwordx4 v1, s[20:23], s61 offen sc1 lds
    s_add_u32 s61, s61, 36864
    s_waitcnt vmcnt(4)
    s_add_u32 m0, s49, 6144
    s_nop 0
    buffer_load_dwordx4 v1, s[20:23], s61 offen sc1 lds
    s_add_u32 s61, s61, 36864
    s_waitcnt vmcnt(4)
    s_add_u32 m0, s49, 7168
    s_nop 0
    buffer_load_dwordx4 v1, s[20:23], s61 offen sc1 lds
    s_add_u32 s61, s61, 36864
    s_waitcnt vmcnt(4)
    s_add_u32 m0, s49, 8192
    s_nop 0
    buffer_load_dwordx4 v1, s[20:23], s61 offen sc1 lds
    s_add_u32 s61, s61, 36864
    s_waitcnt vmcnt(4)
    v_add_u32 v6, 40960, v1
    v_add_u32 v7, 96256, v1
    s_add_u32 s56, s55, 4096
    s_add_u32 s57, s55, 8192
    s_add_u32 s58, s55, 12288
    s_add_u32 s59, s55, 16384
    s_mov_b32 s100, 100000
L_parall_poll_11:
    buffer_load_dword v84, v13, s[20:23], s47 offen sc0 sc1
    s_waitcnt vmcnt(0)
    v_cmp_eq_u32 vcc, s99, v84
    s_nop 3
    s_bcnt1_i32_b64 s101, vcc
    s_cmp_eq_u32 s101, 1
    s_cbranch_scc1 L_parall_poll_11_ok
    s_sub_u32 s100, s100, 1
    s_cbranch_scc1 L_parall_poll_11_ok
    s_sleep 8
    s_branch L_parall_poll_11
L_parall_poll_11_ok:
    v_mov_b32 v84, 9
    ds_write_b32 v10, v84
    buffer_load_dwordx4 v[32:35], v1, s[20:23], s52 offen offset:0 sc1
    buffer_load_dwordx4 v[36:39], v1, s[20:23], s52 offen offset:1024 sc1
    buffer_load_dwordx4 v[40:43], v1, s[20:23], s52 offen offset:2048 sc1
    buffer_load_dwordx4 v[44:47], v1, s[20:23], s52 offen offset:3072 sc1
    buffer_load_dwordx4 v[52:55], v1, s[20:23], s53 offen sc1
    s_mov_b32 s100, 1600000
    v_mov_b32 v180, 162832
L_parall_lw_12:
    ds_read_b128 v[176:179], v180
    s_waitcnt lgkmcnt(0)
    v_min3_u32 v176, v176, v177, v178
    v_min_u32 v176, v176, v179
    s_nop 0
    v_readfirstlane_b32 s101, v176
    s_cmp_ge_u32 s101, 9
    s_cbranch_scc1 L_parall_lw_12_ok
    s_sleep 1
    s_sub_u32 s100, s100, 1
    s_cbranch_scc0 L_parall_lw_12
L_parall_lw_12_ok:
    ds_read_b128 v[56:59], v6 offset:0
    ds_read_b128 v[60:63], v6 offset:18432
    ds_read_b128 v[64:67], v6 offset:36864
    ds_read_b128 v[68:71], v7 offset:0
    ds_read_b128 v[72:75], v7 offset:18432
    ds_read_b128 v[76:79], v6 offset:1024
    ds_read_b128 v[80:83], v6 offset:19456
    ds_read_b128 v[84:87], v6 offset:37888
    ds_read_b128 v[88:91], v7 offset:1024
    ds_read_b128 v[92:95], v7 offset:19456
    s_waitcnt lgkmcnt(5)
    ds_read_b128 v[96:99], v6 offset:2048
    ds_read_b128 v[100:103], v6 offset:20480
    ds_read_b128 v[104:107], v6 offset:38912
    ds_read_b128 v[108:111], v7 offset:2048
    ds_read_b128 v[112:115], v7 offset:20480
    ds_read_b128 v[116:119], v6 offset:3072
    ds_read_b128 v[120:123], v6 offset:21504
    ds_read_b128 v[124:127], v6 offset:39936
    ds_read_b128 v[128:131], v7 offset:3072
    ds_read_b128 v[132:135], v7 offset:21504
    s_waitcnt lgkmcnt(5)
    ds_read_b128 v[136:139], v6 offset:4096
    ds_read_b128 v[140:143], v6 offset:22528
    ds_read_b128 v[144:147], v6 offset:40960
    ds_read_b128 v[148:151], v7 offset:4096
    ds_read_b128 v[152:155], v7 offset:22528
    ds_read_b128 v[156:159], v6 offset:5120
    ds_read_b128 v[160:163], v6 offset:23552
    ds_read_b128 v[164:167], v6 offset:41984
    ds_read_b128 v[168:171], v7 offset:5120
    ds_read_b128 v[172:175], v7 offset:23552
    s_waitcnt lgkmcnt(5)
    s_waitcnt lgkmcnt(0)
    s_waitcnt vmcnt(0)
    v_pk_add_f32 v[16:17], v[16:17], v[32:33]
    v_pk_add_f32 v[18:19], v[18:19], v[34:35]
    v_pk_add_f32 v[20:21], v[20:21], v[36:37]
    v_pk_add_f32 v[22:23], v[22:23], v[38:39]
    v_pk_add_f32 v[24:25], v[24:25], v[40:41]
    v_pk_add_f32 v[26:27], v[26:27], v[42:43]
    v_pk_add_f32 v[28:29], v[28:29], v[44:45]
    v_pk_add_f32 v[30:31], v[30:31], v[46:47]
    v_pk_add_f32 v[48:49], v[48:49], v[52:53]
    v_pk_add_f32 v[50:51], v[50:51], v[54:55]
    s_bitcmp1_b32 s31, 0
    s_cbranch_scc1 L_f2_ow
    s_mov_b32 s100, 1600000
    v_mov_b32 v180, 162816
L_parall_lw_13:
    ds_read_b128 v[176:179], v180
    s_waitcnt lgkmcnt(0)
    v_min3_u32 v176, v176, v177, v178
    v_min_u32 v176, v176, v179
    s_nop 0
    v_readfirstlane_b32 s101, v176
    s_cmp_ge_u32 s101, 6
    s_cbranch_scc1 L_parall_lw_13_ok
    s_sleep 2
    s_sub_u32 s100, s100, 1
    s_cbranch_scc0 L_parall_lw_13
L_parall_lw_13_ok:
    s_mov_b32 s100, 100000
L_parall_poll_14:
    buffer_load_dword v176, v4, s[20:23], s54 offen sc0 sc1
    s_waitcnt vmcnt(0)
    v_cmp_eq_u32 vcc, s99, v176
    s_nop 3
    s_bcnt1_i32_b64 s101, vcc
    s_cmp_eq_u32 s101, 32
    s_cbranch_scc1 L_parall_poll_14_ok
    s_sub_u32 s100, s100, 1
    s_cbranch_scc1 L_parall_poll_14_ok
    s_sleep 2
    s_branch L_parall_poll_14
L_parall_poll_14_ok:
    v_mov_b32 v176, 10
    ds_write_b32 v10, v176
    s_branch L_f2_ok
L_f2_ow:
    s_mov_b32 s100, 6400000
    v_subrev_u32 v180, 4, v10
L_f2_ow1:
    s_sleep 1
    ds_read_b32 v176, v180
    s_waitcnt lgkmcnt(0)
    v_readfirstlane_b32 s101, v176
    s_cmp_ge_u32 s101, 10
    s_cbranch_scc1 L_f2_ok
    s_sub_u32 s100, s100, 1
    s_cbranch_scc0 L_f2_ow1
L_f2_ok:
    s_waitcnt lgkmcnt(0)
    s_mov_b32 s63, 100000
    buffer_load_dwordx4 v[184:187], v1, s[20:23], s55 offen offset:0 sc1
    buffer_load_dwordx4 v[188:191], v1, s[20:23], s55 offen offset:1024 sc1
    buffer_load_dwordx4 v[192:195], v1, s[20:23], s55 offen offset:2048 sc1
    buffer_load_dwordx4 v[196:199], v1, s[20:23], s55 offen offset:3072 sc1
    buffer_load_dwordx4 v[200:203], v1, s[20:23], s56 offen offset:0 sc1
    buffer_load_dwordx4 v[204:207], v1, s[20:23], s56 offen offset:1024 sc1
    buffer_load_dwordx4 v[208:211], v1, s[20:23], s56 offen offset:2048 sc1
    buffer_load_dwordx4 v[212:215], v1, s[20:23], s56 offen offset:3072 sc1
    buffer_load_dwordx4 v[216:219], v1, s[20:23], s57 offen offset:0 sc1
    buffer_load_dwordx4 v[220:223], v1, s[20:23], s57 offen offset:1024 sc1
    buffer_load_dwordx4 v[224:227], v1, s[20:23], s57 offen offset:2048 sc1
    buffer_load_dwordx4 v[228:231], v1, s[20:23], s57 offen offset:3072 sc1
    buffer_load_dwordx4 v[232:235], v1, s[20:23], s58 offen offset:0 sc1
    buffer_load_dwordx4 v[236:239], v1, s[20:23], s58 offen offset:1024 sc1
    buffer_load_dwordx4 v[240:243], v1, s[20:23], s58 offen offset:2048 sc1
    buffer_load_dwordx4 v[244:247], v1, s[20:23], s58 offen offset:3072 sc1
    buffer_load_dwordx4 v[248:251], v1, s[20:23], s59 offen offset:0 sc1
    buffer_load_dwordx4 v[252:255], v1, s[20:23], s59 offen offset:1024 sc1
    s_waitcnt vmcnt(17)
    v_max3_u32 v176, v184, v185, v186
    v_max_u32 v176, v176, v187
    v_cmp_eq_u32 vcc, -1, v176
    s_cbranch_vccnz L_f2_r0
L_f2_g0:
    s_waitcnt lgkmcnt(0)
    v_mfma_f32_16x16x32_bf16 v[16:19], v[56:59], v[184:187], v[16:19]
    v_mfma_f32_16x16x32_bf16 v[20:23], v[60:63], v[184:187], v[20:23]
    v_mfma_f32_16x16x32_bf16 v[24:27], v[64:67], v[184:187], v[24:27]
    s_waitcnt vmcnt(16)
    v_max3_u32 v176, v188, v189, v190
    v_max_u32 v176, v176, v191
    v_cmp_eq_u32 vcc, -1, v176
    v_mfma_f32_16x16x32_bf16 v[28:31], v[68:71], v[184:187], v[28:31]
    v_mfma_f32_16x16x32_bf16 v[48:51], v[72:75], v[184:187], v[48:51]
    ds_read_b128 v[56:59], v6 offset:6144
    ds_read_b128 v[60:63], v6 offset:24576
    ds_read_b128 v[64:67], v6 offset:43008
    ds_read_b128 v[68:71], v7 offset:6144
    ds_read_b128 v[72:75], v7 offset:24576
    s_cbranch_vccnz L_f2_r1
L_f2_g1:
    s_waitcnt lgkmcnt(5)
    v_mfma_f32_16x16x32_bf16 v[16:19], v[76:79], v[188:191], v[16:19]
    v_mfma_f32_16x16x32_bf16 v[20:23], v[80:83], v[188:191], v[20:23]
    v_mfma_f32_16x16x32_bf16 v[24:27], v[84:87], v[188:191], v[24:27]
    s_waitcnt vmcnt(15)
    v_max3_u32 v176, v192, v193, v194
    v_max_u32 v176, v176, v195
    v_cmp_eq_u32 vcc, -1, v176
    v_mfma_f32_16x16x32_bf16 v[28:31], v[88:91], v[188:191], v[28:31]
    v_mfma_f32_16x16x32_bf16 v[48:51], v[92:95], v[188:191], v[48:51]
    ds_read_b128 v[76:79], v6 offset:7168
    ds_read_b128 v[80:83], v6 offset:25600
    ds_read_b128 v[84:87], v6 offset:44032
    ds_read_b128 v[88:91], v7 offset:7168
    ds_read_b128 v[92:95], v7 offset:25600
    s_cbranch_vccnz L_f2_r2
L_f2_g2:
    s_waitcnt lgkmcnt(10)
    v_mfma_f32_16x16x32_bf16 v[16:19], v[96:99], v[192:195], v[16:19]
    v_mfma_f32_16x16x32_bf16 v[20:23], v[100:103], v[192:195], v[20:23]
    v_mfma_f32_16x16x32_bf16 v[24:27], v[104:107], v[192:195], v[24:27]
    s_waitcnt vmcnt(14)
    v_max3_u32 v176, v196, v197, v198
    v_max_u32 v176, v176, v199
    v_cmp_eq_u32 vcc, -1, v176
    v_mfma_f32_16x16x32_bf16 v[28:31], v[108:111], v[192:195], v[28:31]
    v_mfma_f32_16x16x32_bf16 v[48:51], v[112:115], v[192:195], v[48:51]
    ds_read_b128 v[96:99], v6 offset:8192
    ds_read_b128 v[100:103], v6 offset:26624
    ds_read_b128 v[104:107], v6 offset:45056
    ds_read_b128 v[108:111], v7 offset:8192
    ds_read_b128 v[112:115], v7 offset:26624
    s_cbranch_vccnz L_f2_r3
L_f2_g3:
    s_waitcnt lgkmcnt(15)
    v_mfma_f32_16x16x32_bf16 v[16:19], v[116:119], v[196:199], v[16:19]
    v_mfma_f32_16x16x32_bf16 v[20:23], v[120:123], v[196:199], v[20:23]
    v_mfma_f32_16x16x32_bf16 v[24:27], v[124:127], v[196:199], v[24:27]
    s_waitcnt vmcnt(13)
    v_max3_u32 v176, v200, v201, v202
    v_max_u32 v176, v176, v203
    v_cmp_eq_u32 vcc, -1, v176
    v_mfma_f32_16x16x32_bf16 v[28:31], v[128:131], v[196:199], v[28:31]
    v_mfma_f32_16x16x32_bf16 v[48:51], v[132:135], v[196:199], v[48:51]
    s_waitcnt lgkmcnt(10)
    ds_read_b128 v[116:119], v6 offset:9216
    ds_read_b128 v[120:123], v6 offset:27648
    ds_read_b128 v[124:127], v6 offset:46080
    ds_read_b128 v[128:131], v7 offset:9216
    ds_read_b128 v[132:135], v7 offset:27648
    s_cbranch_vccnz L_f2_r4
L_f2_g4:
    s_waitcnt lgkmcnt(15)
    v_mfma_f32_16x16x32_bf16 v[16:19], v[136:139], v[200:203], v[16:19]
    v_mfma_f32_16x16x32_bf16 v[20:23], v[140:143], v[200:203], v[20:23]
    v_mfma_f32_16x16x32_bf16 v[24:27], v[144:147], v[200:203], v[24:27]
    s_waitcnt vmcnt(12)
    v_max3_u32 v176, v204, v205, v206
    v_max_u32 v176, v176, v207
    v_cmp_eq_u32 vcc, -1, v176
    v_mfma_f32_16x16x32_bf16 v[28:31], v[148:151], v[200:203], v[28:31]
    v_mfma_f32_16x16x32_bf16 v[48:51], v[152:155], v[200:203], v[48:51]
    s_waitcnt lgkmcnt(10)
    ds_read_b128 v[136:139], v6 offset:10240
    ds_read_b128 v[140:143], v6 offset:28672
    ds_read_b128 v[144:147], v6 offset:47104
    ds_read_b128 v[148:151], v7 offset:10240
    ds_read_b128 v[152:155], v7 offset:28672
    s_cbranch_vccnz L_f2_r5
L_f2_g5:
    s_waitcnt lgkmcnt(15)
    v_mfma_f32_16x16x32_bf16 v[16:19], v[156:159], v[204:207], v[16:19]
    v_mfma_f32_16x16x32_bf16 v[20:23], v[160:163], v[204:207], v[20:23]
    v_mfma_f32_16x16x32_bf16 v[24:27], v[164:167], v[204:207], v[24:27]
    s_waitcnt vmcnt(11)
    v_max3_u32 v176, v208, v209, v210
    v_max_u32 v176, v176, v211
    v_cmp_eq_u32 vcc, -1, v176
    v_mfma_f32_16x16x32_bf16 v[28:31], v[168:171], v[204:207], v[28:31]
    v_mfma_f32_16x16x32_bf16 v[48:51], v[172:175], v[204:207], v[48:51]
    s_waitcnt lgkmcnt(10)
    ds_read_b128 v[156:159], v6 offset:11264
    ds_read_b128 v[160:163], v6 offset:29696
    ds_read_b128 v[164:167], v6 offset:48128
    ds_read_b128 v[168:171], v7 offset:11264
    ds_read_b128 v[172:175], v7 offset:29696
    s_cbranch_vccnz L_f2_r6
L_f2_g6:
    s_waitcnt lgkmcnt(15)
    v_mfma_f32_16x16x32_bf16 v[16:19], v[56:59], v[208:211], v[16:19]
    v_mfma_f32_16x16x32_bf16 v[20:23], v[60:63], v[208:211], v[20:23]
    v_mfma_f32_16x16x32_bf16 v[24:27], v[64:67], v[208:211], v[24:27]
    s_waitcnt vmcnt(10)
    v_max3_u32 v176, v212, v213, v214
    v_max_u32 v176, v176, v215
    v_cmp_eq_u32 vcc, -1, v176
    v_mfma_f32_16x16x32_bf16 v[28:31], v[68:71], v[208:211], v[28:31]
    v_mfma_f32_16x16x32_bf16 v[48:51], v[72:75], v[208:211], v[48:51]
    s_waitcnt lgkmcnt(10)
    ds_read_b128 v[56:59], v6 offset:12288
    ds_read_b128 v[60:63], v6 offset:30720
    ds_read_b128 v[64:67], v6 offset:49152
    ds_read_b128 v[68:71], v7 offset:12288
    ds_read_b128 v[72:75], v7 offset:30720
    s_cbranch_vccnz L_f2_r7
L_f2_g7:
    s_waitcnt lgkmcnt(15)
    v_mfma_f32_16x16x32_bf16 v[16:19], v[76:79], v[212:215], v[16:19]
    v_mfma_f32_16x16x32_bf16 v[20:23], v[80:83], v[212:215], v[20:23]
    v_mfma_f32_16x16x32_bf16 v[24:27], v[84:87], v[212:215], v[24:27]
    s_waitcnt vmcnt(9)
    v_max3_u32 v176, v216, v217, v218
    v_max_u32 v176, v176, v219
    v_cmp_eq_u32 vcc, -1, v176
    v_mfma_f32_16x16x32_bf16 v[28:31], v[88:91], v[212:215], v[28:31]
    v_mfma_f32_16x16x32_bf16 v[48:51], v[92:95], v[212:215], v[48:51]
    s_waitcnt lgkmcnt(10)
    ds_read_b128 v[76:79], v6 offset:13312
    ds_read_b128 v[80:83], v6 offset:31744
    ds_read_b128 v[84:87], v6 offset:50176
    ds_read_b128 v[88:91], v7 offset:13312
    ds_read_b128 v[92:95], v7 offset:31744
    s_cbranch_vccnz L_f2_r8
L_f2_g8:
    s_waitcnt lgkmcnt(15)
    v_mfma_f32_16x16x32_bf16 v[16:19], v[96:99], v[216:219], v[16:19]
    v_mfma_f32_16x16x32_bf16 v[20:23], v[100:103], v[216:219], v[20:23]
    v_mfma_f32_16x16x32_bf16 v[24:27], v[104:107], v[216:219], v[24:27]
    s_waitcnt vmcnt(8)
    v_max3_u32 v176, v220, v221, v222
    v_max_u32 v176, v176, v223
    v_cmp_eq_u32 vcc, -1, v176
    v_mfma_f32_16x16x32_bf16 v[28:31], v[108:111], v[216:219], v[28:31]
    v_mfma_f32_16x16x32_bf16 v[48:51], v[112:115], v[216:219], v[48:51]
    s_waitcnt lgkmcnt(10)
    ds_read_b128 v[96:99], v6 offset:14336
    ds_read_b128 v[100:103], v6 offset:32768
    ds_read_b128 v[104:107], v6 offset:51200
    ds_read_b128 v[108:111], v7 offset:14336
    ds_read_b128 v[112:115], v7 offset:32768
    s_cbranch_vccnz L_f2_r9
L_f2_g9:
    s_waitcnt lgkmcnt(15)
    v_mfma_f32_16x16x32_bf16 v[16:19], v[116:119], v[220:223], v[16:19]
    v_mfma_f32_16x16x32_bf16 v[20:23], v[120:123], v[220:223], v[20:23]
    v_mfma_f32_16x16x32_bf16 v[24:27], v[124:127], v[220:223], v[24:27]
    s_waitcnt vmcnt(7)
    v_max3_u32 v176, v224, v225, v226
    v_max_u32 v176, v176, v227
    v_cmp_eq_u32 vcc, -1, v176
    v_mfma_f32_16x16x32_bf16 v[28:31], v[128:131], v[220:223], v[28:31]
    v_mfma_f32_16x16x32_bf16 v[48:51], v[132:135], v[220:223], v[48:51]
    s_waitcnt lgkmcnt(10)
    ds_read_b128 v[116:119], v6 offset:15360
    ds_read_b128 v[120:123], v6 offset:33792
    ds_read_b128 v[124:127], v6 offset:52224
    ds_read_b128 v[128:131], v7 offset:15360
    ds_read_b128 v[132:135], v7 offset:33792
    s_cbranch_vccnz L_f2_r10
L_f2_g10:
    s_waitcnt lgkmcnt(15)
    v_mfma_f32_16x16x32_bf16 v[16:19], v[136:139], v[224:227], v[16:19]
    v_mfma_f32_16x16x32_bf16 v[20:23], v[140:143], v[224:227], v[20:23]
    v_mfma_f32_16x16x32_bf16 v[24:27], v[144:147], v[224:227], v[24:27]
    s_waitcnt vmcnt(6)
    v_max3_u32 v176, v228, v229, v230
    v_max_u32 v176, v176, v231
    v_cmp_eq_u32 vcc, -1, v176
    v_mfma_f32_16x16x32_bf16 v[28:31], v[148:151], v[224:227], v[28:31]
    v_mfma_f32_16x16x32_bf16 v[48:51], v[152:155], v[224:227], v[48:51]
    s_waitcnt lgkmcnt(10)
    ds_read_b128 v[136:139], v6 offset:16384
    ds_read_b128 v[140:143], v6 offset:34816
    ds_read_b128 v[144:147], v6 offset:53248
    ds_read_b128 v[148:151], v7 offset:16384
    ds_read_b128 v[152:155], v7 offset:34816
    s_cbranch_vccnz L_f2_r11
L_f2_g11:
    s_waitcnt lgkmcnt(15)
    v_mfma_f32_16x16x32_bf16 v[16:19], v[156:159], v[228:231], v[16:19]
    v_mfma_f32_16x16x32_bf16 v[20:23], v[160:163], v[228:231], v[20:23]
    v_mfma_f32_16x16x32_bf16 v[24:27], v[164:167], v[228:231], v[24:27]
    s_waitcnt vmcnt(5)
    v_max3_u32 v176, v232, v233, v234
    v_max_u32 v176, v176, v235
    v_cmp_eq_u32 vcc, -1, v176
    v_mfma_f32_16x16x32_bf16 v[28:31], v[168:171], v[228:231], v[28:31]
    v_mfma_f32_16x16x32_bf16 v[48:51], v[172:175], v[228:231], v[48:51]
    s_waitcnt lgkmcnt(10)
    ds_read_b128 v[156:159], v6 offset:17408
    ds_read_b128 v[160:163], v6 offset:35840
    ds_read_b128 v[164:167], v6 offset:54272
    ds_read_b128 v[168:171], v7 offset:17408
    ds_read_b128 v[172:175], v7 offset:35840
    s_cbranch_vccnz L_f2_r12
L_f2_g12:
    s_waitcnt lgkmcnt(15)
    v_mfma_f32_16x16x32_bf16 v[16:19], v[56:59], v[232:235], v[16:19]
    v_mfma_f32_16x16x32_bf16 v[20:23], v[60:63], v[232:235], v[20:23]
    v_mfma_f32_16x16x32_bf16 v[24:27], v[64:67], v[232:235], v[24:27]
    s_waitcnt vmcnt(4)
    v_max3_u32 v176, v236, v237, v238
    v_max_u32 v176, v176, v239
    v_cmp_eq_u32 vcc, -1, v176
    v_mfma_f32_16x16x32_bf16 v[28:31], v[68:71], v[232:235], v[28:31]
    v_mfma_f32_16x16x32_bf16 v[48:51], v[72:75], v[232:235], v[48:51]
    s_cbranch_vccnz L_f2_r13
L_f2_g13:
    s_waitcnt lgkmcnt(15)
    v_mfma_f32_16x16x32_bf16 v[16:19], v[76:79], v[236:239], v[16:19]
    v_mfma_f32_16x16x32_bf16 v[20:23], v[80:83], v[236:239], v[20:23]
    v_mfma_f32_16x16x32_bf16 v[24:27], v[84:87], v[236:239], v[24:27]
    s_waitcnt vmcnt(3)
    v_max3_u32 v176, v240, v241, v242
    v_max_u32 v176, v176, v243
    v_cmp_eq_u32 vcc, -1, v176
    v_mfma_f32_16x16x32_bf16 v[28:31], v[88:91], v[236:239], v[28:31]
    v_mfma_f32_16x16x32_bf16 v[48:51], v[92:95], v[236:239], v[48:51]
    s_cbranch_vccnz L_f2_r14
L_f2_g14:
    s_waitcnt lgkmcnt(15)
    v_mfma_f32_16x16x32_bf16 v[16:19], v[96:99], v[240:243], v[16:19]
    v_mfma_f32_16x16x32_bf16 v[20:23], v[100:103], v[240:243], v[20:23]
    v_mfma_f32_16x16x32_bf16 v[24:27], v[104:107], v[240:243], v[24:27]
    s_waitcnt vmcnt(2)
    v_max3_u32 v176, v244, v245, v246
    v_max_u32 v176, v176, v247
    v_cmp_eq_u32 vcc, -1, v176
    v_mfma_f32_16x16x32_bf16 v[28:31], v[108:111], v[240:243], v[28:31]
    v_mfma_f32_16x16x32_bf16 v[48:51], v[112:115], v[240:243], v[48:51]
    s_cbranch_vccnz L_f2_r15
L_f2_g15:
    s_waitcnt lgkmcnt(10)
    v_mfma_f32_16x16x32_bf16 v[16:19], v[116:119], v[244:247], v[16:19]
    v_mfma_f32_16x16x32_bf16 v[20:23], v[120:123], v[244:247], v[20:23]
    v_mfma_f32_16x16x32_bf16 v[24:27], v[124:127], v[244:247], v[24:27]
    s_waitcnt vmcnt(1)
    v_max3_u32 v176, v248, v249, v250
    v_max_u32 v176, v176, v251
    v_cmp_eq_u32 vcc, -1, v176
    v_mfma_f32_16x16x32_bf16 v[28:31], v[128:131], v[244:247], v[28:31]
    v_mfma_f32_16x16x32_bf16 v[48:51], v[132:135], v[244:247], v[48:51]
    s_cbranch_vccnz L_f2_r16
L_f2_g16:
    s_waitcnt lgkmcnt(5)
    v_mfma_f32_16x16x32_bf16 v[16:19], v[136:139], v[248:251], v[16:19]
    v_mfma_f32_16x16x32_bf16 v[20:23], v[140:143], v[248:251], v[20:23]
    v_mfma_f32_16x16x32_bf16 v[24:27], v[144:147], v[248:251], v[24:27]
    s_waitcnt vmcnt(0)
    v_max3_u32 v176, v252, v253, v254
    v_max_u32 v176, v176, v255
    v_cmp_eq_u32 vcc, -1, v176
    v_mfma_f32_16x16x32_bf16 v[28:31], v[148:151], v[248:251], v[28:31]
    v_mfma_f32_16x16x32_bf16 v[48:51], v[152:155], v[248:251], v[48:51]
    s_cbranch_vccnz L_f2_r17
L_f2_g17:
    s_waitcnt lgkmcnt(0)
    v_mfma_f32_16x16x32_bf16 v[16:19], v[156:159], v[252:255], v[16:19]
    v_mfma_f32_16x16x32_bf16 v[20:23], v[160:163], v[252:255], v[20:23]
    v_mfma_f32_16x16x32_bf16 v[24:27], v[164:167], v[252:255], v[24:27]
    v_mfma_f32_16x16x32_bf16 v[28:31], v[168:171], v[252:255], v[28:31]
    v_mfma_f32_16x16x32_bf16 v[48:51], v[172:175], v[252:255], v[48:51]
    s_nop 4
    v_cvt_pk_bf16_f32 v16, v16, v17
    v_cvt_pk_bf16_f32 v17, v18, v19
    buffer_store_dwordx2 v[16:17], v9, s[8:11], s62 offen offset:0
    v_cvt_pk_bf16_f32 v20, v20, v21
    v_cvt_pk_bf16_f32 v21, v22, v23
    buffer_store_dwordx2 v[20:21], v9, s[8:11], s62 offen offset:32
    v_cvt_pk_bf16_f32 v24, v24, v25
    v_cvt_pk_bf16_f32 v25, v26, v27
    buffer_store_dwordx2 v[24:25], v9, s[8:11], s62 offen offset:64
    v_cvt_pk_bf16_f32 v28, v28, v29
    v_cvt_pk_bf16_f32 v29, v30, v31
    buffer_store_dwordx2 v[28:29], v9, s[8:11], s62 offen offset:96
    v_cvt_pk_bf16_f32 v48, v48, v49
    v_cvt_pk_bf16_f32 v49, v50, v51
    buffer_store_dwordx2 v[48:49], v9, s[8:11], s64 offen
    s_endpgm
L_f2_r0:
    s_cmp_eq_u32 s63, 0
    s_cbranch_scc1 L_f2_g0
    s_sub_u32 s63, s63, 1
    buffer_load_dwordx4 v[184:187], v1, s[20:23], s55 offen offset:0 sc0 sc1
    buffer_load_dwordx4 v[188:191], v1, s[20:23], s55 offen offset:1024 sc0 sc1
    buffer_load_dwordx4 v[248:251], v1, s[20:23], s59 offen offset:0 sc0 sc1
    s_waitcnt vmcnt(0)
    v_max3_u32 v176, v184, v185, v186
    v_max_u32 v176, v176, v187
    v_cmp_eq_u32 vcc, -1, v176
    s_cbranch_vccnz L_f2_r0
    s_branch L_f2_g0
L_f2_r1:
    s_cmp_eq_u32 s63, 0
    s_cbranch_scc1 L_f2_g1
    s_sub_u32 s63, s63, 1
    buffer_load_dwordx4 v[188:191], v1, s[20:23], s55 offen offset:1024 sc0 sc1
    buffer_load_dwordx4 v[248:251], v1, s[20:23], s59 offen offset:0 sc0 sc1
    s_waitcnt vmcnt(0)
    v_max3_u32 v176, v188, v189, v190
    v_max_u32 v176, v176, v191
    v_cmp_eq_u32 vcc, -1, v176
    s_cbranch_vccnz L_f2_r1
    s_branch L_f2_g1
L_f2_r2:
    s_cmp_eq_u32 s63, 0
    s_cbranch_scc1 L_f2_g2
    s_sub_u32 s63, s63, 1
    buffer_load_dwordx4 v[192:195], v1, s[20:23], s55 offen offset:2048 sc0 sc1
    buffer_load_dwordx4 v[196:199], v1, s[20:23], s55 offen offset:3072 sc0 sc1
    buffer_load_dwordx4 v[248:251], v1, s[20:23], s59 offen offset:0 sc0 sc1
    s_waitcnt vmcnt(0)
    v_max3_u32 v176, v192, v193, v194
    v_max_u32 v176, v176, v195
    v_cmp_eq_u32 vcc, -1, v176
    s_cbranch_vccnz L_f2_r2
    s_branch L_f2_g2
L_f2_r3:
    s_cmp_eq_u32 s63, 0
    s_cbranch_scc1 L_f2_g3
    s_sub_u32 s63, s63, 1
    buffer_load_dwordx4 v[196:199], v1, s[20:23], s55 offen offset:3072 sc0 sc1
    buffer_load_dwordx4 v[248:251], v1, s[20:23], s59 offen offset:0 sc0 sc1
    s_waitcnt vmcnt(0)
    v_max3_u32 v176, v196, v197, v198
    v_max_u32 v176, v176, v199
    v_cmp_eq_u32 vcc, -1, v176
    s_cbranch_vccnz L_f2_r3
    s_branch L_f2_g3
L_f2_r4:
    s_cmp_eq_u32 s63, 0
    s_cbranch_scc1 L_f2_g4
    s_sub_u32 s63, s63, 1
    buffer_load_dwordx4 v[200:203], v1, s[20:23], s56 offen offset:0 sc0 sc1
    buffer_load_dwordx4 v[204:207], v1, s[20:23], s56 offen offset:1024 sc0 sc1
    buffer_load_dwordx4 v[248:251], v1, s[20:23], s59 offen offset:0 sc0 sc1
    s_waitcnt vmcnt(0)
    v_max3_u32 v176, v200, v201, v202
    v_max_u32 v176, v176, v203
    v_cmp_eq_u32 vcc, -1, v176
    s_cbranch_vccnz L_f2_r4
    s_branch L_f2_g4
L_f2_r5:
    s_cmp_eq_u32 s63, 0
    s_cbranch_scc1 L_f2_g5
    s_sub_u32 s63, s63, 1
    buffer_load_dwordx4 v[204:207], v1, s[20:23], s56 offen offset:1024 sc0 sc1
    buffer_load_dwordx4 v[248:251], v1, s[20:23], s59 offen offset:0 sc0 sc1
    s_waitcnt vmcnt(0)
    v_max3_u32 v176, v204, v205, v206
    v_max_u32 v176, v176, v207
    v_cmp_eq_u32 vcc, -1, v176
    s_cbranch_vccnz L_f2_r5
    s_branch L_f2_g5
L_f2_r6:
    s_cmp_eq_u32 s63, 0
    s_cbranch_scc1 L_f2_g6
    s_sub_u32 s63, s63, 1
    buffer_load_dwordx4 v[208:211], v1, s[20:23], s56 offen offset:2048 sc0 sc1
    buffer_load_dwordx4 v[212:215], v1, s[20:23], s56 offen offset:3072 sc0 sc1
    buffer_load_dwordx4 v[248:251], v1, s[20:23], s59 offen offset:0 sc0 sc1
    s_waitcnt vmcnt(0)
    v_max3_u32 v176, v208, v209, v210
    v_max_u32 v176, v176, v211
    v_cmp_eq_u32 vcc, -1, v176
    s_cbranch_vccnz L_f2_r6
    s_branch L_f2_g6
L_f2_r7:
    s_cmp_eq_u32 s63, 0
    s_cbranch_scc1 L_f2_g7
    s_sub_u32 s63, s63, 1
    buffer_load_dwordx4 v[212:215], v1, s[20:23], s56 offen offset:3072 sc0 sc1
    buffer_load_dwordx4 v[248:251], v1, s[20:23], s59 offen offset:0 sc0 sc1
    s_waitcnt vmcnt(0)
    v_max3_u32 v176, v212, v213, v214
    v_max_u32 v176, v176, v215
    v_cmp_eq_u32 vcc, -1, v176
    s_cbranch_vccnz L_f2_r7
    s_branch L_f2_g7
L_f2_r8:
    s_cmp_eq_u32 s63, 0
    s_cbranch_scc1 L_f2_g8
    s_sub_u32 s63, s63, 1
    buffer_load_dwordx4 v[216:219], v1, s[20:23], s57 offen offset:0 sc0 sc1
    buffer_load_dwordx4 v[220:223], v1, s[20:23], s57 offen offset:1024 sc0 sc1
    buffer_load_dwordx4 v[252:255], v1, s[20:23], s59 offen offset:1024 sc0 sc1
    s_waitcnt vmcnt(0)
    v_max3_u32 v176, v216, v217, v218
    v_max_u32 v176, v176, v219
    v_cmp_eq_u32 vcc, -1, v176
    s_cbranch_vccnz L_f2_r8
    s_branch L_f2_g8
L_f2_r9:
    s_cmp_eq_u32 s63, 0
    s_cbranch_scc1 L_f2_g9
    s_sub_u32 s63, s63, 1
    buffer_load_dwordx4 v[220:223], v1, s[20:23], s57 offen offset:1024 sc0 sc1
    buffer_load_dwordx4 v[252:255], v1, s[20:23], s59 offen offset:1024 sc0 sc1
    s_waitcnt vmcnt(0)
    v_max3_u32 v176, v220, v221, v222
    v_max_u32 v176, v176, v223
    v_cmp_eq_u32 vcc, -1, v176
    s_cbranch_vccnz L_f2_r9
    s_branch L_f2_g9
L_f2_r10:
    s_cmp_eq_u32 s63, 0
    s_cbranch_scc1 L_f2_g10
    s_sub_u32 s63, s63, 1
    buffer_load_dwordx4 v[224:227], v1, s[20:23], s57 offen offset:2048 sc0 sc1
    buffer_load_dwordx4 v[228:231], v1, s[20:23], s57 offen offset:3072 sc0 sc1
    buffer_load_dwordx4 v[252:255], v1, s[20:23], s59 offen offset:1024 sc0 sc1
    s_waitcnt vmcnt(0)
    v_max3_u32 v176, v224, v225, v226
    v_max_u32 v176, v176, v227
    v_cmp_eq_u32 vcc, -1, v176
    s_cbranch_vccnz L_f2_r10
    s_branch L_f2_g10
L_f2_r11:
    s_cmp_eq_u32 s63, 0
    s_cbranch_scc1 L_f2_g11
    s_sub_u32 s63, s63, 1
    buffer_load_dwordx4 v[228:231], v1, s[20:23], s57 offen offset:3072 sc0 sc1
    buffer_load_dwordx4 v[252:255], v1, s[20:23], s59 offen offset:1024 sc0 sc1
    s_waitcnt vmcnt(0)
    v_max3_u32 v176, v228, v229, v230
    v_max_u32 v176, v176, v231
    v_cmp_eq_u32 vcc, -1, v176
    s_cbranch_vccnz L_f2_r11
    s_branch L_f2_g11
L_f2_r12:
    s_cmp_eq_u32 s63, 0
    s_cbranch_scc1 L_f2_g12
    s_sub_u32 s63, s63, 1
    buffer_load_dwordx4 v[232:235], v1, s[20:23], s58 offen offset:0 sc0 sc1
    buffer_load_dwordx4 v[236:239], v1, s[20:23], s58 offen offset:1024 sc0 sc1
    buffer_load_dwordx4 v[252:255], v1, s[20:23], s59 offen offset:1024 sc0 sc1
    s_waitcnt vmcnt(0)
    v_max3_u32 v176, v232, v233, v234
    v_max_u32 v176, v176, v235
    v_cmp_eq_u32 vcc, -1, v176
    s_cbranch_vccnz L_f2_r12
    s_branch L_f2_g12
L_f2_r13:
    s_cmp_eq_u32 s63, 0
    s_cbranch_scc1 L_f2_g13
    s_sub_u32 s63, s63, 1
    buffer_load_dwordx4 v[236:239], v1, s[20:23], s58 offen offset:1024 sc0 sc1
    buffer_load_dwordx4 v[252:255], v1, s[20:23], s59 offen offset:1024 sc0 sc1
    s_waitcnt vmcnt(0)
    v_max3_u32 v176, v236, v237, v238
    v_max_u32 v176, v176, v239
    v_cmp_eq_u32 vcc, -1, v176
    s_cbranch_vccnz L_f2_r13
    s_branch L_f2_g13
L_f2_r14:
    s_cmp_eq_u32 s63, 0
    s_cbranch_scc1 L_f2_g14
    s_sub_u32 s63, s63, 1
    buffer_load_dwordx4 v[240:243], v1, s[20:23], s58 offen offset:2048 sc0 sc1
    buffer_load_dwordx4 v[244:247], v1, s[20:23], s58 offen offset:3072 sc0 sc1
    buffer_load_dwordx4 v[252:255], v1, s[20:23], s59 offen offset:1024 sc0 sc1
    s_waitcnt vmcnt(0)
    v_max3_u32 v176, v240, v241, v242
    v_max_u32 v176, v176, v243
    v_cmp_eq_u32 vcc, -1, v176
    s_cbranch_vccnz L_f2_r14
    s_branch L_f2_g14
L_f2_r15:
    s_cmp_eq_u32 s63, 0
    s_cbranch_scc1 L_f2_g15
    s_sub_u32 s63, s63, 1
    buffer_load_dwordx4 v[244:247], v1, s[20:23], s58 offen offset:3072 sc0 sc1
    buffer_load_dwordx4 v[252:255], v1, s[20:23], s59 offen offset:1024 sc0 sc1
    s_waitcnt vmcnt(0)
    v_max3_u32 v176, v244, v245, v246
    v_max_u32 v176, v176, v247
    v_cmp_eq_u32 vcc, -1, v176
    s_cbranch_vccnz L_f2_r15
    s_branch L_f2_g15
L_f2_r16:
    s_cmp_eq_u32 s63, 0
    s_cbranch_scc1 L_f2_g16
    s_sub_u32 s63, s63, 1
    buffer_load_dwordx4 v[248:251], v1, s[20:23], s59 offen offset:0 sc0 sc1
    s_waitcnt vmcnt(0)
    v_max3_u32 v176, v248, v249, v250
    v_max_u32 v176, v176, v251
    v_cmp_eq_u32 vcc, -1, v176
    s_cbranch_vccnz L_f2_r16
    s_branch L_f2_g16
L_f2_r17:
    s_cmp_eq_u32 s63, 0
    s_cbranch_scc1 L_f2_g17
    s_sub_u32 s63, s63, 1
    buffer_load_dwordx4 v[252:255], v1, s[20:23], s59 offen offset:1024 sc0 sc1
    s_waitcnt vmcnt(0)
    v_max3_u32 v176, v252, v253, v254
    v_max_u32 v176, v176, v255
    v_cmp_eq_u32 vcc, -1, v176
    s_cbranch_vccnz L_f2_r17
    s_branch L_f2_g17
L_g1_grpB:
    ds_read_b128 v[16:19], v10 offset:18432
    ds_read_b128 v[20:23], v10 offset:19456
    ds_read_b128 v[24:27], v10 offset:20480
    ds_read_b128 v[28:31], v10 offset:21504
    ds_read_b64_tr_b16 v[48:49], v9 offset:192
    ds_read_b64_tr_b16 v[50:51], v9 offset:2496
    ds_read_b64_tr_b16 v[52:53], v9 offset:9408
    ds_read_b64_tr_b16 v[54:55], v9 offset:11712
    ds_read_b64_tr_b16 v[56:57], v9 offset:224
    ds_read_b64_tr_b16 v[58:59], v9 offset:2528
    buffer_store_dwordx4 v[80:83], v90, s[20:23], s41 offen sc1
    buffer_store_dwordx4 v[84:87], v91, s[20:23], s41 offen sc1
    s_waitcnt lgkmcnt(4)
    v_mfma_f32_16x16x32_bf16 v[96:99], v[48:51], v[16:19], 0
    ds_read_b64_tr_b16 v[60:61], v9 offset:9440
    v_mfma_f32_16x16x32_bf16 v[100:103], v[48:51], v[20:23], 0
    ds_read_b64_tr_b16 v[62:63], v9 offset:11744
    v_mfma_f32_16x16x32_bf16 v[104:107], v[48:51], v[24:27], 0
    s_add_u32 s44, s30, 122880
    s_add_u32 s45, s29, 122880
    v_mfma_f32_16x16x32_bf16 v[108:111], v[48:51], v[28:31], 0
    s_waitcnt lgkmcnt(4)
    v_mfma_f32_16x16x32_bf16 v[124:127], v[52:55], v[28:31], 0
    ds_read_b64_tr_b16 v[64:65], v9 offset:256
    s_add_u32 m0, s45, 0
    v_mfma_f32_16x16x32_bf16 v[120:123], v[52:55], v[24:27], 0
    ds_read_b64_tr_b16 v[66:67], v9 offset:2560
    v_mfma_f32_16x16x32_bf16 v[116:119], v[52:55], v[20:23], 0
    buffer_load_dwordx4 v2, s[12:15], s27 offen sc1 lds
    v_mfma_f32_16x16x32_bf16 v[112:115], v[52:55], v[16:19], 0
    s_waitcnt lgkmcnt(4)
    v_mfma_f32_16x16x32_bf16 v[128:131], v[56:59], v[16:19], 0
    ds_read_b64_tr_b16 v[48:49], v9 offset:9472
    s_add_u32 m0, s45, 1024
    v_mfma_f32_16x16x32_bf16 v[132:135], v[56:59], v[20:23], 0
    ds_read_b64_tr_b16 v[50:51], v9 offset:11776
    v_mfma_f32_16x16x32_bf16 v[136:139], v[56:59], v[24:27], 0
    buffer_load_dwordx4 v3, s[12:15], s27 offen sc1 lds
    v_mfma_f32_16x16x32_bf16 v[140:143], v[56:59], v[28:31], 0
    s_waitcnt lgkmcnt(4)
    v_mfma_f32_16x16x32_bf16 v[156:159], v[60:63], v[28:31], 0
    ds_read_b64_tr_b16 v[52:53], v11 offset:0
    s_add_u32 m0, s45, 2048
    v_mfma_f32_16x16x32_bf16 v[152:155], v[60:63], v[24:27], 0
    ds_read_b64_tr_b16 v[54:55], v11 offset:1280
    v_mfma_f32_16x16x32_bf16 v[148:151], v[60:63], v[20:23], 0
    buffer_load_dwordx4 v4, s[12:15], s27 offen sc1 lds
    s_add_u32 s27, s27, s28
    v_mfma_f32_16x16x32_bf16 v[144:147], v[60:63], v[16:19], 0
    s_waitcnt lgkmcnt(4)
    v_mfma_f32_16x16x32_bf16 v[160:163], v[64:67], v[16:19], 0
    ds_read_b64_tr_b16 v[56:57], v11 offset:32
    s_add_u32 m0, s44, 0
    v_mfma_f32_16x16x32_bf16 v[164:167], v[64:67], v[20:23], 0
    ds_read_b64_tr_b16 v[58:59], v11 offset:1312
    v_mfma_f32_16x16x32_bf16 v[168:171], v[64:67], v[24:27], 0
    buffer_load_dwordx4 v1, s[20:23], s33 offen sc1 lds
    s_add_u32 s33, s33, 1024
    v_mfma_f32_16x16x32_bf16 v[172:175], v[64:67], v[28:31], 0
    s_waitcnt lgkmcnt(4)
    v_mfma_f32_16x16x32_bf16 v[188:191], v[48:51], v[28:31], 0
    ds_read_b64_tr_b16 v[60:61], v11 offset:64
    s_add_u32 m0, s44, 1024
    v_mfma_f32_16x16x32_bf16 v[184:187], v[48:51], v[24:27], 0
    ds_read_b64_tr_b16 v[62:63], v11 offset:1344
    v_mfma_f32_16x16x32_bf16 v[180:183], v[48:51], v[20:23], 0
    buffer_load_dwordx4 v1, s[20:23], s34 offen sc1 lds
    s_add_u32 s34, s34, 1024
    v_mfma_f32_16x16x32_bf16 v[176:179], v[48:51], v[16:19], 0
    s_waitcnt lgkmcnt(4)
    v_mfma_f32_16x16x32_bf16 v[192:195], v[52:55], v[16:19], 0
    ds_read_b64_tr_b16 v[64:65], v12 offset:96
    v_mfma_f32_16x16x32_bf16 v[196:199], v[52:55], v[20:23], 0
    ds_read_b64_tr_b16 v[66:67], v12 offset:1376
    v_mfma_f32_16x16x32_bf16 v[200:203], v[52:55], v[24:27], 0
    v_add_u32 v9, s46, v5
    v_add_u32 v10, s46, v6
    v_add_u32 v11, s46, v7
    v_add_u32 v12, s46, v8
    v_mfma_f32_16x16x32_bf16 v[204:207], v[52:55], v[28:31], 0
    s_waitcnt vmcnt(12) lgkmcnt(4)
    s_barrier
    v_mfma_f32_16x16x32_bf16 v[220:223], v[56:59], v[28:31], 0
    ds_read_b64_tr_b16 v[48:49], v9 offset:192
    v_mfma_f32_16x16x32_bf16 v[216:219], v[56:59], v[24:27], 0
    ds_read_b64_tr_b16 v[50:51], v9 offset:2496
    v_mfma_f32_16x16x32_bf16 v[212:215], v[56:59], v[20:23], 0
    ds_read_b128 v[32:35], v10 offset:18432
    v_mfma_f32_16x16x32_bf16 v[208:211], v[56:59], v[16:19], 0
    ds_read_b128 v[36:39], v10 offset:19456
    s_waitcnt lgkmcnt(6)
    v_mfma_f32_16x16x32_bf16 v[224:227], v[16:19], v[60:63], 0
    ds_read_b64_tr_b16 v[52:53], v9 offset:9408
    s_add_u32 s46, s46, 40960
    s_cmp_eq_u32 s46, 163840
    s_cselect_b32 s46, 0, s46
    v_mfma_f32_16x16x32_bf16 v[228:231], v[20:23], v[60:63], 0
    ds_read_b64_tr_b16 v[54:55], v9 offset:11712
    v_mfma_f32_16x16x32_bf16 v[232:235], v[24:27], v[60:63], 0
    ds_read_b128 v[40:43], v10 offset:20480
    v_mfma_f32_16x16x32_bf16 v[236:239], v[28:31], v[60:63], 0
    ds_read_b128 v[44:47], v10 offset:21504
    s_waitcnt lgkmcnt(8)
    v_mfma_f32_16x16x32_bf16 v[252:255], v[28:31], v[64:67], 0
    ds_read_b64_tr_b16 v[56:57], v9 offset:224
    v_mfma_f32_16x16x32_bf16 v[248:251], v[24:27], v[64:67], 0
    ds_read_b64_tr_b16 v[58:59], v9 offset:2528
    v_mfma_f32_16x16x32_bf16 v[244:247], v[20:23], v[64:67], 0
    v_mfma_f32_16x16x32_bf16 v[240:243], v[16:19], v[64:67], 0
    s_mov_b32 s47, 0
    s_waitcnt lgkmcnt(2)
    v_mfma_f32_16x16x32_bf16 v[96:99], v[48:51], v[32:35], v[96:99]
    ds_read_b64_tr_b16 v[60:61], v9 offset:9440
    v_mfma_f32_16x16x32_bf16 v[100:103], v[48:51], v[36:39], v[100:103]
    ds_read_b64_tr_b16 v[62:63], v9 offset:11744
    v_mfma_f32_16x16x32_bf16 v[104:107], v[48:51], v[40:43], v[104:107]
    s_add_u32 s44, s30, s47
    s_add_u32 s45, s29, s47
    v_mfma_f32_16x16x32_bf16 v[108:111], v[48:51], v[44:47], v[108:111]
    s_waitcnt lgkmcnt(4)
    v_mfma_f32_16x16x32_bf16 v[124:127], v[52:55], v[44:47], v[124:127]
    ds_read_b64_tr_b16 v[64:65], v9 offset:256
    s_add_u32 m0, s45, 0
    v_mfma_f32_16x16x32_bf16 v[120:123], v[52:55], v[40:43], v[120:123]
    ds_read_b64_tr_b16 v[66:67], v9 offset:2560
    v_mfma_f32_16x16x32_bf16 v[116:119], v[52:55], v[36:39], v[116:119]
    buffer_load_dwordx4 v2, s[12:15], s27 offen sc1 lds
    v_mfma_f32_16x16x32_bf16 v[112:115], v[52:55], v[32:35], v[112:115]
    s_waitcnt lgkmcnt(4)
    v_mfma_f32_16x16x32_bf16 v[128:131], v[56:59], v[32:35], v[128:131]
    ds_read_b64_tr_b16 v[48:49], v9 offset:9472
    s_add_u32 m0, s45, 1024
    v_mfma_f32_16x16x32_bf16 v[132:135], v[56:59], v[36:39], v[132:135]
    ds_read_b64_tr_b16 v[50:51], v9 offset:11776
    v_mfma_f32_16x16x32_bf16 v[136:139], v[56:59], v[40:43], v[136:139]
    buffer_load_dwordx4 v3, s[12:15], s27 offen sc1 lds
    v_mfma_f32_16x16x32_bf16 v[140:143], v[56:59], v[44:47], v[140:143]
    s_waitcnt lgkmcnt(4)
    v_mfma_f32_16x16x32_bf16 v[156:159], v[60:63], v[44:47], v[156:159]
    ds_read_b64_tr_b16 v[52:53], v11 offset:0
    s_add_u32 m0, s45, 2048
    v_mfma_f32_16x16x32_bf16 v[152:155], v[60:63], v[40:43], v[152:155]
    ds_read_b64_tr_b16 v[54:55], v11 offset:1280
    v_mfma_f32_16x16x32_bf16 v[148:151], v[60:63], v[36:39], v[148:151]
    buffer_load_dwordx4 v4, s[12:15], s27 offen sc1 lds
    s_add_u32 s27, s27, s28
    v_mfma_f32_16x16x32_bf16 v[144:147], v[60:63], v[32:35], v[144:147]
    s_waitcnt lgkmcnt(4)
    v_mfma_f32_16x16x32_bf16 v[160:163], v[64:67], v[32:35], v[160:163]
    ds_read_b64_tr_b16 v[56:57], v11 offset:32
    s_add_u32 m0, s44, 0
    v_mfma_f32_16x16x32_bf16 v[164:167], v[64:67], v[36:39], v[164:167]
    ds_read_b64_tr_b16 v[58:59], v11 offset:1312
    v_mfma_f32_16x16x32_bf16 v[168:171], v[64:67], v[40:43], v[168:171]
    buffer_load_dwordx4 v1, s[20:23], s33 offen sc1 lds
    s_add_u32 s33, s33, 1024
    v_mfma_f32_16x16x32_bf16 v[172:175], v[64:67], v[44:47], v[172:175]
    s_waitcnt lgkmcnt(4)
    v_mfma_f32_16x16x32_bf16 v[188:191], v[48:51], v[44:47], v[188:191]
    ds_read_b64_tr_b16 v[60:61], v11 offset:64
    s_add_u32 m0, s44, 1024
    v_mfma_f32_16x16x32_bf16 v[184:187], v[48:51], v[40:43], v[184:187]
    ds_read_b64_tr_b16 v[62:63], v11 offset:1344
    v_mfma_f32_16x16x32_bf16 v[180:183], v[48:51], v[36:39], v[180:183]
    buffer_load_dwordx4 v1, s[20:23], s34 offen sc1 lds
    s_add_u32 s34, s34, 1024
    v_mfma_f32_16x16x32_bf16 v[176:179], v[48:51], v[32:35], v[176:179]
    s_waitcnt lgkmcnt(4)
    v_mfma_f32_16x16x32_bf16 v[192:195], v[52:55], v[32:35], v[192:195]
    ds_read_b64_tr_b16 v[64:65], v12 offset:96
    v_mfma_f32_16x16x32_bf16 v[196:199], v[52:55], v[36:39], v[196:199]
    ds_read_b64_tr_b16 v[66:67], v12 offset:1376
    v_mfma_f32_16x16x32_bf16 v[200:203], v[52:55], v[40:43], v[200:203]
    v_add_u32 v9, s46, v5
    v_add_u32 v10, s46, v6
    v_add_u32 v11, s46, v7
    v_add_u32 v12, s46, v8
    v_mfma_f32_16x16x32_bf16 v[204:207], v[52:55], v[44:47], v[204:207]
    s_waitcnt vmcnt(12) lgkmcnt(4)
    s_barrier
    v_mfma_f32_16x16x32_bf16 v[220:223], v[56:59], v[44:47], v[220:223]
    ds_read_b64_tr_b16 v[48:49], v9 offset:192
    v_mfma_f32_16x16x32_bf16 v[216:219], v[56:59], v[40:43], v[216:219]
    ds_read_b64_tr_b16 v[50:51], v9 offset:2496
    v_mfma_f32_16x16x32_bf16 v[212:215], v[56:59], v[36:39], v[212:215]
    ds_read_b128 v[16:19], v10 offset:18432
    v_mfma_f32_16x16x32_bf16 v[208:211], v[56:59], v[32:35], v[208:211]
    ds_read_b128 v[20:23], v10 offset:19456
    s_waitcnt lgkmcnt(6)
    v_mfma_f32_16x16x32_bf16 v[224:227], v[32:35], v[60:63], v[224:227]
    ds_read_b64_tr_b16 v[52:53], v9 offset:9408
    s_add_u32 s46, s46, 40960
    s_cmp_eq_u32 s46, 163840
    s_cselect_b32 s46, 0, s46
    v_mfma_f32_16x16x32_bf16 v[228:231], v[36:39], v[60:63], v[228:231]
    ds_read_b64_tr_b16 v[54:55], v9 offset:11712
    v_mfma_f32_16x16x32_bf16 v[232:235], v[40:43], v[60:63], v[232:235]
    ds_read_b128 v[24:27], v10 offset:20480
    v_mfma_f32_16x16x32_bf16 v[236:239], v[44:47], v[60:63], v[236:239]
    ds_read_b128 v[28:31], v10 offset:21504
    s_waitcnt lgkmcnt(8)
    v_mfma_f32_16x16x32_bf16 v[252:255], v[44:47], v[64:67], v[252:255]
    ds_read_b64_tr_b16 v[56:57], v9 offset:224
    v_mfma_f32_16x16x32_bf16 v[248:251], v[40:43], v[64:67], v[248:251]
    ds_read_b64_tr_b16 v[58:59], v9 offset:2528
    v_mfma_f32_16x16x32_bf16 v[244:247], v[36:39], v[64:67], v[244:247]
    v_mfma_f32_16x16x32_bf16 v[240:243], v[32:35], v[64:67], v[240:243]
    s_add_u32 s47, s47, 40960
    s_cmp_eq_u32 s47, 163840
    s_cselect_b32 s47, 0, s47
    s_waitcnt vmcnt(10)
    buffer_store_dword v14, v13, s[20:23], s50 offen sc0 sc1
    s_waitcnt lgkmcnt(2)
    v_mfma_f32_16x16x32_bf16 v[96:99], v[48:51], v[16:19], v[96:99]
    ds_read_b64_tr_b16 v[60:61], v9 offset:9440
    v_mfma_f32_16x16x32_bf16 v[100:103], v[48:51], v[20:23], v[100:103]
    ds_read_b64_tr_b16 v[62:63], v9 offset:11744
    v_mfma_f32_16x16x32_bf16 v[104:107], v[48:51], v[24:27], v[104:107]
    s_add_u32 s44, s30, s47
    s_add_u32 s45, s29, s47
    v_mfma_f32_16x16x32_bf16 v[108:111], v[48:51], v[28:31], v[108:111]
    s_waitcnt lgkmcnt(4)
    v_mfma_f32_16x16x32_bf16 v[124:127], v[52:55], v[28:31], v[124:127]
    ds_read_b64_tr_b16 v[64:65], v9 offset:256
    s_add_u32 m0, s45, 0
    v_mfma_f32_16x16x32_bf16 v[120:123], v[52:55], v[24:27], v[120:123]
    ds_read_b64_tr_b16 v[66:67], v9 offset:2560
    v_mfma_f32_16x16x32_bf16 v[116:119], v[52:55], v[20:23], v[116:119]
    buffer_load_dwordx4 v2, s[12:15], s27 offen sc1 lds
    v_mfma_f32_16x16x32_bf16 v[112:115], v[52:55], v[16:19], v[112:115]
    s_waitcnt lgkmcnt(4)
    v_mfma_f32_16x16x32_bf16 v[128:131], v[56:59], v[16:19], v[128:131]
    ds_read_b64_tr_b16 v[48:49], v9 offset:9472
    s_add_u32 m0, s45, 1024
    v_mfma_f32_16x16x32_bf16 v[132:135], v[56:59], v[20:23], v[132:135]
    ds_read_b64_tr_b16 v[50:51], v9 offset:11776
    v_mfma_f32_16x16x32_bf16 v[136:139], v[56:59], v[24:27], v[136:139]
    buffer_load_dwordx4 v3, s[12:15], s27 offen sc1 lds
    v_mfma_f32_16x16x32_bf16 v[140:143], v[56:59], v[28:31], v[140:143]
    s_waitcnt lgkmcnt(4)
    v_mfma_f32_16x16x32_bf16 v[156:159], v[60:63], v[28:31], v[156:159]
    ds_read_b64_tr_b16 v[52:53], v11 offset:0
    s_add_u32 m0, s45, 2048
    v_mfma_f32_16x16x32_bf16 v[152:155], v[60:63], v[24:27], v[152:155]
    ds_read_b64_tr_b16 v[54:55], v11 offset:1280
    v_mfma_f32_16x16x32_bf16 v[148:151], v[60:63], v[20:23], v[148:151]
    buffer_load_dwordx4 v4, s[12:15], s27 offen sc1 lds
    s_add_u32 s27, s27, s28
    v_mfma_f32_16x16x32_bf16 v[144:147], v[60:63], v[16:19], v[144:147]
    s_waitcnt lgkmcnt(4)
    v_mfma_f32_16x16x32_bf16 v[160:163], v[64:67], v[16:19], v[160:163]
    ds_read_b64_tr_b16 v[56:57], v11 offset:32
    s_add_u32 m0, s44, 0
    v_mfma_f32_16x16x32_bf16 v[164:167], v[64:67], v[20:23], v[164:167]
    ds_read_b64_tr_b16 v[58:59], v11 offset:1312
    v_mfma_f32_16x16x32_bf16 v[168:171], v[64:67], v[24:27], v[168:171]
    buffer_load_dwordx4 v1, s[20:23], s33 offen sc1 lds
    s_add_u32 s33, s33, 1024
    v_mfma_f32_16x16x32_bf16 v[172:175], v[64:67], v[28:31], v[172:175]
    s_waitcnt lgkmcnt(4)
    v_mfma_f32_16x16x32_bf16 v[188:191], v[48:51], v[28:31], v[188:191]
    ds_read_b64_tr_b16 v[60:61], v11 offset:64
    s_add_u32 m0, s44, 1024
    v_mfma_f32_16x16x32_bf16 v[184:187], v[48:51], v[24:27], v[184:187]
    ds_read_b64_tr_b16 v[62:63], v11 offset:1344
    v_mfma_f32_16x16x32_bf16 v[180:183], v[48:51], v[20:23], v[180:183]
    buffer_load_dwordx4 v1, s[20:23], s34 offen sc1 lds
    s_add_u32 s34, s34, 1024
    v_mfma_f32_16x16x32_bf16 v[176:179], v[48:51], v[16:19], v[176:179]
    s_waitcnt lgkmcnt(4)
    v_mfma_f32_16x16x32_bf16 v[192:195], v[52:55], v[16:19], v[192:195]
    ds_read_b64_tr_b16 v[64:65], v12 offset:96
    v_mfma_f32_16x16x32_bf16 v[196:199], v[52:55], v[20:23], v[196:199]
    ds_read_b64_tr_b16 v[66:67], v12 offset:1376
    v_mfma_f32_16x16x32_bf16 v[200:203], v[52:55], v[24:27], v[200:203]
    v_add_u32 v9, s46, v5
    v_add_u32 v10, s46, v6
    v_add_u32 v11, s46, v7
    v_add_u32 v12, s46, v8
    v_mfma_f32_16x16x32_bf16 v[204:207], v[52:55], v[28:31], v[204:207]
    s_waitcnt vmcnt(11) lgkmcnt(4)
    s_barrier
    v_mfma_f32_16x16x32_bf16 v[220:223], v[56:59], v[28:31], v[220:223]
    ds_read_b64_tr_b16 v[48:49], v9 offset:192
    v_mfma_f32_16x16x32_bf16 v[216:219], v[56:59], v[24:27], v[216:219]
    ds_read_b64_tr_b16 v[50:51], v9 offset:2496
    v_mfma_f32_16x16x32_bf16 v[212:215], v[56:59], v[20:23], v[212:215]
    ds_read_b128 v[32:35], v10 offset:18432
    v_mfma_f32_16x16x32_bf16 v[208:211], v[56:59], v[16:19], v[208:211]
    ds_read_b128 v[36:39], v10 offset:19456
    s_waitcnt lgkmcnt(6)
    v_mfma_f32_16x16x32_bf16 v[224:227], v[16:19], v[60:63], v[224:227]
    ds_read_b64_tr_b16 v[52:53], v9 offset:9408
    s_add_u32 s46, s46, 40960
    s_cmp_eq_u32 s46, 163840
    s_cselect_b32 s46, 0, s46
    v_mfma_f32_16x16x32_bf16 v[228:231], v[20:23], v[60:63], v[228:231]
    ds_read_b64_tr_b16 v[54:55], v9 offset:11712
    v_mfma_f32_16x16x32_bf16 v[232:235], v[24:27], v[60:63], v[232:235]
    ds_read_b128 v[40:43], v10 offset:20480
    v_mfma_f32_16x16x32_bf16 v[236:239], v[28:31], v[60:63], v[236:239]
    ds_read_b128 v[44:47], v10 offset:21504
    s_waitcnt lgkmcnt(8)
    v_mfma_f32_16x16x32_bf16 v[252:255], v[28:31], v[64:67], v[252:255]
    ds_read_b64_tr_b16 v[56:57], v9 offset:224
    v_mfma_f32_16x16x32_bf16 v[248:251], v[24:27], v[64:67], v[248:251]
    ds_read_b64_tr_b16 v[58:59], v9 offset:2528
    v_mfma_f32_16x16x32_bf16 v[244:247], v[20:23], v[64:67], v[244:247]
    v_mfma_f32_16x16x32_bf16 v[240:243], v[16:19], v[64:67], v[240:243]
    s_add_u32 s47, s47, 40960
    s_cmp_eq_u32 s47, 163840
    s_cselect_b32 s47, 0, s47
    buffer_load_dword v78, v77, s[20:23], s43 offen sc0 sc1
    s_waitcnt lgkmcnt(2)
    v_mfma_f32_16x16x32_bf16 v[96:99], v[48:51], v[32:35], v[96:99]
    ds_read_b64_tr_b16 v[60:61], v9 offset:9440
    v_mfma_f32_16x16x32_bf16 v[100:103], v[48:51], v[36:39], v[100:103]
    ds_read_b64_tr_b16 v[62:63], v9 offset:11744
    v_mfma_f32_16x16x32_bf16 v[104:107], v[48:51], v[40:43], v[104:107]
    s_add_u32 s44, s30, s47
    s_add_u32 s45, s29, s47
    v_mfma_f32_16x16x32_bf16 v[108:111], v[48:51], v[44:47], v[108:111]
    s_waitcnt lgkmcnt(4)
    v_mfma_f32_16x16x32_bf16 v[124:127], v[52:55], v[44:47], v[124:127]
    ds_read_b64_tr_b16 v[64:65], v9 offset:256
    s_add_u32 m0, s45, 0
    v_mfma_f32_16x16x32_bf16 v[120:123], v[52:55], v[40:43], v[120:123]
    ds_read_b64_tr_b16 v[66:67], v9 offset:2560
    v_mfma_f32_16x16x32_bf16 v[116:119], v[52:55], v[36:39], v[116:119]
    buffer_load_dwordx4 v2, s[12:15], s27 offen sc1 lds
    v_mfma_f32_16x16x32_bf16 v[112:115], v[52:55], v[32:35], v[112:115]
    s_waitcnt lgkmcnt(4)
    v_mfma_f32_16x16x32_bf16 v[128:131], v[56:59], v[32:35], v[128:131]
    ds_read_b64_tr_b16 v[48:49], v9 offset:9472
    s_add_u32 m0, s45, 1024
    v_mfma_f32_16x16x32_bf16 v[132:135], v[56:59], v[36:39], v[132:135]
    ds_read_b64_tr_b16 v[50:51], v9 offset:11776
    v_mfma_f32_16x16x32_bf16 v[136:139], v[56:59], v[40:43], v[136:139]
    buffer_load_dwordx4 v3, s[12:15], s27 offen sc1 lds
    v_mfma_f32_16x16x32_bf16 v[140:143], v[56:59], v[44:47], v[140:143]
    s_waitcnt lgkmcnt(4)
    v_mfma_f32_16x16x32_bf16 v[156:159], v[60:63], v[44:47], v[156:159]
    ds_read_b64_tr_b16 v[52:53], v11 offset:0
    s_add_u32 m0, s45, 2048
    v_mfma_f32_16x16x32_bf16 v[152:155], v[60:63], v[40:43], v[152:155]
    ds_read_b64_tr_b16 v[54:55], v11 offset:1280
    v_mfma_f32_16x16x32_bf16 v[148:151], v[60:63], v[36:39], v[148:151]
    buffer_load_dwordx4 v4, s[12:15], s27 offen sc1 lds
    s_add_u32 s27, s27, s28
    v_mfma_f32_16x16x32_bf16 v[144:147], v[60:63], v[32:35], v[144:147]
    s_waitcnt lgkmcnt(4)
    v_mfma_f32_16x16x32_bf16 v[160:163], v[64:67], v[32:35], v[160:163]
    ds_read_b64_tr_b16 v[56:57], v11 offset:32
    s_add_u32 m0, s44, 0
    v_mfma_f32_16x16x32_bf16 v[164:167], v[64:67], v[36:39], v[164:167]
    ds_read_b64_tr_b16 v[58:59], v11 offset:1312
    v_mfma_f32_16x16x32_bf16 v[168:171], v[64:67], v[40:43], v[168:171]
    buffer_load_dwordx4 v1, s[20:23], s33 offen sc1 lds
    s_add_u32 s33, s33, 1024
    v_mfma_f32_16x16x32_bf16 v[172:175], v[64:67], v[44:47], v[172:175]
    s_waitcnt lgkmcnt(4)
    v_mfma_f32_16x16x32_bf16 v[188:191], v[48:51], v[44:47], v[188:191]
    ds_read_b64_tr_b16 v[60:61], v11 offset:64
    s_add_u32 m0, s44, 1024
    v_mfma_f32_16x16x32_bf16 v[184:187], v[48:51], v[40:43], v[184:187]
    ds_read_b64_tr_b16 v[62:63], v11 offset:1344
    v_mfma_f32_16x16x32_bf16 v[180:183], v[48:51], v[36:39], v[180:183]
    buffer_load_dwordx4 v1, s[20:23], s34 offen sc1 lds
    s_add_u32 s34, s34, 1024
    v_mfma_f32_16x16x32_bf16 v[176:179], v[48:51], v[32:35], v[176:179]
    s_waitcnt lgkmcnt(4)
    v_mfma_f32_16x16x32_bf16 v[192:195], v[52:55], v[32:35], v[192:195]
    ds_read_b64_tr_b16 v[64:65], v12 offset:96
    v_mfma_f32_16x16x32_bf16 v[196:199], v[52:55], v[36:39], v[196:199]
    ds_read_b64_tr_b16 v[66:67], v12 offset:1376
    v_mfma_f32_16x16x32_bf16 v[200:203], v[52:55], v[40:43], v[200:203]
    v_add_u32 v9, s46, v5
    v_add_u32 v10, s46, v6
    v_add_u32 v11, s46, v7
    v_add_u32 v12, s46, v8
    v_mfma_f32_16x16x32_bf16 v[204:207], v[52:55], v[44:47], v[204:207]
    s_waitcnt vmcnt(12) lgkmcnt(4)
    s_barrier
    v_mfma_f32_16x16x32_bf16 v[220:223], v[56:59], v[44:47], v[220:223]
    ds_read_b64_tr_b16 v[48:49], v9 offset:192
    v_mfma_f32_16x16x32_bf16 v[216:219], v[56:59], v[40:43], v[216:219]
    ds_read_b64_tr_b16 v[50:51], v9 offset:2496
    v_mfma_f32_16x16x32_bf16 v[212:215], v[56:59], v[36:39], v[212:215]
    ds_read_b128 v[16:19], v10 offset:18432
    v_mfma_f32_16x16x32_bf16 v[208:211], v[56:59], v[32:35], v[208:211]
    ds_read_b128 v[20:23], v10 offset:19456
    s_waitcnt lgkmcnt(6)
    v_mfma_f32_16x16x32_bf16 v[224:227], v[32:35], v[60:63], v[224:227]
    ds_read_b64_tr_b16 v[52:53], v9 offset:9408
    s_add_u32 s46, s46, 40960
    s_cmp_eq_u32 s46, 163840
    s_cselect_b32 s46, 0, s46
    v_mfma_f32_16x16x32_bf16 v[228:231], v[36:39], v[60:63], v[228:231]
    ds_read_b64_tr_b16 v[54:55], v9 offset:11712
    v_mfma_f32_16x16x32_bf16 v[232:235], v[40:43], v[60:63], v[232:235]
    ds_read_b128 v[24:27], v10 offset:20480
    v_mfma_f32_16x16x32_bf16 v[236:239], v[44:47], v[60:63], v[236:239]
    ds_read_b128 v[28:31], v10 offset:21504
    s_waitcnt lgkmcnt(8)
    v_mfma_f32_16x16x32_bf16 v[252:255], v[44:47], v[64:67], v[252:255]
    ds_read_b64_tr_b16 v[56:57], v9 offset:224
    v_mfma_f32_16x16x32_bf16 v[248:251], v[40:43], v[64:67], v[248:251]
    ds_read_b64_tr_b16 v[58:59], v9 offset:2528
    v_mfma_f32_16x16x32_bf16 v[244:247], v[36:39], v[64:67], v[244:247]
    v_mfma_f32_16x16x32_bf16 v[240:243], v[32:35], v[64:67], v[240:243]
    s_add_u32 s47, s47, 40960
    s_cmp_eq_u32 s47, 163840
    s_cselect_b32 s47, 0, s47
    s_waitcnt vmcnt(5)
    s_mov_b32 s35, 1
    s_cmp_lt_u32 s24, 6
    s_cbranch_scc1 L_g1_qs
    v_cmp_eq_u32 vcc, s99, v78
    s_nop 3
    s_bcnt1_i32_b64 s101, vcc
    s_cmp_eq_u32 s101, 32
    s_cbranch_scc1 L_g1_qok
    s_mov_b32 s100, 100000
L_parall_poll_15:
    buffer_load_dword v78, v77, s[20:23], s43 offen sc0 sc1
    s_waitcnt vmcnt(0)
    v_cmp_eq_u32 vcc, s99, v78
    s_nop 3
    s_bcnt1_i32_b64 s101, vcc
    s_cmp_eq_u32 s101, 32
    s_cbranch_scc1 L_parall_poll_15_ok
    s_sub_u32 s100, s100, 1
    s_cbranch_scc1 L_parall_poll_15_ok
    s_sleep 8
    s_branch L_parall_poll_15
L_parall_poll_15_ok:
L_g1_qok:
    s_sub_u32 s3, s24, 6
    s_mul_i32 s40, s3, 3072
    v_add_u32 v2, s40, v1
    v_add_u32 v3, 1024, v2
    v_add_u32 v4, 2048, v2
    s_cmp_eq_u32 s24, 7
    s_cselect_b64 vcc, -1, 0
    v_cndmask_b32 v4, v4, v15, vcc
    s_add_u32 s27, s41, 35840
    s_mov_b32 s28, 5120
    s_mov_b32 s12, s20
    s_mov_b32 s13, s21
    s_mov_b32 s14, 49629184
L_g1_qs:
.p2align 6
L_g1_loop1:
    s_waitcnt lgkmcnt(2)
    v_mfma_f32_16x16x32_bf16 v[96:99], v[48:51], v[16:19], v[96:99]
    ds_read_b64_tr_b16 v[60:61], v9 offset:9440
    v_mfma_f32_16x16x32_bf16 v[100:103], v[48:51], v[20:23], v[100:103]
    ds_read_b64_tr_b16 v[62:63], v9 offset:11744
    v_mfma_f32_16x16x32_bf16 v[104:107], v[48:51], v[24:27], v[104:107]
    s_add_u32 s44, s30, s47
    s_add_u32 s45, s29, s47
    v_mfma_f32_16x16x32_bf16 v[108:111], v[48:51], v[28:31], v[108:111]
    s_waitcnt lgkmcnt(4)
    v_mfma_f32_16x16x32_bf16 v[124:127], v[52:55], v[28:31], v[124:127]
    ds_read_b64_tr_b16 v[64:65], v9 offset:256
    s_add_u32 m0, s45, 0
    v_mfma_f32_16x16x32_bf16 v[120:123], v[52:55], v[24:27], v[120:123]
    ds_read_b64_tr_b16 v[66:67], v9 offset:2560
    v_mfma_f32_16x16x32_bf16 v[116:119], v[52:55], v[20:23], v[116:119]
    buffer_load_dwordx4 v2, s[12:15], s27 offen sc1 lds
    v_mfma_f32_16x16x32_bf16 v[112:115], v[52:55], v[16:19], v[112:115]
    s_waitcnt lgkmcnt(4)
    v_mfma_f32_16x16x32_bf16 v[128:131], v[56:59], v[16:19], v[128:131]
    ds_read_b64_tr_b16 v[48:49], v9 offset:9472
    s_add_u32 m0, s45, 1024
    v_mfma_f32_16x16x32_bf16 v[132:135], v[56:59], v[20:23], v[132:135]
    ds_read_b64_tr_b16 v[50:51], v9 offset:11776
    v_mfma_f32_16x16x32_bf16 v[136:139], v[56:59], v[24:27], v[136:139]
    buffer_load_dwordx4 v3, s[12:15], s27 offen sc1 lds
    v_mfma_f32_16x16x32_bf16 v[140:143], v[56:59], v[28:31], v[140:143]
    s_waitcnt lgkmcnt(4)
    v_mfma_f32_16x16x32_bf16 v[156:159], v[60:63], v[28:31], v[156:159]
    ds_read_b64_tr_b16 v[52:53], v11 offset:0
    s_add_u32 m0, s45, 2048
    v_mfma_f32_16x16x32_bf16 v[152:155], v[60:63], v[24:27], v[152:155]
    ds_read_b64_tr_b16 v[54:55], v11 offset:1280
    v_mfma_f32_16x16x32_bf16 v[148:151], v[60:63], v[20:23], v[148:151]
    buffer_load_dwordx4 v4, s[12:15], s27 offen sc1 lds
    s_add_u32 s27, s27, s28
    v_mfma_f32_16x16x32_bf16 v[144:147], v[60:63], v[16:19], v[144:147]
    s_waitcnt lgkmcnt(4)
    v_mfma_f32_16x16x32_bf16 v[160:163], v[64:67], v[16:19], v[160:163]
    ds_read_b64_tr_b16 v[56:57], v11 offset:32
    s_add_u32 m0, s44, 0
    v_mfma_f32_16x16x32_bf16 v[164:167], v[64:67], v[20:23], v[164:167]
    ds_read_b64_tr_b16 v[58:59], v11 offset:1312
    v_mfma_f32_16x16x32_bf16 v[168:171], v[64:67], v[24:27], v[168:171]
    buffer_load_dwordx4 v1, s[20:23], s33 offen sc1 lds
    s_add_u32 s33, s33, 1024
    v_mfma_f32_16x16x32_bf16 v[172:175], v[64:67], v[28:31], v[172:175]
    s_waitcnt lgkmcnt(4)
    v_mfma_f32_16x16x32_bf16 v[188:191], v[48:51], v[28:31], v[188:191]
    ds_read_b64_tr_b16 v[60:61], v11 offset:64
    s_add_u32 m0, s44, 1024
    v_mfma_f32_16x16x32_bf16 v[184:187], v[48:51], v[24:27], v[184:187]
    ds_read_b64_tr_b16 v[62:63], v11 offset:1344
    v_mfma_f32_16x16x32_bf16 v[180:183], v[48:51], v[20:23], v[180:183]
    buffer_load_dwordx4 v1, s[20:23], s34 offen sc1 lds
    s_add_u32 s34, s34, 1024
    v_mfma_f32_16x16x32_bf16 v[176:179], v[48:51], v[16:19], v[176:179]
    s_waitcnt lgkmcnt(4)
    v_mfma_f32_16x16x32_bf16 v[192:195], v[52:55], v[16:19], v[192:195]
    ds_read_b64_tr_b16 v[64:65], v12 offset:96
    v_mfma_f32_16x16x32_bf16 v[196:199], v[52:55], v[20:23], v[196:199]
    ds_read_b64_tr_b16 v[66:67], v12 offset:1376
    v_mfma_f32_16x16x32_bf16 v[200:203], v[52:55], v[24:27], v[200:203]
    v_add_u32 v9, s46, v5
    v_add_u32 v10, s46, v6
    v_add_u32 v11, s46, v7
    v_add_u32 v12, s46, v8
    v_mfma_f32_16x16x32_bf16 v[204:207], v[52:55], v[28:31], v[204:207]
    s_waitcnt vmcnt(10) lgkmcnt(4)
    s_barrier
    v_mfma_f32_16x16x32_bf16 v[220:223], v[56:59], v[28:31], v[220:223]
    ds_read_b64_tr_b16 v[48:49], v9 offset:192
    v_mfma_f32_16x16x32_bf16 v[216:219], v[56:59], v[24:27], v[216:219]
    ds_read_b64_tr_b16 v[50:51], v9 offset:2496
    v_mfma_f32_16x16x32_bf16 v[212:215], v[56:59], v[20:23], v[212:215]
    ds_read_b128 v[32:35], v10 offset:18432
    v_mfma_f32_16x16x32_bf16 v[208:211], v[56:59], v[16:19], v[208:211]
    ds_read_b128 v[36:39], v10 offset:19456
    s_waitcnt lgkmcnt(6)
    v_mfma_f32_16x16x32_bf16 v[224:227], v[16:19], v[60:63], v[224:227]
    ds_read_b64_tr_b16 v[52:53], v9 offset:9408
    s_add_u32 s46, s46, 40960
    s_cmp_eq_u32 s46, 163840
    s_cselect_b32 s46, 0, s46
    v_mfma_f32_16x16x32_bf16 v[228:231], v[20:23], v[60:63], v[228:231]
    ds_read_b64_tr_b16 v[54:55], v9 offset:11712
    v_mfma_f32_16x16x32_bf16 v[232:235], v[24:27], v[60:63], v[232:235]
    ds_read_b128 v[40:43], v10 offset:20480
    v_mfma_f32_16x16x32_bf16 v[236:239], v[28:31], v[60:63], v[236:239]
    ds_read_b128 v[44:47], v10 offset:21504
    s_waitcnt lgkmcnt(8)
    v_mfma_f32_16x16x32_bf16 v[252:255], v[28:31], v[64:67], v[252:255]
    ds_read_b64_tr_b16 v[56:57], v9 offset:224
    v_mfma_f32_16x16x32_bf16 v[248:251], v[24:27], v[64:67], v[248:251]
    ds_read_b64_tr_b16 v[58:59], v9 offset:2528
    v_mfma_f32_16x16x32_bf16 v[244:247], v[20:23], v[64:67], v[244:247]
    v_mfma_f32_16x16x32_bf16 v[240:243], v[16:19], v[64:67], v[240:243]
    s_add_u32 s47, s47, 40960
    s_cmp_eq_u32 s47, 163840
    s_cselect_b32 s47, 0, s47
    s_waitcnt lgkmcnt(2)
    v_mfma_f32_16x16x32_bf16 v[96:99], v[48:51], v[32:35], v[96:99]
    ds_read_b64_tr_b16 v[60:61], v9 offset:9440
    v_mfma_f32_16x16x32_bf16 v[100:103], v[48:51], v[36:39], v[100:103]
    ds_read_b64_tr_b16 v[62:63], v9 offset:11744
    v_mfma_f32_16x16x32_bf16 v[104:107], v[48:51], v[40:43], v[104:107]
    s_add_u32 s44, s30, s47
    s_add_u32 s45, s29, s47
    v_mfma_f32_16x16x32_bf16 v[108:111], v[48:51], v[44:47], v[108:111]
    s_waitcnt lgkmcnt(4)
    v_mfma_f32_16x16x32_bf16 v[124:127], v[52:55], v[44:47], v[124:127]
    ds_read_b64_tr_b16 v[64:65], v9 offset:256
    s_add_u32 m0, s45, 0
    v_mfma_f32_16x16x32_bf16 v[120:123], v[52:55], v[40:43], v[120:123]
    ds_read_b64_tr_b16 v[66:67], v9 offset:2560
    v_mfma_f32_16x16x32_bf16 v[116:119], v[52:55], v[36:39], v[116:119]
    buffer_load_dwordx4 v2, s[12:15], s27 offen sc1 lds
    v_mfma_f32_16x16x32_bf16 v[112:115], v[52:55], v[32:35], v[112:115]
    s_waitcnt lgkmcnt(4)
    v_mfma_f32_16x16x32_bf16 v[128:131], v[56:59], v[32:35], v[128:131]
    ds_read_b64_tr_b16 v[48:49], v9 offset:9472
    s_add_u32 m0, s45, 1024
    v_mfma_f32_16x16x32_bf16 v[132:135], v[56:59], v[36:39], v[132:135]
    ds_read_b64_tr_b16 v[50:51], v9 offset:11776
    v_mfma_f32_16x16x32_bf16 v[136:139], v[56:59], v[40:43], v[136:139]
    buffer_load_dwordx4 v3, s[12:15], s27 offen sc1 lds
    v_mfma_f32_16x16x32_bf16 v[140:143], v[56:59], v[44:47], v[140:143]
    s_waitcnt lgkmcnt(4)
    v_mfma_f32_16x16x32_bf16 v[156:159], v[60:63], v[44:47], v[156:159]
    ds_read_b64_tr_b16 v[52:53], v11 offset:0
    s_add_u32 m0, s45, 2048
    v_mfma_f32_16x16x32_bf16 v[152:155], v[60:63], v[40:43], v[152:155]
    ds_read_b64_tr_b16 v[54:55], v11 offset:1280
    v_mfma_f32_16x16x32_bf16 v[148:151], v[60:63], v[36:39], v[148:151]
    buffer_load_dwordx4 v4, s[12:15], s27 offen sc1 lds
    s_add_u32 s27, s27, s28
    v_mfma_f32_16x16x32_bf16 v[144:147], v[60:63], v[32:35], v[144:147]
    s_waitcnt lgkmcnt(4)
    v_mfma_f32_16x16x32_bf16 v[160:163], v[64:67], v[32:35], v[160:163]
    ds_read_b64_tr_b16 v[56:57], v11 offset:32
    s_add_u32 m0, s44, 0
    v_mfma_f32_16x16x32_bf16 v[164:167], v[64:67], v[36:39], v[164:167]
    ds_read_b64_tr_b16 v[58:59], v11 offset:1312
    v_mfma_f32_16x16x32_bf16 v[168:171], v[64:67], v[40:43], v[168:171]
    buffer_load_dwordx4 v1, s[20:23], s33 offen sc1 lds
    s_add_u32 s33, s33, 1024
    v_mfma_f32_16x16x32_bf16 v[172:175], v[64:67], v[44:47], v[172:175]
    s_waitcnt lgkmcnt(4)
    v_mfma_f32_16x16x32_bf16 v[188:191], v[48:51], v[44:47], v[188:191]
    ds_read_b64_tr_b16 v[60:61], v11 offset:64
    s_add_u32 m0, s44, 1024
    v_mfma_f32_16x16x32_bf16 v[184:187], v[48:51], v[40:43], v[184:187]
    ds_read_b64_tr_b16 v[62:63], v11 offset:1344
    v_mfma_f32_16x16x32_bf16 v[180:183], v[48:51], v[36:39], v[180:183]
    buffer_load_dwordx4 v1, s[20:23], s34 offen sc1 lds
    s_add_u32 s34, s34, 1024
    v_mfma_f32_16x16x32_bf16 v[176:179], v[48:51], v[32:35], v[176:179]
    s_waitcnt lgkmcnt(4)
    v_mfma_f32_16x16x32_bf16 v[192:195], v[52:55], v[32:35], v[192:195]
    ds_read_b64_tr_b16 v[64:65], v12 offset:96
    v_mfma_f32_16x16x32_bf16 v[196:199], v[52:55], v[36:39], v[196:199]
    ds_read_b64_tr_b16 v[66:67], v12 offset:1376
    v_mfma_f32_16x16x32_bf16 v[200:203], v[52:55], v[40:43], v[200:203]
    v_add_u32 v9, s46, v5
    v_add_u32 v10, s46, v6
    v_add_u32 v11, s46, v7
    v_add_u32 v12, s46, v8
    v_mfma_f32_16x16x32_bf16 v[204:207], v[52:55], v[44:47], v[204:207]
    s_waitcnt vmcnt(10) lgkmcnt(4)
    s_barrier
    v_mfma_f32_16x16x32_bf16 v[220:223], v[56:59], v[44:47], v[220:223]
    ds_read_b64_tr_b16 v[48:49], v9 offset:192
    v_mfma_f32_16x16x32_bf16 v[216:219], v[56:59], v[40:43], v[216:219]
    ds_read_b64_tr_b16 v[50:51], v9 offset:2496
    v_mfma_f32_16x16x32_bf16 v[212:215], v[56:59], v[36:39], v[212:215]
    ds_read_b128 v[16:19], v10 offset:18432
    v_mfma_f32_16x16x32_bf16 v[208:211], v[56:59], v[32:35], v[208:211]
    ds_read_b128 v[20:23], v10 offset:19456
    s_waitcnt lgkmcnt(6)
    v_mfma_f32_16x16x32_bf16 v[224:227], v[32:35], v[60:63], v[224:227]
    ds_read_b64_tr_b16 v[52:53], v9 offset:9408
    s_add_u32 s46, s46, 40960
    s_cmp_eq_u32 s46, 163840
    s_cselect_b32 s46, 0, s46
    v_mfma_f32_16x16x32_bf16 v[228:231], v[36:39], v[60:63], v[228:231]
    ds_read_b64_tr_b16 v[54:55], v9 offset:11712
    v_mfma_f32_16x16x32_bf16 v[232:235], v[40:43], v[60:63], v[232:235]
    ds_read_b128 v[24:27], v10 offset:20480
    v_mfma_f32_16x16x32_bf16 v[236:239], v[44:47], v[60:63], v[236:239]
    ds_read_b128 v[28:31], v10 offset:21504
    s_waitcnt lgkmcnt(8)
    v_mfma_f32_16x16x32_bf16 v[252:255], v[44:47], v[64:67], v[252:255]
    ds_read_b64_tr_b16 v[56:57], v9 offset:224
    v_mfma_f32_16x16x32_bf16 v[248:251], v[40:43], v[64:67], v[248:251]
    ds_read_b64_tr_b16 v[58:59], v9 offset:2528
    v_mfma_f32_16x16x32_bf16 v[244:247], v[36:39], v[64:67], v[244:247]
    v_mfma_f32_16x16x32_bf16 v[240:243], v[32:35], v[64:67], v[240:243]
    s_add_u32 s47, s47, 40960
    s_cmp_eq_u32 s47, 163840
    s_cselect_b32 s47, 0, s47
    s_add_u32 s35, s35, 1
    s_cmp_lt_u32 s35, 6
    s_cbranch_scc1 L_g1_loop1
L_g1_exit1:
    s_waitcnt lgkmcnt(2)
    v_mfma_f32_16x16x32_bf16 v[96:99], v[48:51], v[16:19], v[96:99]
    ds_read_b64_tr_b16 v[60:61], v9 offset:9440
    v_mfma_f32_16x16x32_bf16 v[100:103], v[48:51], v[20:23], v[100:103]
    ds_read_b64_tr_b16 v[62:63], v9 offset:11744
    v_mfma_f32_16x16x32_bf16 v[104:107], v[48:51], v[24:27], v[104:107]
    s_add_u32 s44, s30, s47
    s_add_u32 s45, s29, s47
    v_mfma_f32_16x16x32_bf16 v[108:111], v[48:51], v[28:31], v[108:111]
    s_waitcnt lgkmcnt(4)
    v_mfma_f32_16x16x32_bf16 v[124:127], v[52:55], v[28:31], v[124:127]
    ds_read_b64_tr_b16 v[64:65], v9 offset:256
    s_add_u32 m0, s45, 0
    v_mfma_f32_16x16x32_bf16 v[120:123], v[52:55], v[24:27], v[120:123]
    ds_read_b64_tr_b16 v[66:67], v9 offset:2560
    v_mfma_f32_16x16x32_bf16 v[116:119], v[52:55], v[20:23], v[116:119]
    buffer_load_dwordx4 v2, s[12:15], s27 offen sc1 lds
    v_mfma_f32_16x16x32_bf16 v[112:115], v[52:55], v[16:19], v[112:115]
    s_waitcnt lgkmcnt(4)
    v_mfma_f32_16x16x32_bf16 v[128:131], v[56:59], v[16:19], v[128:131]
    ds_read_b64_tr_b16 v[48:49], v9 offset:9472
    s_add_u32 m0, s45, 1024
    v_mfma_f32_16x16x32_bf16 v[132:135], v[56:59], v[20:23], v[132:135]
    ds_read_b64_tr_b16 v[50:51], v9 offset:11776
    v_mfma_f32_16x16x32_bf16 v[136:139], v[56:59], v[24:27], v[136:139]
    buffer_load_dwordx4 v3, s[12:15], s27 offen sc1 lds
    v_mfma_f32_16x16x32_bf16 v[140:143], v[56:59], v[28:31], v[140:143]
    s_waitcnt lgkmcnt(4)
    v_mfma_f32_16x16x32_bf16 v[156:159], v[60:63], v[28:31], v[156:159]
    ds_read_b64_tr_b16 v[52:53], v11 offset:0
    s_add_u32 m0, s45, 2048
    v_mfma_f32_16x16x32_bf16 v[152:155], v[60:63], v[24:27], v[152:155]
    ds_read_b64_tr_b16 v[54:55], v11 offset:1280
    v_mfma_f32_16x16x32_bf16 v[148:151], v[60:63], v[20:23], v[148:151]
    buffer_load_dwordx4 v4, s[12:15], s27 offen sc1 lds
    s_add_u32 s27, s27, s28
    v_mfma_f32_16x16x32_bf16 v[144:147], v[60:63], v[16:19], v[144:147]
    s_waitcnt lgkmcnt(4)
    v_mfma_f32_16x16x32_bf16 v[160:163], v[64:67], v[16:19], v[160:163]
    ds_read_b64_tr_b16 v[56:57], v11 offset:32
    s_add_u32 m0, s44, 0
    v_mfma_f32_16x16x32_bf16 v[164:167], v[64:67], v[20:23], v[164:167]
    ds_read_b64_tr_b16 v[58:59], v11 offset:1312
    v_mfma_f32_16x16x32_bf16 v[168:171], v[64:67], v[24:27], v[168:171]
    buffer_load_dwordx4 v1, s[20:23], s33 offen sc1 lds
    s_add_u32 s33, s33, 1024
    v_mfma_f32_16x16x32_bf16 v[172:175], v[64:67], v[28:31], v[172:175]
    s_waitcnt lgkmcnt(4)
    v_mfma_f32_16x16x32_bf16 v[188:191], v[48:51], v[28:31], v[188:191]
    ds_read_b64_tr_b16 v[60:61], v11 offset:64
    s_add_u32 m0, s44, 1024
    v_mfma_f32_16x16x32_bf16 v[184:187], v[48:51], v[24:27], v[184:187]
    ds_read_b64_tr_b16 v[62:63], v11 offset:1344
    v_mfma_f32_16x16x32_bf16 v[180:183], v[48:51], v[20:23], v[180:183]
    buffer_load_dwordx4 v1, s[20:23], s34 offen sc1 lds
    s_add_u32 s34, s34, 1024
    v_mfma_f32_16x16x32_bf16 v[176:179], v[48:51], v[16:19], v[176:179]
    s_waitcnt lgkmcnt(4)
    v_mfma_f32_16x16x32_bf16 v[192:195], v[52:55], v[16:19], v[192:195]
    ds_read_b64_tr_b16 v[64:65], v12 offset:96
    v_mfma_f32_16x16x32_bf16 v[196:199], v[52:55], v[20:23], v[196:199]
    ds_read_b64_tr_b16 v[66:67], v12 offset:1376
    v_mfma_f32_16x16x32_bf16 v[200:203], v[52:55], v[24:27], v[200:203]
    v_add_u32 v9, s46, v5
    v_add_u32 v10, s46, v6
    v_add_u32 v11, s46, v7
    v_add_u32 v12, s46, v8
    v_mfma_f32_16x16x32_bf16 v[204:207], v[52:55], v[28:31], v[204:207]
    s_waitcnt vmcnt(10) lgkmcnt(4)
    s_barrier
    v_mfma_f32_16x16x32_bf16 v[220:223], v[56:59], v[28:31], v[220:223]
    ds_read_b64_tr_b16 v[48:49], v9 offset:192
    v_mfma_f32_16x16x32_bf16 v[216:219], v[56:59], v[24:27], v[216:219]
    ds_read_b64_tr_b16 v[50:51], v9 offset:2496
    v_mfma_f32_16x16x32_bf16 v[212:215], v[56:59], v[20:23], v[212:215]
    ds_read_b128 v[32:35], v10 offset:18432
    v_mfma_f32_16x16x32_bf16 v[208:211], v[56:59], v[16:19], v[208:211]
    ds_read_b128 v[36:39], v10 offset:19456
    s_waitcnt lgkmcnt(6)
    v_mfma_f32_16x16x32_bf16 v[224:227], v[16:19], v[60:63], v[224:227]
    ds_read_b64_tr_b16 v[52:53], v9 offset:9408
    s_add_u32 s46, s46, 40960
    s_cmp_eq_u32 s46, 163840
    s_cselect_b32 s46, 0, s46
    v_mfma_f32_16x16x32_bf16 v[228:231], v[20:23], v[60:63], v[228:231]
    ds_read_b64_tr_b16 v[54:55], v9 offset:11712
    v_mfma_f32_16x16x32_bf16 v[232:235], v[24:27], v[60:63], v[232:235]
    ds_read_b128 v[40:43], v10 offset:20480
    v_mfma_f32_16x16x32_bf16 v[236:239], v[28:31], v[60:63], v[236:239]
    ds_read_b128 v[44:47], v10 offset:21504
    s_waitcnt lgkmcnt(8)
    v_mfma_f32_16x16x32_bf16 v[252:255], v[28:31], v[64:67], v[252:255]
    ds_read_b64_tr_b16 v[56:57], v9 offset:224
    v_mfma_f32_16x16x32_bf16 v[248:251], v[24:27], v[64:67], v[248:251]
    ds_read_b64_tr_b16 v[58:59], v9 offset:2528
    v_mfma_f32_16x16x32_bf16 v[244:247], v[20:23], v[64:67], v[244:247]
    v_mfma_f32_16x16x32_bf16 v[240:243], v[16:19], v[64:67], v[240:243]
    s_add_u32 s47, s47, 40960
    s_cmp_eq_u32 s47, 163840
    s_cselect_b32 s47, 0, s47
    s_waitcnt lgkmcnt(2)
    v_mfma_f32_16x16x32_bf16 v[96:99], v[48:51], v[32:35], v[96:99]
    ds_read_b64_tr_b16 v[60:61], v9 offset:9440
    v_mfma_f32_16x16x32_bf16 v[100:103], v[48:51], v[36:39], v[100:103]
    ds_read_b64_tr_b16 v[62:63], v9 offset:11744
    v_mfma_f32_16x16x32_bf16 v[104:107], v[48:51], v[40:43], v[104:107]
    s_add_u32 m0, s64, 0
    v_mfma_f32_16x16x32_bf16 v[108:111], v[48:51], v[44:47], v[108:111]
    s_waitcnt lgkmcnt(4)
    v_mfma_f32_16x16x32_bf16 v[124:127], v[52:55], v[44:47], v[124:127]
    ds_read_b64_tr_b16 v[64:65], v9 offset:256
    buffer_load_dwordx4 v68, s[16:19], s56 offen  lds
    v_mfma_f32_16x16x32_bf16 v[120:123], v[52:55], v[40:43], v[120:123]
    ds_read_b64_tr_b16 v[66:67], v9 offset:2560
    v_mfma_f32_16x16x32_bf16 v[116:119], v[52:55], v[36:39], v[116:119]
    s_add_u32 m0, s64, 1024
    v_mfma_f32_16x16x32_bf16 v[112:115], v[52:55], v[32:35], v[112:115]
    s_waitcnt lgkmcnt(4)
    v_mfma_f32_16x16x32_bf16 v[128:131], v[56:59], v[32:35], v[128:131]
    ds_read_b64_tr_b16 v[48:49], v9 offset:9472
    buffer_load_dwordx4 v69, s[16:19], s56 offen  lds
    v_mfma_f32_16x16x32_bf16 v[132:135], v[56:59], v[36:39], v[132:135]
    ds_read_b64_tr_b16 v[50:51], v9 offset:11776
    v_mfma_f32_16x16x32_bf16 v[136:139], v[56:59], v[40:43], v[136:139]
    s_add_u32 m0, s64, 2048
    v_mfma_f32_16x16x32_bf16 v[140:143], v[56:59], v[44:47], v[140:143]
    s_waitcnt lgkmcnt(4)
    v_mfma_f32_16x16x32_bf16 v[156:159], v[60:63], v[44:47], v[156:159]
    ds_read_b64_tr_b16 v[52:53], v11 offset:0
    buffer_load_dwordx4 v70, s[16:19], s56 offen  lds
    v_mfma_f32_16x16x32_bf16 v[152:155], v[60:63], v[40:43], v[152:155]
    ds_read_b64_tr_b16 v[54:55], v11 offset:1280
    v_mfma_f32_16x16x32_bf16 v[148:151], v[60:63], v[36:39], v[148:151]
    s_add_u32 m0, s64, 3072
    v_mfma_f32_16x16x32_bf16 v[144:147], v[60:63], v[32:35], v[144:147]
    s_waitcnt lgkmcnt(4)
    v_mfma_f32_16x16x32_bf16 v[160:163], v[64:67], v[32:35], v[160:163]
    ds_read_b64_tr_b16 v[56:57], v11 offset:32
    buffer_load_dwordx4 v71, s[16:19], s56 offen  lds
    v_mfma_f32_16x16x32_bf16 v[164:167], v[64:67], v[36:39], v[164:167]
    ds_read_b64_tr_b16 v[58:59], v11 offset:1312
    v_mfma_f32_16x16x32_bf16 v[168:171], v[64:67], v[40:43], v[168:171]
    s_add_u32 m0, s64, 4096
    v_mfma_f32_16x16x32_bf16 v[172:175], v[64:67], v[44:47], v[172:175]
    s_waitcnt lgkmcnt(4)
    v_mfma_f32_16x16x32_bf16 v[188:191], v[48:51], v[44:47], v[188:191]
    ds_read_b64_tr_b16 v[60:61], v11 offset:64
    buffer_load_dwordx4 v72, s[16:19], s56 offen  lds
    v_mfma_f32_16x16x32_bf16 v[184:187], v[48:51], v[40:43], v[184:187]
    ds_read_b64_tr_b16 v[62:63], v11 offset:1344
    v_mfma_f32_16x16x32_bf16 v[180:183], v[48:51], v[36:39], v[180:183]
    v_mfma_f32_16x16x32_bf16 v[176:179], v[48:51], v[32:35], v[176:179]
    s_waitcnt lgkmcnt(4)
    v_mfma_f32_16x16x32_bf16 v[192:195], v[52:55], v[32:35], v[192:195]
    ds_read_b64_tr_b16 v[64:65], v12 offset:96
    v_mfma_f32_16x16x32_bf16 v[196:199], v[52:55], v[36:39], v[196:199]
    ds_read_b64_tr_b16 v[66:67], v12 offset:1376
    v_mfma_f32_16x16x32_bf16 v[200:203], v[52:55], v[40:43], v[200:203]
    v_add_u32 v9, s46, v5
    v_add_u32 v10, s46, v6
    v_add_u32 v11, s46, v7
    v_add_u32 v12, s46, v8
    v_mfma_f32_16x16x32_bf16 v[204:207], v[52:55], v[44:47], v[204:207]
    s_waitcnt vmcnt(5) lgkmcnt(4)
    s_setprio 3
    s_barrier
    v_mfma_f32_16x16x32_bf16 v[220:223], v[56:59], v[44:47], v[220:223]
    ds_read_b64_tr_b16 v[48:49], v11 offset:0
    v_mfma_f32_16x16x32_bf16 v[216:219], v[56:59], v[40:43], v[216:219]
    ds_read_b64_tr_b16 v[50:51], v11 offset:1280
    v_mfma_f32_16x16x32_bf16 v[212:215], v[56:59], v[36:39], v[212:215]
    ds_read_b128 v[16:19], v10 offset:18432
    v_mfma_f32_16x16x32_bf16 v[208:211], v[56:59], v[32:35], v[208:211]
    ds_read_b128 v[20:23], v10 offset:19456
    s_waitcnt lgkmcnt(6)
    v_mfma_f32_16x16x32_bf16 v[224:227], v[32:35], v[60:63], v[224:227]
    ds_read_b64_tr_b16 v[52:53], v11 offset:40960
    s_add_u32 s46, s46, 40960
    s_cmp_eq_u32 s46, 163840
    s_cselect_b32 s46, 0, s46
    v_mfma_f32_16x16x32_bf16 v[228:231], v[36:39], v[60:63], v[228:231]
    ds_read_b64_tr_b16 v[54:55], v11 offset:42240
    v_mfma_f32_16x16x32_bf16 v[232:235], v[40:43], v[60:63], v[232:235]
    ds_read_b128 v[24:27], v10 offset:20480
    v_mfma_f32_16x16x32_bf16 v[236:239], v[44:47], v[60:63], v[236:239]
    ds_read_b128 v[28:31], v10 offset:21504
    s_waitcnt lgkmcnt(8)
    v_mfma_f32_16x16x32_bf16 v[252:255], v[44:47], v[64:67], v[252:255]
    ds_read_b64_tr_b16 v[56:57], v11 offset:32
    v_mfma_f32_16x16x32_bf16 v[248:251], v[40:43], v[64:67], v[248:251]
    ds_read_b64_tr_b16 v[58:59], v11 offset:1312
    v_mfma_f32_16x16x32_bf16 v[244:247], v[36:39], v[64:67], v[244:247]
    v_mfma_f32_16x16x32_bf16 v[240:243], v[32:35], v[64:67], v[240:243]
    ds_read_b128 v[32:35], v10 offset:59392
    ds_read_b128 v[36:39], v10 offset:60416
    ds_read_b128 v[40:43], v10 offset:61440
    ds_read_b128 v[44:47], v10 offset:62464
L_g1_postB:
    s_setprio 3
    s_waitcnt lgkmcnt(6)
    v_mfma_f32_16x16x32_bf16 v[192:195], v[48:51], v[16:19], v[192:195]
    ds_read_b64_tr_b16 v[60:61], v11 offset:40992
    v_mfma_f32_16x16x32_bf16 v[196:199], v[48:51], v[20:23], v[196:199]
    ds_read_b64_tr_b16 v[62:63], v11 offset:42272
    v_mfma_f32_16x16x32_bf16 v[200:203], v[48:51], v[24:27], v[200:203]
    v_mfma_f32_16x16x32_bf16 v[204:207], v[48:51], v[28:31], v[204:207]
    s_waitcnt lgkmcnt(2)
    v_mfma_f32_16x16x32_bf16 v[192:195], v[52:55], v[32:35], v[192:195]
    ds_read_b64_tr_b16 v[64:65], v11 offset:64
    v_mfma_f32_16x16x32_bf16 v[196:199], v[52:55], v[36:39], v[196:199]
    ds_read_b64_tr_b16 v[66:67], v11 offset:1344
    v_mfma_f32_16x16x32_bf16 v[200:203], v[52:55], v[40:43], v[200:203]
    v_mfma_f32_16x16x32_bf16 v[204:207], v[52:55], v[44:47], v[204:207]
    s_waitcnt lgkmcnt(4)
    v_mfma_f32_16x16x32_bf16 v[208:211], v[56:59], v[16:19], v[208:211]
    ds_read_b64_tr_b16 v[48:49], v11 offset:41024
    v_mfma_f32_16x16x32_bf16 v[212:215], v[56:59], v[20:23], v[212:215]
    ds_read_b64_tr_b16 v[50:51], v11 offset:42304
    v_mfma_f32_16x16x32_bf16 v[216:219], v[56:59], v[24:27], v[216:219]
    v_mfma_f32_16x16x32_bf16 v[220:223], v[56:59], v[28:31], v[220:223]
    s_waitcnt lgkmcnt(4)
    v_mfma_f32_16x16x32_bf16 v[208:211], v[60:63], v[32:35], v[208:211]
    ds_read_b64_tr_b16 v[52:53], v12 offset:96
    v_mfma_f32_16x16x32_bf16 v[212:215], v[60:63], v[36:39], v[212:215]
    ds_read_b64_tr_b16 v[54:55], v12 offset:1376
    v_mfma_f32_16x16x32_bf16 v[216:219], v[60:63], v[40:43], v[216:219]
    v_mfma_f32_16x16x32_bf16 v[220:223], v[60:63], v[44:47], v[220:223]
    s_waitcnt lgkmcnt(4)
    v_mfma_f32_16x16x32_bf16 v[224:227], v[16:19], v[64:67], v[224:227]
    ds_read_b64_tr_b16 v[56:57], v12 offset:41056
    v_mfma_f32_16x16x32_bf16 v[228:231], v[20:23], v[64:67], v[228:231]
    ds_read_b64_tr_b16 v[58:59], v12 offset:42336
    v_mfma_f32_16x16x32_bf16 v[232:235], v[24:27], v[64:67], v[232:235]
    v_mfma_f32_16x16x32_bf16 v[236:239], v[28:31], v[64:67], v[236:239]
    s_waitcnt lgkmcnt(4)
    v_mfma_f32_16x16x32_bf16 v[224:227], v[32:35], v[48:51], v[224:227]
    ds_read_b64_tr_b16 v[60:61], v9 offset:192
    v_mfma_f32_16x16x32_bf16 v[228:231], v[36:39], v[48:51], v[228:231]
    ds_read_b64_tr_b16 v[62:63], v9 offset:2496
    v_mfma_f32_16x16x32_bf16 v[232:235], v[40:43], v[48:51], v[232:235]
    v_mfma_f32_16x16x32_bf16 v[236:239], v[44:47], v[48:51], v[236:239]
    s_waitcnt lgkmcnt(4)
    v_mfma_f32_16x16x32_bf16 v[240:243], v[16:19], v[52:55], v[240:243]
    ds_read_b64_tr_b16 v[64:65], v9 offset:41152
    v_mfma_f32_16x16x32_bf16 v[244:247], v[20:23], v[52:55], v[244:247]
    ds_read_b64_tr_b16 v[66:67], v9 offset:43456
    v_mfma_f32_16x16x32_bf16 v[248:251], v[24:27], v[52:55], v[248:251]
    v_mfma_f32_16x16x32_bf16 v[252:255], v[28:31], v[52:55], v[252:255]
    s_waitcnt lgkmcnt(4)
    v_mfma_f32_16x16x32_bf16 v[240:243], v[32:35], v[56:59], v[240:243]
    ds_read_b64_tr_b16 v[48:49], v9 offset:9408
    v_mfma_f32_16x16x32_bf16 v[244:247], v[36:39], v[56:59], v[244:247]
    ds_read_b64_tr_b16 v[50:51], v9 offset:11712
    v_mfma_f32_16x16x32_bf16 v[248:251], v[40:43], v[56:59], v[248:251]
    v_mfma_f32_16x16x32_bf16 v[252:255], v[44:47], v[56:59], v[252:255]
    s_mov_b32 s40, 0xbfb8aa3b
    s_mov_b32 s41, 0xbfb8aa3b
    s_mov_b32 s42, 1.0
    s_mov_b32 s43, 1.0
    s_lshl_b32 s48, s26, 4
    s_lshl_b32 s3, s31, 2
    s_add_u32 s48, s48, s3
    s_mul_i32 s48, s48, 147456
    s_lshr_b32 s3, s25, 1
    s_mul_i32 s3, s3, 9216
    s_add_u32 s48, s48, s3
    s_add_u32 s48, s48, 9699328
    s_and_b32 s3, s25, 1
    s_lshl_b32 s36, s3, 9
    s_add_u32 s36, s36, s48
    s_add_u32 s36, s36, 8192
    s_lshl_b32 s3, s3, 12
    s_add_u32 s48, s48, s3
    s_add_u32 s49, s48, 147456
    s_add_u32 s50, s48, 294912
    s_add_u32 s51, s48, 442368
    s_add_u32 s37, s36, 294912
    v_mov_b32 v15, 0x80000000
    v_cmp_eq_u32 vcc, 0, v0
    v_mov_b32 v14, s99
    s_lshl_b32 s38, s26, 2
    s_add_u32 s38, s38, s31
    v_cndmask_b32 v13, v15, 0, vcc
    s_lshl_b32 s39, s38, 8
    s_lshl_b32 s3, s25, 3
    s_add_u32 s39, s39, s3
    s_add_u32 s39, s39, 49295360
    s_mov_b32 s44, 0x3eae1a93
    s_mov_b32 s45, 0x3eae1a93
    s_lshl_b32 s53, s25, 3
    s_add_u32 s53, s53, s26
    s_mul_i32 s53, s53, 20480
    s_add_u32 s53, s53, 4456448
    s_mul_i32 s55, s31, 3072
    s_add_u32 s55, s55, 8192
    s_add_u32 s54, s55, s53
    s_lshl_b32 s52, s31, 11
    s_add_u32 s53, s53, s52
    v_and_b32 v2, 15, v0
    v_lshrrev_b32 v3, 5, v0
    v_bfe_u32 v4, v0, 4, 1
    v_lshlrev_b32 v5, 4, v2
    v_lshl_add_u32 v5, v3, 9, v5
    v_lshl_add_u32 v5, v4, 3, v5
    v_add_u32 v5, s52, v5
    v_add_u32 v70, 143360, v5
    v_add_u32 v5, 122880, v5
    s_add_u32 s52, s52, 122880
    s_add_u32 s55, s55, 122880
    v_mul_u32_u24 v6, 384, v4
    v_lshl_add_u32 v6, v3, 3, v6
    v_add_u32 v6, s55, v6
    v_subrev_u32 v7, 2, v2
    v_cmp_gt_u32 s[58:59], 6, v2
    v_and_b32 v8, 14, v2
    v_cmp_eq_u32 s[56:57], 8, v8
    v_cndmask_b32 v7, v7, v2, s[58:59]
    v_lshl_add_u32 v7, v7, 4, v6
    v_add_u32 v7, 256, v7
    s_or_b64 s[58:59], s[58:59], s[56:57]
    v_lshl_add_u32 v6, v2, 4, v6
    v_mov_b32 v68, 1.0
    v_mov_b32 v69, 0x3eae1a93
    v_cndmask_b32 v68, v68, v69, s[56:57]
    v_cmp_eq_u32 vcc, 2, v8
    v_cmp_eq_u32 s[56:57], 2, v2
    v_mov_b32 v69, 0x3f803f80
    v_add_u32 v71, s52, v1
    v_cndmask_b32 v69, 0, v69, s[56:57]
    v_add_u32 v72, s55, v1
    v_cvt_pk_bf16_f32 v208, v208, v209
    v_cvt_pk_bf16_f32 v209, v210, v211
    v_cvt_pk_bf16_f32 v224, v224, v225
    v_cvt_pk_bf16_f32 v225, v226, v227
    v_mul_f32 v240, v240, v68
    v_mul_f32 v241, v241, v68
    v_mul_f32 v242, v242, v68
    v_mul_f32 v243, v243, v68
    ds_write_b64 v5, v[208:209] offset:0
    ds_write_b64 v6, v[224:225] offset:0
    v_cvt_pk_bf16_f32 v240, v240, v241
    v_cvt_pk_bf16_f32 v241, v242, v243
    v_cndmask_b32 v240, v240, v69, vcc
    v_cndmask_b32 v241, v241, v69, vcc
    v_cvt_pk_bf16_f32 v212, v212, v213
    v_cvt_pk_bf16_f32 v213, v214, v215
    v_cvt_pk_bf16_f32 v228, v228, v229
    v_cvt_pk_bf16_f32 v229, v230, v231
    v_mul_f32 v244, v244, v68
    v_mul_f32 v245, v245, v68
    v_mul_f32 v246, v246, v68
    v_mul_f32 v247, v247, v68
    ds_write_b64 v5, v[212:213] offset:256
    ds_write_b64 v6, v[228:229] offset:768
    v_cvt_pk_bf16_f32 v244, v244, v245
    v_cvt_pk_bf16_f32 v245, v246, v247
    v_cndmask_b32 v244, v244, v69, vcc
    v_cndmask_b32 v245, v245, v69, vcc
    v_cvt_pk_bf16_f32 v216, v216, v217
    v_cvt_pk_bf16_f32 v217, v218, v219
    v_cvt_pk_bf16_f32 v232, v232, v233
    v_cvt_pk_bf16_f32 v233, v234, v235
    v_mul_f32 v248, v248, v68
    v_mul_f32 v249, v249, v68
    v_mul_f32 v250, v250, v68
    v_mul_f32 v251, v251, v68
    ds_write_b64 v5, v[216:217] offset:1024
    ds_write_b64 v6, v[232:233] offset:1536
    v_cvt_pk_bf16_f32 v248, v248, v249
    v_cvt_pk_bf16_f32 v249, v250, v251
    v_cndmask_b32 v248, v248, v69, vcc
    v_cndmask_b32 v249, v249, v69, vcc
    v_cvt_pk_bf16_f32 v220, v220, v221
    v_cvt_pk_bf16_f32 v221, v222, v223
    v_cvt_pk_bf16_f32 v236, v236, v237
    v_cvt_pk_bf16_f32 v237, v238, v239
    v_mul_f32 v252, v252, v68
    v_mul_f32 v253, v253, v68
    v_mul_f32 v254, v254, v68
    v_mul_f32 v255, v255, v68
    ds_write_b64 v5, v[220:221] offset:1280
    ds_write_b64 v6, v[236:237] offset:2304
    v_cvt_pk_bf16_f32 v252, v252, v253
    v_cvt_pk_bf16_f32 v253, v254, v255
    v_cndmask_b32 v252, v252, v69, vcc
    v_cndmask_b32 v253, v253, v69, vcc
    s_mov_b64 exec, s[58:59]
    ds_write_b64 v7, v[240:241] offset:0
    ds_write_b64 v7, v[244:245] offset:768
    ds_write_b64 v7, v[248:249] offset:1536
    ds_write_b64 v7, v[252:253] offset:2304
    s_mov_b64 exec, -1
    s_waitcnt lgkmcnt(0)
    ds_read_b128 v[76:79], v71 offset:0
    ds_read_b128 v[80:83], v71 offset:1024
    ds_read_b128 v[84:87], v72 offset:0
    ds_read_b128 v[88:91], v72 offset:1024
    ds_read_b128 v[92:95], v72 offset:2048
    v_pk_mul_f32 v[192:193], v[192:193], s[44:45]
    v_pk_mul_f32 v[194:195], v[194:195], s[44:45]
    v_cvt_pk_bf16_f32 v192, v192, v193
    v_cvt_pk_bf16_f32 v193, v194, v195
    v_pk_mul_f32 v[196:197], v[196:197], s[44:45]
    v_pk_mul_f32 v[198:199], v[198:199], s[44:45]
    v_cvt_pk_bf16_f32 v196, v196, v197
    v_cvt_pk_bf16_f32 v197, v198, v199
    v_pk_mul_f32 v[200:201], v[200:201], s[44:45]
    v_pk_mul_f32 v[202:203], v[202:203], s[44:45]
    v_cvt_pk_bf16_f32 v200, v200, v201
    v_cvt_pk_bf16_f32 v201, v202, v203
    v_pk_mul_f32 v[204:205], v[204:205], s[44:45]
    v_pk_mul_f32 v[206:207], v[206:207], s[44:45]
    v_cvt_pk_bf16_f32 v204, v204, v205
    v_cvt_pk_bf16_f32 v205, v206, v207
    s_waitcnt lgkmcnt(0)
    buffer_store_dwordx4 v[76:79], v1, s[20:23], s53 offen offset:0 sc1
    buffer_store_dwordx4 v[80:83], v1, s[20:23], s53 offen offset:1024 sc1
    buffer_store_dwordx4 v[84:87], v1, s[20:23], s54 offen offset:0 sc1
    buffer_store_dwordx4 v[88:91], v1, s[20:23], s54 offen offset:1024 sc1
    buffer_store_dwordx4 v[92:95], v1, s[20:23], s54 offen offset:2048 sc1
    ds_write_b64 v70, v[192:193] offset:0
    ds_write_b64 v70, v[196:197] offset:256
    ds_write_b64 v70, v[200:201] offset:1024
    ds_write_b64 v70, v[204:205] offset:1280
    s_lshl_b32 s3, s31, 2
    s_add_u32 s3, s3, 162816
    v_mov_b32 v71, s3
    v_mov_b32 v72, 1
    ds_write_b32 v71, v72
    s_setprio 3
    v_mul_u32_u24 v73, 147456, v4
    v_lshl_add_u32 v73, v3, 8, v73
    v_lshl_add_u32 v73, v2, 4, v73
    s_lshl_b32 s52, s25, 7
    s_lshl_b32 s3, s38, 2
    s_add_u32 s52, s52, s3
    s_add_u32 s52, s52, 49291264
    s_waitcnt lgkmcnt(5)
    v_mfma_f32_16x16x32_bf16 v[96:99], v[60:63], v[16:19], v[96:99]
    ds_read_b64_tr_b16 v[52:53], v9 offset:50368
    v_mfma_f32_16x16x32_bf16 v[100:103], v[60:63], v[20:23], v[100:103]
    ds_read_b64_tr_b16 v[54:55], v9 offset:52672
    v_mfma_f32_16x16x32_bf16 v[104:107], v[60:63], v[24:27], v[104:107]
    v_mfma_f32_16x16x32_bf16 v[108:111], v[60:63], v[28:31], v[108:111]
    s_waitcnt lgkmcnt(7)
    v_mfma_f32_16x16x32_bf16 v[96:99], v[64:67], v[32:35], v[96:99]
    ds_read_b64_tr_b16 v[56:57], v9 offset:224
    v_mfma_f32_16x16x32_bf16 v[100:103], v[64:67], v[36:39], v[100:103]
    ds_read_b64_tr_b16 v[58:59], v9 offset:2528
    v_mfma_f32_16x16x32_bf16 v[104:107], v[64:67], v[40:43], v[104:107]
    v_mfma_f32_16x16x32_bf16 v[108:111], v[64:67], v[44:47], v[108:111]
    s_waitcnt lgkmcnt(9)
    v_mfma_f32_16x16x32_bf16 v[112:115], v[48:51], v[16:19], v[112:115]
    ds_read_b64_tr_b16 v[60:61], v9 offset:41184
    v_mfma_f32_16x16x32_bf16 v[116:119], v[48:51], v[20:23], v[116:119]
    ds_read_b64_tr_b16 v[62:63], v9 offset:43488
    v_mfma_f32_16x16x32_bf16 v[120:123], v[48:51], v[24:27], v[120:123]
    v_mfma_f32_16x16x32_bf16 v[124:127], v[48:51], v[28:31], v[124:127]
    s_waitcnt lgkmcnt(4)
    v_mfma_f32_16x16x32_bf16 v[112:115], v[52:55], v[32:35], v[112:115]
    ds_read_b64_tr_b16 v[64:65], v9 offset:9440
    v_mfma_f32_16x16x32_bf16 v[116:119], v[52:55], v[36:39], v[116:119]
    ds_read_b64_tr_b16 v[66:67], v9 offset:11744
    v_mfma_f32_16x16x32_bf16 v[120:123], v[52:55], v[40:43], v[120:123]
    v_mfma_f32_16x16x32_bf16 v[124:127], v[52:55], v[44:47], v[124:127]
    s_waitcnt lgkmcnt(4)
    v_mfma_f32_16x16x32_bf16 v[128:131], v[56:59], v[16:19], v[128:131]
    ds_read_b64_tr_b16 v[48:49], v9 offset:50400
    v_mfma_f32_16x16x32_bf16 v[132:135], v[56:59], v[20:23], v[132:135]
    ds_read_b64_tr_b16 v[50:51], v9 offset:52704
    v_mfma_f32_16x16x32_bf16 v[136:139], v[56:59], v[24:27], v[136:139]
    v_mfma_f32_16x16x32_bf16 v[140:143], v[56:59], v[28:31], v[140:143]
    s_waitcnt lgkmcnt(4)
    v_mfma_f32_16x16x32_bf16 v[128:131], v[60:63], v[32:35], v[128:131]
    ds_read_b64_tr_b16 v[52:53], v9 offset:256
    v_mfma_f32_16x16x32_bf16 v[132:135], v[60:63], v[36:39], v[132:135]
    ds_read_b64_tr_b16 v[54:55], v9 offset:2560
    v_mfma_f32_16x16x32_bf16 v[136:139], v[60:63], v[40:43], v[136:139]
    v_mfma_f32_16x16x32_bf16 v[140:143], v[60:63], v[44:47], v[140:143]
    s_waitcnt lgkmcnt(4)
    v_mfma_f32_16x16x32_bf16 v[144:147], v[64:67], v[16:19], v[144:147]
    ds_read_b64_tr_b16 v[56:57], v9 offset:41216
    v_mfma_f32_16x16x32_bf16 v[148:151], v[64:67], v[20:23], v[148:151]
    ds_read_b64_tr_b16 v[58:59], v9 offset:43520
    v_mfma_f32_16x16x32_bf16 v[152:155], v[64:67], v[24:27], v[152:155]
    v_mfma_f32_16x16x32_bf16 v[156:159], v[64:67], v[28:31], v[156:159]
    s_waitcnt lgkmcnt(4)
    v_mfma_f32_16x16x32_bf16 v[144:147], v[48:51], v[32:35], v[144:147]
    ds_read_b64_tr_b16 v[60:61], v9 offset:9472
    v_mfma_f32_16x16x32_bf16 v[148:151], v[48:51], v[36:39], v[148:151]
    ds_read_b64_tr_b16 v[62:63], v9 offset:11776
    v_mfma_f32_16x16x32_bf16 v[152:155], v[48:51], v[40:43], v[152:155]
    v_mfma_f32_16x16x32_bf16 v[156:159], v[48:51], v[44:47], v[156:159]
    s_waitcnt lgkmcnt(4)
    v_mfma_f32_16x16x32_bf16 v[160:163], v[52:55], v[16:19], v[160:163]
    ds_read_b64_tr_b16 v[64:65], v9 offset:50432
    v_mfma_f32_16x16x32_bf16 v[164:167], v[52:55], v[20:23], v[164:167]
    ds_read_b64_tr_b16 v[66:67], v9 offset:52736
    v_mfma_f32_16x16x32_bf16 v[168:171], v[52:55], v[24:27], v[168:171]
    v_mfma_f32_16x16x32_bf16 v[172:175], v[52:55], v[28:31], v[172:175]
    s_waitcnt lgkmcnt(4)
    v_mfma_f32_16x16x32_bf16 v[160:163], v[56:59], v[32:35], v[160:163]
    v_mfma_f32_16x16x32_bf16 v[164:167], v[56:59], v[36:39], v[164:167]
    v_mfma_f32_16x16x32_bf16 v[168:171], v[56:59], v[40:43], v[168:171]
    v_mfma_f32_16x16x32_bf16 v[172:175], v[56:59], v[44:47], v[172:175]
    s_waitcnt lgkmcnt(2)
    v_mfma_f32_16x16x32_bf16 v[176:179], v[60:63], v[16:19], v[176:179]
    v_mfma_f32_16x16x32_bf16 v[180:183], v[60:63], v[20:23], v[180:183]
    v_mfma_f32_16x16x32_bf16 v[184:187], v[60:63], v[24:27], v[184:187]
    v_mfma_f32_16x16x32_bf16 v[188:191], v[60:63], v[28:31], v[188:191]
    s_waitcnt lgkmcnt(0)
    v_mfma_f32_16x16x32_bf16 v[176:179], v[64:67], v[32:35], v[176:179]
    v_mfma_f32_16x16x32_bf16 v[180:183], v[64:67], v[36:39], v[180:183]
    v_mfma_f32_16x16x32_bf16 v[184:187], v[64:67], v[40:43], v[184:187]
    v_mfma_f32_16x16x32_bf16 v[188:191], v[64:67], v[44:47], v[188:191]
    s_waitcnt vmcnt(5)
    v_mov_b32 v72, 2
    ds_write_b32 v71, v72
    v_pk_mul_f32 v[96:97], v[96:97], s[40:41]
    v_pk_mul_f32 v[98:99], v[98:99], s[40:41]
    v_pk_mul_f32 v[128:129], v[128:129], s[40:41]
    v_pk_mul_f32 v[130:131], v[130:131], s[40:41]
    v_exp_f32 v96, v96
    v_exp_f32 v97, v97
    v_exp_f32 v98, v98
    v_exp_f32 v99, v99
    v_exp_f32 v128, v128
    v_exp_f32 v129, v129
    v_exp_f32 v130, v130
    v_exp_f32 v131, v131
    v_pk_add_f32 v[96:97], v[96:97], s[42:43]
    v_pk_add_f32 v[98:99], v[98:99], s[42:43]
    v_pk_add_f32 v[128:129], v[128:129], s[42:43]
    v_pk_add_f32 v[130:131], v[130:131], s[42:43]
    v_rcp_f32 v96, v96
    v_rcp_f32 v97, v97
    v_rcp_f32 v98, v98
    v_rcp_f32 v99, v99
    v_rcp_f32 v128, v128
    v_rcp_f32 v129, v129
    v_rcp_f32 v130, v130
    v_rcp_f32 v131, v131
    v_pk_mul_f32 v[96:97], v[96:97], v[112:113]
    v_pk_mul_f32 v[98:99], v[98:99], v[114:115]
    v_pk_mul_f32 v[128:129], v[128:129], v[144:145]
    v_pk_mul_f32 v[130:131], v[130:131], v[146:147]
    v_cvt_pk_bf16_f32 v96, v96, v97
    v_cvt_pk_bf16_f32 v97, v98, v99
    v_cvt_pk_bf16_f32 v98, v128, v129
    v_cvt_pk_bf16_f32 v99, v130, v131
    buffer_store_dwordx4 v[96:99], v1, s[20:23], s48 offen offset:3072 sc1
    v_pk_mul_f32 v[100:101], v[100:101], s[40:41]
    v_pk_mul_f32 v[102:103], v[102:103], s[40:41]
    v_pk_mul_f32 v[132:133], v[132:133], s[40:41]
    v_pk_mul_f32 v[134:135], v[134:135], s[40:41]
    v_exp_f32 v100, v100
    v_exp_f32 v101, v101
    v_exp_f32 v102, v102
    v_exp_f32 v103, v103
    v_exp_f32 v132, v132
    v_exp_f32 v133, v133
    v_exp_f32 v134, v134
    v_exp_f32 v135, v135
    v_pk_add_f32 v[100:101], v[100:101], s[42:43]
    v_pk_add_f32 v[102:103], v[102:103], s[42:43]
    v_pk_add_f32 v[132:133], v[132:133], s[42:43]
    v_pk_add_f32 v[134:135], v[134:135], s[42:43]
    v_rcp_f32 v100, v100
    v_rcp_f32 v101, v101
    v_rcp_f32 v102, v102
    v_rcp_f32 v103, v103
    v_rcp_f32 v132, v132
    v_rcp_f32 v133, v133
    v_rcp_f32 v134, v134
    v_rcp_f32 v135, v135
    v_pk_mul_f32 v[100:101], v[100:101], v[116:117]
    v_pk_mul_f32 v[102:103], v[102:103], v[118:119]
    v_pk_mul_f32 v[132:133], v[132:133], v[148:149]
    v_pk_mul_f32 v[134:135], v[134:135], v[150:151]
    v_cvt_pk_bf16_f32 v100, v100, v101
    v_cvt_pk_bf16_f32 v101, v102, v103
    v_cvt_pk_bf16_f32 v102, v132, v133
    v_cvt_pk_bf16_f32 v103, v134, v135
    buffer_store_dwordx4 v[100:103], v1, s[20:23], s49 offen offset:3072 sc1
    v_pk_mul_f32 v[104:105], v[104:105], s[40:41]
    v_pk_mul_f32 v[106:107], v[106:107], s[40:41]
    v_pk_mul_f32 v[136:137], v[136:137], s[40:41]
    v_pk_mul_f32 v[138:139], v[138:139], s[40:41]
    v_exp_f32 v104, v104
    v_exp_f32 v105, v105
    v_exp_f32 v106, v106
    v_exp_f32 v107, v107
    v_exp_f32 v136, v136
    v_exp_f32 v137, v137
    v_exp_f32 v138, v138
    v_exp_f32 v139, v139
    v_pk_add_f32 v[104:105], v[104:105], s[42:43]
    v_pk_add_f32 v[106:107], v[106:107], s[42:43]
    v_pk_add_f32 v[136:137], v[136:137], s[42:43]
    v_pk_add_f32 v[138:139], v[138:139], s[42:43]
    v_rcp_f32 v104, v104
    v_rcp_f32 v105, v105
    v_rcp_f32 v106, v106
    v_rcp_f32 v107, v107
    v_rcp_f32 v136, v136
    v_rcp_f32 v137, v137
    v_rcp_f32 v138, v138
    v_rcp_f32 v139, v139
    v_pk_mul_f32 v[104:105], v[104:105], v[120:121]
    v_pk_mul_f32 v[106:107], v[106:107], v[122:123]
    v_pk_mul_f32 v[136:137], v[136:137], v[152:153]
    v_pk_mul_f32 v[138:139], v[138:139], v[154:155]
    v_cvt_pk_bf16_f32 v104, v104, v105
    v_cvt_pk_bf16_f32 v105, v106, v107
    v_cvt_pk_bf16_f32 v106, v136, v137
    v_cvt_pk_bf16_f32 v107, v138, v139
    buffer_store_dwordx4 v[104:107], v1, s[20:23], s50 offen offset:3072 sc1
    s_waitcnt vmcnt(3)
    buffer_store_dword v14, v13, s[20:23], s52 offen offset:0 sc0 sc1
    v_pk_mul_f32 v[108:109], v[108:109], s[40:41]
    v_pk_mul_f32 v[110:111], v[110:111], s[40:41]
    v_pk_mul_f32 v[140:141], v[140:141], s[40:41]
    v_pk_mul_f32 v[142:143], v[142:143], s[40:41]
    v_exp_f32 v108, v108
    v_exp_f32 v109, v109
    v_exp_f32 v110, v110
    v_exp_f32 v111, v111
    v_exp_f32 v140, v140
    v_exp_f32 v141, v141
    v_exp_f32 v142, v142
    v_exp_f32 v143, v143
    v_pk_add_f32 v[108:109], v[108:109], s[42:43]
    v_pk_add_f32 v[110:111], v[110:111], s[42:43]
    v_pk_add_f32 v[140:141], v[140:141], s[42:43]
    v_pk_add_f32 v[142:143], v[142:143], s[42:43]
    v_rcp_f32 v108, v108
    v_rcp_f32 v109, v109
    v_rcp_f32 v110, v110
    v_rcp_f32 v111, v111
    v_rcp_f32 v140, v140
    v_rcp_f32 v141, v141
    v_rcp_f32 v142, v142
    v_rcp_f32 v143, v143
    v_pk_mul_f32 v[108:109], v[108:109], v[124:125]
    v_pk_mul_f32 v[110:111], v[110:111], v[126:127]
    v_pk_mul_f32 v[140:141], v[140:141], v[156:157]
    v_pk_mul_f32 v[142:143], v[142:143], v[158:159]
    v_cvt_pk_bf16_f32 v108, v108, v109
    v_cvt_pk_bf16_f32 v109, v110, v111
    v_cvt_pk_bf16_f32 v110, v140, v141
    v_cvt_pk_bf16_f32 v111, v142, v143
    buffer_store_dwordx4 v[108:111], v1, s[20:23], s51 offen offset:3072 sc1
    v_pk_mul_f32 v[160:161], v[160:161], s[40:41]
    v_pk_mul_f32 v[162:163], v[162:163], s[40:41]
    v_pk_mul_f32 v[164:165], v[164:165], s[40:41]
    v_pk_mul_f32 v[166:167], v[166:167], s[40:41]
    v_exp_f32 v160, v160
    v_exp_f32 v161, v161
    v_exp_f32 v162, v162
    v_exp_f32 v163, v163
    v_exp_f32 v164, v164
    v_exp_f32 v165, v165
    v_exp_f32 v166, v166
    v_exp_f32 v167, v167
    v_pk_add_f32 v[160:161], v[160:161], s[42:43]
    v_pk_add_f32 v[162:163], v[162:163], s[42:43]
    v_pk_add_f32 v[164:165], v[164:165], s[42:43]
    v_pk_add_f32 v[166:167], v[166:167], s[42:43]
    v_rcp_f32 v160, v160
    v_rcp_f32 v161, v161
    v_rcp_f32 v162, v162
    v_rcp_f32 v163, v163
    v_rcp_f32 v164, v164
    v_rcp_f32 v165, v165
    v_rcp_f32 v166, v166
    v_rcp_f32 v167, v167
    v_pk_mul_f32 v[160:161], v[160:161], v[176:177]
    v_pk_mul_f32 v[162:163], v[162:163], v[178:179]
    v_pk_mul_f32 v[164:165], v[164:165], v[180:181]
    v_pk_mul_f32 v[166:167], v[166:167], v[182:183]
    v_cvt_pk_bf16_f32 v160, v160, v161
    v_cvt_pk_bf16_f32 v161, v162, v163
    v_cvt_pk_bf16_f32 v162, v164, v165
    v_cvt_pk_bf16_f32 v163, v166, v167
    s_nop 1
    v_permlane16_swap_b32 v160, v162
    v_permlane16_swap_b32 v161, v163
    buffer_store_dwordx4 v[160:163], v73, s[20:23], s36 offen sc1
    v_pk_mul_f32 v[168:169], v[168:169], s[40:41]
    v_pk_mul_f32 v[170:171], v[170:171], s[40:41]
    v_pk_mul_f32 v[172:173], v[172:173], s[40:41]
    v_pk_mul_f32 v[174:175], v[174:175], s[40:41]
    v_exp_f32 v168, v168
    v_exp_f32 v169, v169
    v_exp_f32 v170, v170
    v_exp_f32 v171, v171
    v_exp_f32 v172, v172
    v_exp_f32 v173, v173
    v_exp_f32 v174, v174
    v_exp_f32 v175, v175
    v_pk_add_f32 v[168:169], v[168:169], s[42:43]
    v_pk_add_f32 v[170:171], v[170:171], s[42:43]
    v_pk_add_f32 v[172:173], v[172:173], s[42:43]
    v_pk_add_f32 v[174:175], v[174:175], s[42:43]
    v_rcp_f32 v168, v168
    v_rcp_f32 v169, v169
    v_rcp_f32 v170, v170
    v_rcp_f32 v171, v171
    v_rcp_f32 v172, v172
    v_rcp_f32 v173, v173
    v_rcp_f32 v174, v174
    v_rcp_f32 v175, v175
    v_pk_mul_f32 v[168:169], v[168:169], v[184:185]
    v_pk_mul_f32 v[170:171], v[170:171], v[186:187]
    v_pk_mul_f32 v[172:173], v[172:173], v[188:189]
    v_pk_mul_f32 v[174:175], v[174:175], v[190:191]
    v_cvt_pk_bf16_f32 v168, v168, v169
    v_cvt_pk_bf16_f32 v169, v170, v171
    v_cvt_pk_bf16_f32 v170, v172, v173
    v_cvt_pk_bf16_f32 v171, v174, v175
    s_nop 1
    v_permlane16_swap_b32 v168, v170
    v_permlane16_swap_b32 v169, v171
    buffer_store_dwordx4 v[168:171], v73, s[20:23], s37 offen sc1
    s_setprio 1
    s_and_b32 s27, s31, 1
    s_lshr_b32 s28, s31, 1
    v_bfe_u32 v9, v0, 4, 1
    v_mul_u32_u24 v4, 768, v9
    v_bfe_u32 v9, v0, 2, 1
    v_mul_u32_u24 v9, 384, v9
    v_add_u32 v4, v4, v9
    v_bfe_u32 v9, v0, 3, 1
    v_lshl_add_u32 v4, v9, 3, v4
    v_and_b32 v9, 3, v0
    v_lshl_add_u32 v4, v9, 1, v4
    v_lshrrev_b32 v9, 5, v0
    v_lshl_add_u32 v4, v9, 4, v4
    v_add_u32 v4, 8512, v4
    s_lshl_b32 s3, s27, 1
    s_add_u32 s29, s3, s28
    s_xor_b32 s30, s29, 1
    s_lshl_b32 s3, s30, 11
    s_add_u32 s3, s3, 143360
    v_add_u32 v2, s3, v1
    s_lshl_b32 s3, s29, 11
    s_add_u32 s3, s3, 143360
    v_add_u32 v196, s3, v1
    s_mul_i32 s3, s30, 3072
    s_add_u32 s3, s3, 122880
    v_add_u32 v10, s3, v4
    s_mul_i32 s3, s29, 3072
    s_add_u32 s3, s3, 122880
    v_add_u32 v197, s3, v4
    s_mov_b32 s100, 1600000
    v_mov_b32 v194, 162816
L_parall_lw_16:
    ds_read_b128 v[190:193], v194
    s_waitcnt lgkmcnt(0)
    v_min3_u32 v190, v190, v191, v192
    v_min_u32 v190, v190, v193
    s_nop 0
    v_readfirstlane_b32 s101, v190
    s_cmp_ge_u32 s101, 1
    s_cbranch_scc1 L_parall_lw_16_ok
    s_sub_u32 s100, s100, 1
    s_cbranch_scc0 L_parall_lw_16
L_parall_lw_16_ok:
    ds_read_b128 v[16:19], v2 offset:0
    ds_read_u16 v32, v10 offset:32
    ds_read_b128 v[20:23], v2 offset:1024
    ds_read_u16 v36, v10 offset:1568
    ds_read_b128 v[24:27], v196 offset:0
    ds_read_u16 v40, v197 offset:32
    ds_read_b128 v[28:31], v196 offset:1024
    ds_read_u16 v44, v197 offset:1568
    v_and_b32 v10, 31, v0
    v_min_u32 v2, 19, v10
    v_cmp_eq_u32 vcc, 22, v10
    v_mul_u32_u24 v5, 384, v9
    s_lshl_b32 s3, s28, 12
    v_add_u32 v3, s3, v1
    v_cndmask_b32 v2, v2, 18, vcc
    v_lshl_add_u32 v5, v2, 4, v5
    s_mul_i32 s3, s28, 6144
    v_add_u32 v4, s3, v4
    s_add_u32 s3, s3, 8192
    v_add_u32 v5, s3, v5
    v_add_u32 v6, 122880, v3
    v_add_u32 v7, 122880, v4
    v_add_u32 v8, 122880, v5
    v_cmp_gt_u32 s[40:41], 32, v0
    ds_read_b128 v[152:155], v6 offset:0
    ds_read_u16 v160, v7 offset:0
    ds_read_b128 v[168:171], v8 offset:0
    ds_read_b128 v[172:175], v8 offset:768
    v_mov_b32 v33, 0
    v_mov_b32 v34, 0
    v_mov_b32 v35, 0
    v_mov_b32 v37, 0
    v_mov_b32 v38, 0
    v_mov_b32 v39, 0
    v_mov_b32 v41, 0
    v_mov_b32 v42, 0
    v_mov_b32 v43, 0
    v_mov_b32 v45, 0
    v_mov_b32 v46, 0
    v_mov_b32 v47, 0
    v_mov_b32 v161, 0x3f80
    v_mov_b32 v162, 0
    v_mov_b32 v163, 0
    v_mov_b32 v165, 0x3f80
    v_mov_b32 v166, 0
    v_mov_b32 v167, 0
    s_waitcnt lgkmcnt(2)
    v_mfma_f32_32x32x16_bf16 v[80:95], v[152:155], v[16:19], 0
    v_mfma_f32_32x32x16_bf16 v[80:95], v[160:163], v[32:35], v[80:95]
    v_mfma_f32_32x32x16_bf16 v[96:111], v[152:155], v[20:23], 0
    v_mfma_f32_32x32x16_bf16 v[96:111], v[160:163], v[36:39], v[96:111]
    v_mfma_f32_32x32x16_bf16 v[112:127], v[152:155], v[24:27], 0
    v_mfma_f32_32x32x16_bf16 v[112:127], v[160:163], v[40:43], v[112:127]
    v_mfma_f32_32x32x16_bf16 v[128:143], v[152:155], v[28:31], 0
    v_mfma_f32_32x32x16_bf16 v[128:143], v[160:163], v[44:47], v[128:143]
    v_mov_b32 v180, 0
    v_mov_b32 v181, 0
    v_mov_b32 v182, 0
    v_mov_b32 v183, 0
    v_mov_b32 v144, 0
    v_mov_b32 v145, 0
    v_mov_b32 v146, 0
    v_mov_b32 v147, 0
    v_mov_b32 v148, 0
    v_mov_b32 v149, 0
    v_mov_b32 v150, 0
    v_mov_b32 v151, 0
    s_mov_b32 s32, 40960
    s_lshl_b32 s3, s31, 2
    s_add_u32 s3, s3, 162816
    v_mov_b32 v198, s3
    s_mov_b32 s35, 0
    s_mov_b32 s42, 0x3f800000
    v_mov_b32 v199, v15
    v_mov_b32 v200, v15
    s_movk_i32 s93, 0xe1
    s_mov_b32 s33, 0
    v_max3_f32 v188, v80, v81, v82
    v_max3_f32 v188, v188, v83, v84
    v_max3_f32 v188, v188, v85, v86
    v_max3_f32 v188, v188, v87, v88
    v_max3_f32 v188, v188, v89, v90
    v_max3_f32 v188, v188, v91, v92
    v_max3_f32 v188, v188, v93, v94
    v_max_f32 v188, v188, v95
    v_mov_b32 v189, v188
    s_nop 1
    v_permlane32_swap_b32 v188, v189
    s_nop 1
    v_max_f32 v188, v188, v189
    v_rndne_f32 v188, v188
    v_add_f32 v188, 0x42c00000, v188
    v_cvt_pk_bf16_f32 v189, v188, v188
    v_and_b32 v184, 0xffff0000, v189
    v_lshrrev_b32 v189, 16, v189
    v_xor_b32 v189, 0x8000, v189
    v_cndmask_b32 v33, 0, v189, s[40:41]
    v_mov_b32 v80, 0
    v_mov_b32 v81, 0
    v_mov_b32 v82, 0
    v_mov_b32 v83, 0
    v_mov_b32 v84, 0
    v_mov_b32 v85, 0
    v_mov_b32 v86, 0
    v_mov_b32 v87, 0
    v_mov_b32 v88, 0
    v_mov_b32 v89, 0
    v_mov_b32 v90, 0
    v_max3_f32 v188, v96, v97, v98
    v_max3_f32 v188, v188, v99, v100
    v_max3_f32 v188, v188, v101, v102
    v_max3_f32 v188, v188, v103, v104
    v_max3_f32 v188, v188, v105, v106
    v_max3_f32 v188, v188, v107, v108
    v_max3_f32 v188, v188, v109, v110
    v_max_f32 v188, v188, v111
    v_mov_b32 v189, v188
    s_nop 1
    v_permlane32_swap_b32 v188, v189
    s_nop 1
    v_max_f32 v188, v188, v189
    v_rndne_f32 v188, v188
    v_add_f32 v188, 0x42c00000, v188
    v_cvt_pk_bf16_f32 v189, v188, v188
    v_and_b32 v185, 0xffff0000, v189
    v_lshrrev_b32 v189, 16, v189
    v_xor_b32 v189, 0x8000, v189
    v_cndmask_b32 v37, 0, v189, s[40:41]
    v_mfma_f32_32x32x16_bf16 v[48:63], v[152:155], v[16:19], 0
    v_mfma_f32_32x32x16_bf16 v[48:63], v[160:163], v[32:35], v[48:63]
    v_mov_b32 v96, 0
    v_mov_b32 v97, 0
    v_mov_b32 v98, 0
    v_mov_b32 v99, 0
    v_mov_b32 v100, 0
    v_mov_b32 v101, 0
    v_mov_b32 v102, 0
    v_mov_b32 v103, 0
    v_mov_b32 v104, 0
    v_mov_b32 v105, 0
    v_mov_b32 v106, 0
    v_max3_f32 v188, v112, v113, v114
    v_max3_f32 v188, v188, v115, v116
    v_max3_f32 v188, v188, v117, v118
    v_max3_f32 v188, v188, v119, v120
    v_max3_f32 v188, v188, v121, v122
    v_max3_f32 v188, v188, v123, v124
    v_max3_f32 v188, v188, v125, v126
    v_max_f32 v188, v188, v127
    v_mov_b32 v189, v188
    s_nop 1
    v_permlane32_swap_b32 v188, v189
    s_nop 1
    v_max_f32 v188, v188, v189
    v_rndne_f32 v188, v188
    v_add_f32 v188, 0x42c00000, v188
    v_cvt_pk_bf16_f32 v189, v188, v188
    v_and_b32 v186, 0xffff0000, v189
    v_lshrrev_b32 v189, 16, v189
    v_xor_b32 v189, 0x8000, v189
    v_cndmask_b32 v41, 0, v189, s[40:41]
    v_mov_b32 v112, 0
    v_mov_b32 v113, 0
    v_mov_b32 v114, 0
    v_mov_b32 v115, 0
    v_mov_b32 v116, 0
    v_mov_b32 v117, 0
    v_mov_b32 v118, 0
    v_mov_b32 v119, 0
    v_mov_b32 v120, 0
    v_mov_b32 v121, 0
    v_mov_b32 v122, 0
    v_max3_f32 v188, v128, v129, v130
    v_max3_f32 v188, v188, v131, v132
    v_max3_f32 v188, v188, v133, v134
    v_max3_f32 v188, v188, v135, v136
    v_max3_f32 v188, v188, v137, v138
    v_max3_f32 v188, v188, v139, v140
    v_max3_f32 v188, v188, v141, v142
    v_max_f32 v188, v188, v143
    v_mov_b32 v189, v188
    s_nop 1
    v_permlane32_swap_b32 v188, v189
    s_nop 1
    v_max_f32 v188, v188, v189
    v_rndne_f32 v188, v188
    v_add_f32 v188, 0x42c00000, v188
    v_cvt_pk_bf16_f32 v189, v188, v188
    v_and_b32 v187, 0xffff0000, v189
    v_lshrrev_b32 v189, 16, v189
    v_xor_b32 v189, 0x8000, v189
    v_cndmask_b32 v45, 0, v189, s[40:41]
    v_mov_b32 v128, 0
    v_mov_b32 v129, 0
    v_mov_b32 v130, 0
    v_mov_b32 v131, 0
    v_mov_b32 v132, 0
    v_mov_b32 v133, 0
    v_mov_b32 v134, 0
    v_mov_b32 v135, 0
    v_mov_b32 v136, 0
    v_mov_b32 v137, 0
    v_mov_b32 v138, 0
    s_waitcnt lgkmcnt(0)
    s_setprio 1
.p2align 6
L_at_loop:
    v_mfma_f32_32x32x16_bf16 v[64:79], v[152:155], v[20:23], 0
    v_exp_f32 v48, v48
    v_exp_f32 v49, v49
    v_exp_f32 v50, v50
    v_exp_f32 v51, v51
    v_exp_f32 v52, v52
    v_mfma_f32_32x32x16_bf16 v[128:143], v[180:183], v[148:151], v[128:143]
    v_exp_f32 v53, v53
    v_exp_f32 v54, v54
    v_exp_f32 v55, v55
    v_cvt_pk_bf16_f32 v144, v48, v49
    v_cvt_pk_bf16_f32 v145, v50, v51
    v_cvt_pk_bf16_f32 v146, v52, v53
    v_cvt_pk_bf16_f32 v147, v54, v55
    v_mfma_f32_32x32x16_bf16 v[64:79], v[160:163], v[36:39], v[64:79]
    v_exp_f32 v56, v56
    v_exp_f32 v57, v57
    v_exp_f32 v58, v58
    v_exp_f32 v59, v59
    v_exp_f32 v60, v60
    v_mfma_f32_32x32x16_bf16 v[80:95], v[168:171], v[144:147], v[80:95]
    v_exp_f32 v61, v61
    v_exp_f32 v62, v62
    v_exp_f32 v63, v63
    v_cvt_pk_bf16_f32 v148, v56, v57
    v_cvt_pk_bf16_f32 v149, v58, v59
    v_cvt_pk_bf16_f32 v150, v60, v61
    v_cvt_pk_bf16_f32 v151, v62, v63
    s_cbranch_execz L_dry_done
L_dry_1:
    v_mfma_f32_32x32x16_bf16 v[48:63], v[152:155], v[24:27], 0
    ds_read_b128 v[156:159], v6 offset:1024
    v_exp_f32 v64, v64
    ds_read_u16 v164, v7 offset:1536
    v_exp_f32 v65, v65
    v_exp_f32 v66, v66
    v_exp_f32 v67, v67
    v_exp_f32 v68, v68
    v_mfma_f32_32x32x16_bf16 v[80:95], v[172:175], v[148:151], v[80:95]
    v_exp_f32 v69, v69
    v_exp_f32 v70, v70
    v_exp_f32 v71, v71
    v_cvt_pk_bf16_f32 v144, v64, v65
    v_cvt_pk_bf16_f32 v145, v66, v67
    v_cvt_pk_bf16_f32 v146, v68, v69
    v_cvt_pk_bf16_f32 v147, v70, v71
    v_mfma_f32_32x32x16_bf16 v[48:63], v[160:163], v[40:43], v[48:63]
    v_exp_f32 v72, v72
    v_exp_f32 v73, v73
    v_exp_f32 v74, v74
    v_exp_f32 v75, v75
    v_exp_f32 v76, v76
    v_mfma_f32_32x32x16_bf16 v[96:111], v[168:171], v[144:147], v[96:111]
    v_exp_f32 v77, v77
    v_exp_f32 v78, v78
    v_exp_f32 v79, v79
    v_cvt_pk_bf16_f32 v148, v72, v73
    v_cvt_pk_bf16_f32 v149, v74, v75
    v_cvt_pk_bf16_f32 v150, v76, v77
    v_cvt_pk_bf16_f32 v151, v78, v79
    v_mfma_f32_32x32x16_bf16 v[64:79], v[152:155], v[28:31], 0
    ds_read_b128 v[176:179], v8 offset:1536
    v_exp_f32 v48, v48
    ds_read_b128 v[180:183], v8 offset:2304
    v_exp_f32 v49, v49
    v_exp_f32 v50, v50
    v_exp_f32 v51, v51
    v_exp_f32 v52, v52
    v_mfma_f32_32x32x16_bf16 v[96:111], v[172:175], v[148:151], v[96:111]
    v_exp_f32 v53, v53
    v_exp_f32 v54, v54
    v_exp_f32 v55, v55
    v_cvt_pk_bf16_f32 v144, v48, v49
    v_cvt_pk_bf16_f32 v145, v50, v51
    v_cvt_pk_bf16_f32 v146, v52, v53
    v_cvt_pk_bf16_f32 v147, v54, v55
    v_mfma_f32_32x32x16_bf16 v[64:79], v[160:163], v[44:47], v[64:79]
    v_exp_f32 v56, v56
    v_exp_f32 v57, v57
    v_exp_f32 v58, v58
    v_exp_f32 v59, v59
    v_exp_f32 v60, v60
    v_mfma_f32_32x32x16_bf16 v[112:127], v[168:171], v[144:147], v[112:127]
    v_exp_f32 v61, v61
    v_exp_f32 v62, v62
    v_exp_f32 v63, v63
    v_cvt_pk_bf16_f32 v148, v56, v57
    v_cvt_pk_bf16_f32 v149, v58, v59
    v_cvt_pk_bf16_f32 v150, v60, v61
    v_cvt_pk_bf16_f32 v151, v62, v63
    s_waitcnt lgkmcnt(0)
    v_mfma_f32_32x32x16_bf16 v[48:63], v[156:159], v[16:19], 0
    v_exp_f32 v64, v64
    v_exp_f32 v65, v65
    v_exp_f32 v66, v66
    v_exp_f32 v67, v67
    v_exp_f32 v68, v68
    v_mfma_f32_32x32x16_bf16 v[112:127], v[172:175], v[148:151], v[112:127]
    v_exp_f32 v69, v69
    v_exp_f32 v70, v70
    v_exp_f32 v71, v71
    v_cvt_pk_bf16_f32 v144, v64, v65
    v_cvt_pk_bf16_f32 v145, v66, v67
    v_cvt_pk_bf16_f32 v146, v68, v69
    v_cvt_pk_bf16_f32 v147, v70, v71
    v_mfma_f32_32x32x16_bf16 v[48:63], v[164:167], v[32:35], v[48:63]
    v_exp_f32 v72, v72
    v_exp_f32 v73, v73
    v_exp_f32 v74, v74
    v_exp_f32 v75, v75
    v_exp_f32 v76, v76
    v_mfma_f32_32x32x16_bf16 v[128:143], v[168:171], v[144:147], v[128:143]
    v_exp_f32 v77, v77
    v_exp_f32 v78, v78
    v_exp_f32 v79, v79
    v_cvt_pk_bf16_f32 v148, v72, v73
    v_cvt_pk_bf16_f32 v149, v74, v75
    v_cvt_pk_bf16_f32 v150, v76, v77
    v_cvt_pk_bf16_f32 v151, v78, v79
    v_mfma_f32_32x32x16_bf16 v[64:79], v[156:159], v[20:23], 0
    v_exp_f32 v48, v48
    v_exp_f32 v49, v49
    v_exp_f32 v50, v50
    v_exp_f32 v51, v51
    v_exp_f32 v52, v52
    v_mfma_f32_32x32x16_bf16 v[128:143], v[172:175], v[148:151], v[128:143]
    v_exp_f32 v53, v53
    v_exp_f32 v54, v54
    v_exp_f32 v55, v55
    v_cvt_pk_bf16_f32 v144, v48, v49
    v_cvt_pk_bf16_f32 v145, v50, v51
    v_cvt_pk_bf16_f32 v146, v52, v53
    v_cvt_pk_bf16_f32 v147, v54, v55
    v_mfma_f32_32x32x16_bf16 v[64:79], v[164:167], v[36:39], v[64:79]
    v_exp_f32 v56, v56
    v_exp_f32 v57, v57
    v_exp_f32 v58, v58
    v_exp_f32 v59, v59
    v_exp_f32 v60, v60
    v_mfma_f32_32x32x16_bf16 v[80:95], v[176:179], v[144:147], v[80:95]
    v_exp_f32 v61, v61
    v_exp_f32 v62, v62
    v_exp_f32 v63, v63
    v_cvt_pk_bf16_f32 v148, v56, v57
    v_cvt_pk_bf16_f32 v149, v58, v59
    v_cvt_pk_bf16_f32 v150, v60, v61
    v_cvt_pk_bf16_f32 v151, v62, v63
    s_cbranch_execz L_dry_done
L_dry_2:
    v_mfma_f32_32x32x16_bf16 v[48:63], v[156:159], v[24:27], 0
    ds_read_b128 v[152:155], v6 offset:2048
    v_exp_f32 v64, v64
    ds_read_u16 v160, v7 offset:3072
    v_exp_f32 v65, v65
    v_exp_f32 v66, v66
    v_exp_f32 v67, v67
    v_exp_f32 v68, v68
    v_mfma_f32_32x32x16_bf16 v[80:95], v[180:183], v[148:151], v[80:95]
    v_exp_f32 v69, v69
    v_exp_f32 v70, v70
    v_exp_f32 v71, v71
    v_cvt_pk_bf16_f32 v144, v64, v65
    v_cvt_pk_bf16_f32 v145, v66, v67
    v_cvt_pk_bf16_f32 v146, v68, v69
    v_cvt_pk_bf16_f32 v147, v70, v71
    v_mfma_f32_32x32x16_bf16 v[48:63], v[164:167], v[40:43], v[48:63]
    v_exp_f32 v72, v72
    v_exp_f32 v73, v73
    v_exp_f32 v74, v74
    v_exp_f32 v75, v75
    v_exp_f32 v76, v76
    v_mfma_f32_32x32x16_bf16 v[96:111], v[176:179], v[144:147], v[96:111]
    v_exp_f32 v77, v77
    v_exp_f32 v78, v78
    v_exp_f32 v79, v79
    v_cvt_pk_bf16_f32 v148, v72, v73
    v_cvt_pk_bf16_f32 v149, v74, v75
    v_cvt_pk_bf16_f32 v150, v76, v77
    v_cvt_pk_bf16_f32 v151, v78, v79
    v_mfma_f32_32x32x16_bf16 v[64:79], v[156:159], v[28:31], 0
    ds_read_b128 v[168:171], v8 offset:3072
    v_exp_f32 v48, v48
    ds_read_b128 v[172:175], v8 offset:3840
    v_exp_f32 v49, v49
    v_exp_f32 v50, v50
    v_exp_f32 v51, v51
    v_exp_f32 v52, v52
    v_mfma_f32_32x32x16_bf16 v[96:111], v[180:183], v[148:151], v[96:111]
    v_exp_f32 v53, v53
    v_exp_f32 v54, v54
    v_exp_f32 v55, v55
    v_cvt_pk_bf16_f32 v144, v48, v49
    v_cvt_pk_bf16_f32 v145, v50, v51
    v_cvt_pk_bf16_f32 v146, v52, v53
    v_cvt_pk_bf16_f32 v147, v54, v55
    v_mfma_f32_32x32x16_bf16 v[64:79], v[164:167], v[44:47], v[64:79]
    v_exp_f32 v56, v56
    v_exp_f32 v57, v57
    v_exp_f32 v58, v58
    v_exp_f32 v59, v59
    v_exp_f32 v60, v60
    v_mfma_f32_32x32x16_bf16 v[112:127], v[176:179], v[144:147], v[112:127]
    v_exp_f32 v61, v61
    v_exp_f32 v62, v62
    v_exp_f32 v63, v63
    v_cvt_pk_bf16_f32 v148, v56, v57
    v_cvt_pk_bf16_f32 v149, v58, v59
    v_cvt_pk_bf16_f32 v150, v60, v61
    v_cvt_pk_bf16_f32 v151, v62, v63
    s_waitcnt lgkmcnt(0)
    v_mfma_f32_32x32x16_bf16 v[48:63], v[152:155], v[16:19], 0
    v_exp_f32 v64, v64
    v_exp_f32 v65, v65
    v_exp_f32 v66, v66
    v_exp_f32 v67, v67
    v_exp_f32 v68, v68
    v_mfma_f32_32x32x16_bf16 v[112:127], v[180:183], v[148:151], v[112:127]
    v_exp_f32 v69, v69
    v_exp_f32 v70, v70
    v_exp_f32 v71, v71
    v_cvt_pk_bf16_f32 v144, v64, v65
    v_cvt_pk_bf16_f32 v145, v66, v67
    v_cvt_pk_bf16_f32 v146, v68, v69
    v_cvt_pk_bf16_f32 v147, v70, v71
    v_mfma_f32_32x32x16_bf16 v[48:63], v[160:163], v[32:35], v[48:63]
    v_exp_f32 v72, v72
    v_exp_f32 v73, v73
    v_exp_f32 v74, v74
    v_exp_f32 v75, v75
    v_exp_f32 v76, v76
    v_mfma_f32_32x32x16_bf16 v[128:143], v[176:179], v[144:147], v[128:143]
    v_exp_f32 v77, v77
    v_exp_f32 v78, v78
    v_exp_f32 v79, v79
    v_cvt_pk_bf16_f32 v148, v72, v73
    v_cvt_pk_bf16_f32 v149, v74, v75
    v_cvt_pk_bf16_f32 v150, v76, v77
    v_cvt_pk_bf16_f32 v151, v78, v79
    v_mfma_f32_32x32x16_bf16 v[64:79], v[152:155], v[20:23], 0
    v_exp_f32 v48, v48
    v_exp_f32 v49, v49
    v_exp_f32 v50, v50
    v_exp_f32 v51, v51
    v_exp_f32 v52, v52
    v_mfma_f32_32x32x16_bf16 v[128:143], v[180:183], v[148:151], v[128:143]
    v_exp_f32 v53, v53
    v_exp_f32 v54, v54
    v_exp_f32 v55, v55
    v_cvt_pk_bf16_f32 v144, v48, v49
    v_cvt_pk_bf16_f32 v145, v50, v51
    v_cvt_pk_bf16_f32 v146, v52, v53
    v_cvt_pk_bf16_f32 v147, v54, v55
    v_mfma_f32_32x32x16_bf16 v[64:79], v[160:163], v[36:39], v[64:79]
    v_exp_f32 v56, v56
    v_exp_f32 v57, v57
    v_exp_f32 v58, v58
    v_exp_f32 v59, v59
    v_exp_f32 v60, v60
    v_mfma_f32_32x32x16_bf16 v[80:95], v[168:171], v[144:147], v[80:95]
    v_exp_f32 v61, v61
    v_exp_f32 v62, v62
    v_exp_f32 v63, v63
    v_cvt_pk_bf16_f32 v148, v56, v57
    v_cvt_pk_bf16_f32 v149, v58, v59
    v_cvt_pk_bf16_f32 v150, v60, v61
    v_cvt_pk_bf16_f32 v151, v62, v63
    s_cbranch_execz L_dry_done
L_dry_3:
    v_mfma_f32_32x32x16_bf16 v[48:63], v[152:155], v[24:27], 0
    ds_read_b128 v[156:159], v6 offset:3072
    v_exp_f32 v64, v64
    ds_read_u16 v164, v7 offset:4608
    v_exp_f32 v65, v65
    v_exp_f32 v66, v66
    v_exp_f32 v67, v67
    v_exp_f32 v68, v68
    v_mfma_f32_32x32x16_bf16 v[80:95], v[172:175], v[148:151], v[80:95]
    v_exp_f32 v69, v69
    v_exp_f32 v70, v70
    v_exp_f32 v71, v71
    v_cvt_pk_bf16_f32 v144, v64, v65
    v_cvt_pk_bf16_f32 v145, v66, v67
    v_cvt_pk_bf16_f32 v146, v68, v69
    v_cvt_pk_bf16_f32 v147, v70, v71
    v_mfma_f32_32x32x16_bf16 v[48:63], v[160:163], v[40:43], v[48:63]
    v_exp_f32 v72, v72
    v_exp_f32 v73, v73
    v_exp_f32 v74, v74
    v_exp_f32 v75, v75
    v_exp_f32 v76, v76
    v_mfma_f32_32x32x16_bf16 v[96:111], v[168:171], v[144:147], v[96:111]
    v_exp_f32 v77, v77
    v_exp_f32 v78, v78
    v_exp_f32 v79, v79
    v_cvt_pk_bf16_f32 v148, v72, v73
    v_cvt_pk_bf16_f32 v149, v74, v75
    v_cvt_pk_bf16_f32 v150, v76, v77
    v_cvt_pk_bf16_f32 v151, v78, v79
    v_mfma_f32_32x32x16_bf16 v[64:79], v[152:155], v[28:31], 0
    ds_read_b128 v[176:179], v8 offset:4608
    v_exp_f32 v48, v48
    ds_read_b128 v[180:183], v8 offset:5376
    v_exp_f32 v49, v49
    v_exp_f32 v50, v50
    v_exp_f32 v51, v51
    v_exp_f32 v52, v52
    v_mfma_f32_32x32x16_bf16 v[96:111], v[172:175], v[148:151], v[96:111]
    v_exp_f32 v53, v53
    v_exp_f32 v54, v54
    v_exp_f32 v55, v55
    v_cvt_pk_bf16_f32 v144, v48, v49
    v_cvt_pk_bf16_f32 v145, v50, v51
    v_cvt_pk_bf16_f32 v146, v52, v53
    v_cvt_pk_bf16_f32 v147, v54, v55
    v_mfma_f32_32x32x16_bf16 v[64:79], v[160:163], v[44:47], v[64:79]
    v_exp_f32 v56, v56
    v_exp_f32 v57, v57
    v_exp_f32 v58, v58
    v_exp_f32 v59, v59
    v_exp_f32 v60, v60
    v_mfma_f32_32x32x16_bf16 v[112:127], v[168:171], v[144:147], v[112:127]
    v_exp_f32 v61, v61
    v_exp_f32 v62, v62
    v_exp_f32 v63, v63
    v_cvt_pk_bf16_f32 v148, v56, v57
    v_cvt_pk_bf16_f32 v149, v58, v59
    v_cvt_pk_bf16_f32 v150, v60, v61
    v_cvt_pk_bf16_f32 v151, v62, v63
    s_waitcnt lgkmcnt(0)
    v_mfma_f32_32x32x16_bf16 v[48:63], v[156:159], v[16:19], 0
    v_exp_f32 v64, v64
    v_exp_f32 v65, v65
    v_exp_f32 v66, v66
    v_exp_f32 v67, v67
    v_exp_f32 v68, v68
    v_mfma_f32_32x32x16_bf16 v[112:127], v[172:175], v[148:151], v[112:127]
    v_exp_f32 v69, v69
    v_exp_f32 v70, v70
    v_exp_f32 v71, v71
    v_cvt_pk_bf16_f32 v144, v64, v65
    v_cvt_pk_bf16_f32 v145, v66, v67
    v_cvt_pk_bf16_f32 v146, v68, v69
    v_cvt_pk_bf16_f32 v147, v70, v71
    v_mfma_f32_32x32x16_bf16 v[48:63], v[164:167], v[32:35], v[48:63]
    v_exp_f32 v72, v72
    v_exp_f32 v73, v73
    v_exp_f32 v74, v74
    v_exp_f32 v75, v75
    v_exp_f32 v76, v76
    v_mfma_f32_32x32x16_bf16 v[128:143], v[168:171], v[144:147], v[128:143]
    v_exp_f32 v77, v77
    v_exp_f32 v78, v78
    v_exp_f32 v79, v79
    v_cvt_pk_bf16_f32 v148, v72, v73
    v_cvt_pk_bf16_f32 v149, v74, v75
    v_cvt_pk_bf16_f32 v150, v76, v77
    v_cvt_pk_bf16_f32 v151, v78, v79
    v_mfma_f32_32x32x16_bf16 v[64:79], v[156:159], v[20:23], 0
    v_exp_f32 v48, v48
    v_exp_f32 v49, v49
    v_exp_f32 v50, v50
    v_exp_f32 v51, v51
    v_exp_f32 v52, v52
    v_mfma_f32_32x32x16_bf16 v[128:143], v[172:175], v[148:151], v[128:143]
    v_exp_f32 v53, v53
    v_exp_f32 v54, v54
    v_exp_f32 v55, v55
    v_cvt_pk_bf16_f32 v144, v48, v49
    v_cvt_pk_bf16_f32 v145, v50, v51
    v_cvt_pk_bf16_f32 v146, v52, v53
    v_cvt_pk_bf16_f32 v147, v54, v55
    v_mfma_f32_32x32x16_bf16 v[64:79], v[164:167], v[36:39], v[64:79]
    v_exp_f32 v56, v56
    v_exp_f32 v57, v57
    v_exp_f32 v58, v58
    v_exp_f32 v59, v59
    v_exp_f32 v60, v60
    v_mfma_f32_32x32x16_bf16 v[80:95], v[176:179], v[144:147], v[80:95]
    v_exp_f32 v61, v61
    v_exp_f32 v62, v62
    v_exp_f32 v63, v63
    v_cvt_pk_bf16_f32 v148, v56, v57
    v_cvt_pk_bf16_f32 v149, v58, v59
    v_cvt_pk_bf16_f32 v150, v60, v61
    v_cvt_pk_bf16_f32 v151, v62, v63
    s_cbranch_execz L_dry_done
    s_bitcmp1_b32 s93, s35
    s_cbranch_scc1 L_at_sig
L_at_sigback:
    s_cmp_le_u32 s33, s35
    s_cbranch_scc1 L_at_need
L_at_needback:
    v_add_u32 v6, s32, v3
    v_add_u32 v7, s32, v4
    v_add_u32 v8, s32, v5
    v_max3_f32 v188, v106, v122, v138
    v_max_f32 v188, v188, v90
    v_cmp_lt_f32 vcc, s42, v188
    s_cbranch_vccnz L_at_rescale
L_at_back:
L_dry_0:
    v_mfma_f32_32x32x16_bf16 v[48:63], v[156:159], v[24:27], 0
    ds_read_b128 v[152:155], v6 offset:0
    v_exp_f32 v64, v64
    ds_read_u16 v160, v7 offset:0
    v_exp_f32 v65, v65
    v_exp_f32 v66, v66
    v_exp_f32 v67, v67
    v_exp_f32 v68, v68
    v_mfma_f32_32x32x16_bf16 v[80:95], v[180:183], v[148:151], v[80:95]
    v_exp_f32 v69, v69
    v_exp_f32 v70, v70
    v_exp_f32 v71, v71
    v_cvt_pk_bf16_f32 v144, v64, v65
    v_cvt_pk_bf16_f32 v145, v66, v67
    v_cvt_pk_bf16_f32 v146, v68, v69
    v_cvt_pk_bf16_f32 v147, v70, v71
    v_mfma_f32_32x32x16_bf16 v[48:63], v[164:167], v[40:43], v[48:63]
    v_exp_f32 v72, v72
    v_exp_f32 v73, v73
    v_exp_f32 v74, v74
    v_exp_f32 v75, v75
    v_exp_f32 v76, v76
    v_mfma_f32_32x32x16_bf16 v[96:111], v[176:179], v[144:147], v[96:111]
    v_exp_f32 v77, v77
    v_exp_f32 v78, v78
    v_exp_f32 v79, v79
    v_cvt_pk_bf16_f32 v148, v72, v73
    v_cvt_pk_bf16_f32 v149, v74, v75
    v_cvt_pk_bf16_f32 v150, v76, v77
    v_cvt_pk_bf16_f32 v151, v78, v79
    v_mfma_f32_32x32x16_bf16 v[64:79], v[156:159], v[28:31], 0
    ds_read_b128 v[168:171], v8 offset:0
    v_exp_f32 v48, v48
    ds_read_b128 v[172:175], v8 offset:768
    v_exp_f32 v49, v49
    s_add_u32 s32, s32, 20480
    v_exp_f32 v50, v50
    v_exp_f32 v51, v51
    v_exp_f32 v52, v52
    v_mfma_f32_32x32x16_bf16 v[96:111], v[180:183], v[148:151], v[96:111]
    v_exp_f32 v53, v53
    v_exp_f32 v54, v54
    v_exp_f32 v55, v55
    v_cvt_pk_bf16_f32 v144, v48, v49
    v_cvt_pk_bf16_f32 v145, v50, v51
    v_cvt_pk_bf16_f32 v146, v52, v53
    v_cvt_pk_bf16_f32 v147, v54, v55
    v_mfma_f32_32x32x16_bf16 v[64:79], v[164:167], v[44:47], v[64:79]
    v_exp_f32 v56, v56
    v_exp_f32 v57, v57
    v_exp_f32 v58, v58
    v_exp_f32 v59, v59
    v_exp_f32 v60, v60
    v_mfma_f32_32x32x16_bf16 v[112:127], v[176:179], v[144:147], v[112:127]
    v_exp_f32 v61, v61
    v_exp_f32 v62, v62
    v_exp_f32 v63, v63
    v_cvt_pk_bf16_f32 v148, v56, v57
    v_cvt_pk_bf16_f32 v149, v58, v59
    v_cvt_pk_bf16_f32 v150, v60, v61
    v_cvt_pk_bf16_f32 v151, v62, v63
    s_waitcnt lgkmcnt(0)
    v_mfma_f32_32x32x16_bf16 v[48:63], v[152:155], v[16:19], 0
    v_exp_f32 v64, v64
    v_exp_f32 v65, v65
    v_exp_f32 v66, v66
    v_exp_f32 v67, v67
    v_exp_f32 v68, v68
    v_mfma_f32_32x32x16_bf16 v[112:127], v[180:183], v[148:151], v[112:127]
    v_exp_f32 v69, v69
    v_exp_f32 v70, v70
    v_exp_f32 v71, v71
    v_cvt_pk_bf16_f32 v144, v64, v65
    v_cvt_pk_bf16_f32 v145, v66, v67
    v_cvt_pk_bf16_f32 v146, v68, v69
    v_cvt_pk_bf16_f32 v147, v70, v71
    v_mfma_f32_32x32x16_bf16 v[48:63], v[160:163], v[32:35], v[48:63]
    v_exp_f32 v72, v72
    v_exp_f32 v73, v73
    v_exp_f32 v74, v74
    v_exp_f32 v75, v75
    v_exp_f32 v76, v76
    v_mfma_f32_32x32x16_bf16 v[128:143], v[176:179], v[144:147], v[128:143]
    v_exp_f32 v77, v77
    v_exp_f32 v78, v78
    v_exp_f32 v79, v79
    v_cvt_pk_bf16_f32 v148, v72, v73
    v_cvt_pk_bf16_f32 v149, v74, v75
    v_cvt_pk_bf16_f32 v150, v76, v77
    v_cvt_pk_bf16_f32 v151, v78, v79
    s_add_u32 s35, s35, 1
    s_cmp_lt_u32 s35, 8
    s_cbranch_scc1 L_at_loop
L_at_tail:
    v_mfma_f32_32x32x16_bf16 v[128:143], v[180:183], v[148:151], v[128:143]
    v_mov_b32 v91, v184
    v_mov_b32 v107, v185
    v_mov_b32 v123, v186
    v_mov_b32 v188, 0
    v_mov_b32 v189, 0
    v_pk_fma_f32 v[188:189], v[80:81], 0, v[188:189]
    v_pk_fma_f32 v[188:189], v[82:83], 0, v[188:189]
    v_pk_fma_f32 v[188:189], v[84:85], 0, v[188:189]
    v_pk_fma_f32 v[188:189], v[86:87], 0, v[188:189]
    v_pk_fma_f32 v[188:189], v[88:89], 0, v[188:189]
    v_pk_fma_f32 v[188:189], v[90:91], 0, v[188:189]
    v_pk_fma_f32 v[188:189], v[96:97], 0, v[188:189]
    v_pk_fma_f32 v[188:189], v[98:99], 0, v[188:189]
    v_pk_fma_f32 v[188:189], v[100:101], 0, v[188:189]
    v_pk_fma_f32 v[188:189], v[102:103], 0, v[188:189]
    v_pk_fma_f32 v[188:189], v[104:105], 0, v[188:189]
    v_pk_fma_f32 v[188:189], v[106:107], 0, v[188:189]
    v_pk_fma_f32 v[188:189], v[112:113], 0, v[188:189]
    v_pk_fma_f32 v[188:189], v[114:115], 0, v[188:189]
    v_pk_fma_f32 v[188:189], v[116:117], 0, v[188:189]
    v_pk_fma_f32 v[188:189], v[118:119], 0, v[188:189]
    v_pk_fma_f32 v[188:189], v[120:121], 0, v[188:189]
    v_pk_fma_f32 v[188:189], v[122:123], 0, v[188:189]
    v_mov_b32 v139, v187
    v_pk_fma_f32 v[188:189], v[128:129], 0, v[188:189]
    v_pk_fma_f32 v[188:189], v[130:131], 0, v[188:189]
    v_pk_fma_f32 v[188:189], v[132:133], 0, v[188:189]
    v_pk_fma_f32 v[188:189], v[134:135], 0, v[188:189]
    v_pk_fma_f32 v[188:189], v[136:137], 0, v[188:189]
    v_pk_fma_f32 v[188:189], v[138:139], 0, v[188:189]
    v_min3_f32 v190, v90, v106, v122
    v_max3_f32 v191, v90, v106, v122
    v_min_f32 v190, v190, v138
    v_max_f32 v191, v191, v138
    v_cmp_u_f32 vcc, v188, v189
    v_cmp_gt_f32 s[48:49], s52, v190
    v_cmp_lt_f32 s[50:51], s53, v191
    s_nop 3
    s_or_b64 s[48:49], vcc, s[48:49]
    s_or_b64 s[50:51], s[48:49], s[50:51]
    s_cbranch_scc1 L_at_odd
L_at_combine:
    s_mov_b32 s100, 1600000
    v_mov_b32 v194, 162816
L_parall_lw_17:
    ds_read_b128 v[190:193], v194
    s_waitcnt lgkmcnt(0)
    v_min3_u32 v190, v190, v191, v192
    v_min_u32 v190, v190, v193
    s_nop 0
    v_readfirstlane_b32 s101, v190
    s_cmp_ge_u32 s101, 5
    s_cbranch_scc1 L_parall_lw_17_ok
    s_sub_u32 s100, s100, 1
    s_cbranch_scc0 L_parall_lw_17
L_parall_lw_17_ok:
    ds_write_b128 v201, v[80:83] offset:0
    ds_write_b128 v201, v[84:87] offset:1024
    ds_write_b128 v201, v[88:91] offset:2048
    ds_write_b128 v201, v[96:99] offset:3072
    ds_write_b128 v201, v[100:103] offset:4096
    ds_write_b128 v201, v[104:107] offset:5120
    v_mov_b32 v190, 6
    ds_write_b32 v198, v190
    s_mov_b32 s100, 1600000
L_at_exw:
    ds_read_b32 v7, v203
    s_waitcnt lgkmcnt(0)
    v_readfirstlane_b32 s3, v7
    s_cmp_eq_u32 s3, 6
    s_cbranch_scc1 L_at_exok
    s_sub_u32 s100, s100, 1
    s_cbranch_scc0 L_at_exw
L_at_exok:
    ds_read_b128 v[80:83], v202 offset:0
    ds_read_b128 v[84:87], v202 offset:1024
    ds_read_b128 v[88:91], v202 offset:2048
    ds_read_b128 v[96:99], v202 offset:3072
    ds_read_b128 v[100:103], v202 offset:4096
    ds_read_b128 v[104:107], v202 offset:5120
    s_waitcnt vmcnt(0)
    buffer_store_dword v14, v13, s[20:23], s43 offen offset:0 sc0 sc1
    buffer_store_dword v14, v13, s[20:23], s43 offen offset:128 sc0 sc1
    s_waitcnt lgkmcnt(3)
    v_frexp_exp_i32_f32 v190, v122
    v_frexp_exp_i32_f32 v192, v90
    v_cvt_f32_i32 v190, v190
    v_cvt_f32_i32 v192, v192
    v_add_f32 v190, v190, v123
    v_add_f32 v192, v192, v91
    v_max_f32 v188, v190, v192
    v_sub_f32 v190, v123, v188
    v_sub_f32 v192, v91, v188
    v_exp_f32 v190, v190
    v_exp_f32 v192, v192
    s_nop 0
    v_mul_f32 v194, v122, v190
    v_fmac_f32 v194, v90, v192
    v_rcp_f32 v194, v194
    s_nop 0
    v_mul_f32 v190, v190, v194
    v_mul_f32 v192, v192, v194
    v_mov_b32 v191, v190
    v_mov_b32 v193, v192
    v_pk_mul_f32 v[112:113], v[112:113], v[190:191]
    v_pk_mul_f32 v[114:115], v[114:115], v[190:191]
    v_pk_mul_f32 v[116:117], v[116:117], v[190:191]
    v_pk_mul_f32 v[118:119], v[118:119], v[190:191]
    v_pk_mul_f32 v[120:121], v[120:121], v[190:191]
    v_pk_fma_f32 v[112:113], v[80:81], v[192:193], v[112:113]
    v_pk_fma_f32 v[114:115], v[82:83], v[192:193], v[114:115]
    v_pk_fma_f32 v[116:117], v[84:85], v[192:193], v[116:117]
    v_pk_fma_f32 v[118:119], v[86:87], v[192:193], v[118:119]
    v_pk_fma_f32 v[120:121], v[88:89], v[192:193], v[120:121]
    v_cvt_pk_bf16_f32 v112, v112, v113
    v_cvt_pk_bf16_f32 v113, v114, v115
    v_cvt_pk_bf16_f32 v114, v116, v117
    v_cvt_pk_bf16_f32 v115, v118, v119
    v_cvt_pk_bf16_f32 v116, v120, v121
    buffer_store_dwordx4 v[112:115], v199, s[20:23], s54 offen sc1
    buffer_store_dword v116, v200, s[20:23], s56 offen sc1
    s_waitcnt lgkmcnt(0)
    v_frexp_exp_i32_f32 v190, v138
    v_frexp_exp_i32_f32 v192, v106
    v_cvt_f32_i32 v190, v190
    v_cvt_f32_i32 v192, v192
    v_add_f32 v190, v190, v139
    v_add_f32 v192, v192, v107
    v_max_f32 v188, v190, v192
    v_sub_f32 v190, v139, v188
    v_sub_f32 v192, v107, v188
    v_exp_f32 v190, v190
    v_exp_f32 v192, v192
    s_nop 0
    v_mul_f32 v194, v138, v190
    v_fmac_f32 v194, v106, v192
    v_rcp_f32 v194, v194
    s_nop 0
    v_mul_f32 v190, v190, v194
    v_mul_f32 v192, v192, v194
    v_mov_b32 v191, v190
    v_mov_b32 v193, v192
    v_pk_mul_f32 v[128:129], v[128:129], v[190:191]
    v_pk_mul_f32 v[130:131], v[130:131], v[190:191]
    v_pk_mul_f32 v[132:133], v[132:133], v[190:191]
    v_pk_mul_f32 v[134:135], v[134:135], v[190:191]
    v_pk_mul_f32 v[136:137], v[136:137], v[190:191]
    v_pk_fma_f32 v[128:129], v[96:97], v[192:193], v[128:129]
    v_pk_fma_f32 v[130:131], v[98:99], v[192:193], v[130:131]
    v_pk_fma_f32 v[132:133], v[100:101], v[192:193], v[132:133]
    v_pk_fma_f32 v[134:135], v[102:103], v[192:193], v[134:135]
    v_pk_fma_f32 v[136:137], v[104:105], v[192:193], v[136:137]
    v_cvt_pk_bf16_f32 v128, v128, v129
    v_cvt_pk_bf16_f32 v129, v130, v131
    v_cvt_pk_bf16_f32 v130, v132, v133
    v_cvt_pk_bf16_f32 v131, v134, v135
    v_cvt_pk_bf16_f32 v132, v136, v137
    buffer_store_dwordx4 v[128:131], v199, s[20:23], s55 offen sc1
    buffer_store_dword v132, v200, s[20:23], s57 offen sc1
    s_endpgm
L_at_sig:
    s_cmp_eq_u32 s35, 7
    s_cbranch_scc1 L_at_needback
    s_cmp_eq_u32 s35, 5
    s_cbranch_scc1 L_at_s5
    s_cmp_eq_u32 s35, 6
    s_cbranch_scc1 L_at_s6
    v_mov_b32 v190, 3
    ds_write_b32 v198, v190
    s_waitcnt vmcnt(0)
    buffer_store_dword v14, v13, s[20:23], s39 offen offset:4 sc0 sc1
    s_branch L_at_sigback
L_at_s5:
    v_mov_b32 v190, 4
    ds_write_b32 v198, v190
    v_bfe_u32 v9, v0, 4, 1
    v_mul_u32_u24 v199, 18432, v9
    v_and_b32 v9, 15, v0
    v_lshl_add_u32 v199, v9, 4, v199
    v_cndmask_b32 v200, v15, v199, s[40:41]
    v_lshrrev_b32 v9, 5, v0
    v_lshl_add_u32 v199, v9, 8, v199
    s_lshl_b32 s43, s26, 3
    s_lshl_b32 s3, s27, 2
    s_add_u32 s43, s43, s3
    s_lshl_b32 s3, s28, 1
    s_add_u32 s43, s43, s3
    s_mul_i32 s54, s43, 36864
    s_add_u32 s54, s54, 28573696
    s_lshr_b32 s3, s25, 2
    s_lshl_b32 s3, s3, 8
    s_and_b32 s56, s25, 3
    s_lshl_b32 s56, s56, 2
    s_add_u32 s56, s56, s3
    s_add_u32 s56, s56, 16384
    s_add_u32 s56, s56, s54
    s_lshl_b32 s3, s25, 9
    s_add_u32 s54, s54, s3
    s_add_u32 s55, s54, 36864
    s_add_u32 s57, s56, 36864
    s_lshl_b32 s43, s43, 7
    s_lshl_b32 s3, s25, 2
    s_add_u32 s43, s43, s3
    s_add_u32 s43, s43, 49311744
    s_mul_i32 s30, s31, 6144
    s_add_u32 s30, s30, 20480
    s_cmp_eq_u32 s31, 3
    s_cselect_b32 s30, 151552, s30
    s_xor_b32 s3, s31, 2
    s_mul_i32 s29, s3, 6144
    s_add_u32 s29, s29, 20480
    s_cmp_eq_u32 s3, 3
    s_cselect_b32 s29, 151552, s29
    v_add_u32 v201, s30, v1
    v_add_u32 v202, s29, v1
    v_xor_b32 v203, 8, v198
    s_mov_b32 s52, 0x0d800000
    s_mov_b32 s53, 0x6c800000
    v_mov_b32 v192, -1
    v_mov_b32 v193, -1
    v_mov_b32 v194, -1
    v_mov_b32 v195, -1
    buffer_store_dwordx4 v[192:195], v199, s[20:23], s54 offen sc1
    buffer_store_dword v192, v200, s[20:23], s56 offen sc1
    buffer_store_dwordx4 v[192:195], v199, s[20:23], s55 offen sc1
    buffer_store_dword v192, v200, s[20:23], s57 offen sc1
    s_nop 1
    s_mov_b32 s32, 20480
    s_branch L_at_sigback
L_at_s6:
    v_mov_b32 v190, 5
    ds_write_b32 v198, v190
    s_mov_b32 s32, 0
    s_branch L_at_sigback
L_at_need:
    s_add_u32 s34, s35, 1
    s_max_u32 s34, s34, 2
    s_mov_b32 s100, 1600000
    v_mov_b32 v194, 162832
L_parall_lw_18:
    ds_read_b128 v[190:193], v194
    s_waitcnt lgkmcnt(0)
    v_min3_u32 v190, v190, v191, v192
    v_min_u32 v190, v190, v193
    s_nop 0
    v_readfirstlane_b32 s101, v190
    s_cmp_ge_u32 s101, s34
    s_cbranch_scc1 L_parall_lw_18_ok
    s_sub_u32 s100, s100, 1
    s_cbranch_scc0 L_parall_lw_18
L_parall_lw_18_ok:
    s_mov_b32 s33, s101
    s_branch L_at_needback
L_at_rescale:
    v_mfma_f32_32x32x16_bf16 v[80:95], v[180:183], v[148:151], v[80:95]
    s_nop 15
    v_mov_b32 v148, 0
    v_mov_b32 v149, 0
    v_mov_b32 v150, 0
    v_mov_b32 v151, 0
    v_frexp_exp_i32_f32 v188, v90
    v_add_u32 v188, 96, v188
    v_max_i32 v188, 0, v188
    v_cvt_f32_i32 v188, v188
    v_add_f32 v188, v188, v184
    v_mov_b32 v190, v184
    v_cvt_pk_bf16_f32 v189, v188, v188
    v_and_b32 v184, 0xffff0000, v189
    v_lshrrev_b32 v189, 16, v189
    v_xor_b32 v189, 0x8000, v189
    v_cndmask_b32 v33, 0, v189, s[40:41]
    v_sub_f32 v190, v190, v184
    v_cvt_i32_f32 v191, v190
    v_ldexp_f32 v80, v80, v191
    v_ldexp_f32 v81, v81, v191
    v_ldexp_f32 v82, v82, v191
    v_ldexp_f32 v83, v83, v191
    v_ldexp_f32 v84, v84, v191
    v_ldexp_f32 v85, v85, v191
    v_ldexp_f32 v86, v86, v191
    v_ldexp_f32 v87, v87, v191
    v_ldexp_f32 v88, v88, v191
    v_ldexp_f32 v89, v89, v191
    v_ldexp_f32 v90, v90, v191
    v_frexp_exp_i32_f32 v188, v106
    v_add_u32 v188, 96, v188
    v_max_i32 v188, 0, v188
    v_cvt_f32_i32 v188, v188
    v_add_f32 v188, v188, v185
    v_mov_b32 v190, v185
    v_cvt_pk_bf16_f32 v189, v188, v188
    v_and_b32 v185, 0xffff0000, v189
    v_lshrrev_b32 v189, 16, v189
    v_xor_b32 v189, 0x8000, v189
    v_cndmask_b32 v37, 0, v189, s[40:41]
    v_sub_f32 v190, v190, v185
    v_cvt_i32_f32 v191, v190
    v_ldexp_f32 v96, v96, v191
    v_ldexp_f32 v97, v97, v191
    v_ldexp_f32 v98, v98, v191
    v_ldexp_f32 v99, v99, v191
    v_ldexp_f32 v100, v100, v191
    v_ldexp_f32 v101, v101, v191
    v_ldexp_f32 v102, v102, v191
    v_ldexp_f32 v103, v103, v191
    v_ldexp_f32 v104, v104, v191
    v_ldexp_f32 v105, v105, v191
    v_ldexp_f32 v106, v106, v191
    v_add_f32 v64, v64, v190
    v_add_f32 v65, v65, v190
    v_add_f32 v66, v66, v190
    v_add_f32 v67, v67, v190
    v_add_f32 v68, v68, v190
    v_add_f32 v69, v69, v190
    v_add_f32 v70, v70, v190
    v_add_f32 v71, v71, v190
    v_add_f32 v72, v72, v190
    v_add_f32 v73, v73, v190
    v_add_f32 v74, v74, v190
    v_add_f32 v75, v75, v190
    v_add_f32 v76, v76, v190
    v_add_f32 v77, v77, v190
    v_add_f32 v78, v78, v190
    v_add_f32 v79, v79, v190
    v_frexp_exp_i32_f32 v188, v122
    v_add_u32 v188, 96, v188
    v_max_i32 v188, 0, v188
    v_cvt_f32_i32 v188, v188
    v_add_f32 v188, v188, v186
    v_mov_b32 v190, v186
    v_cvt_pk_bf16_f32 v189, v188, v188
    v_and_b32 v186, 0xffff0000, v189
    v_lshrrev_b32 v189, 16, v189
    v_xor_b32 v189, 0x8000, v189
    v_cndmask_b32 v41, 0, v189, s[40:41]
    v_sub_f32 v190, v190, v186
    v_cvt_i32_f32 v191, v190
    v_ldexp_f32 v112, v112, v191
    v_ldexp_f32 v113, v113, v191
    v_ldexp_f32 v114, v114, v191
    v_ldexp_f32 v115, v115, v191
    v_ldexp_f32 v116, v116, v191
    v_ldexp_f32 v117, v117, v191
    v_ldexp_f32 v118, v118, v191
    v_ldexp_f32 v119, v119, v191
    v_ldexp_f32 v120, v120, v191
    v_ldexp_f32 v121, v121, v191
    v_ldexp_f32 v122, v122, v191
    v_frexp_exp_i32_f32 v188, v138
    v_add_u32 v188, 96, v188
    v_max_i32 v188, 0, v188
    v_cvt_f32_i32 v188, v188
    v_add_f32 v188, v188, v187
    v_mov_b32 v190, v187
    v_cvt_pk_bf16_f32 v189, v188, v188
    v_and_b32 v187, 0xffff0000, v189
    v_lshrrev_b32 v189, 16, v189
    v_xor_b32 v189, 0x8000, v189
    v_cndmask_b32 v45, 0, v189, s[40:41]
    v_sub_f32 v190, v190, v187
    v_cvt_i32_f32 v191, v190
    v_ldexp_f32 v128, v128, v191
    v_ldexp_f32 v129, v129, v191
    v_ldexp_f32 v130, v130, v191
    v_ldexp_f32 v131, v131, v191
    v_ldexp_f32 v132, v132, v191
    v_ldexp_f32 v133, v133, v191
    v_ldexp_f32 v134, v134, v191
    v_ldexp_f32 v135, v135, v191
    v_ldexp_f32 v136, v136, v191
    v_ldexp_f32 v137, v137, v191
    v_ldexp_f32 v138, v138, v191
    s_nop 3
    s_branch L_at_back
L_at_odd:
    s_cmp_lg_u64 s[48:49], 0
    s_cbranch_scc1 L_at_fallback
    v_frexp_exp_i32_f32 v188, v90
    v_cvt_f32_i32 v189, v188
    v_sub_u32 v188, 0, v188
    v_add_f32 v91, v91, v189
    v_ldexp_f32 v80, v80, v188
    v_ldexp_f32 v81, v81, v188
    v_ldexp_f32 v82, v82, v188
    v_ldexp_f32 v83, v83, v188
    v_ldexp_f32 v84, v84, v188
    v_ldexp_f32 v85, v85, v188
    v_ldexp_f32 v86, v86, v188
    v_ldexp_f32 v87, v87, v188
    v_ldexp_f32 v88, v88, v188
    v_ldexp_f32 v89, v89, v188
    v_ldexp_f32 v90, v90, v188
    v_frexp_exp_i32_f32 v188, v106
    v_cvt_f32_i32 v189, v188
    v_sub_u32 v188, 0, v188
    v_add_f32 v107, v107, v189
    v_ldexp_f32 v96, v96, v188
    v_ldexp_f32 v97, v97, v188
    v_ldexp_f32 v98, v98, v188
    v_ldexp_f32 v99, v99, v188
    v_ldexp_f32 v100, v100, v188
    v_ldexp_f32 v101, v101, v188
    v_ldexp_f32 v102, v102, v188
    v_ldexp_f32 v103, v103, v188
    v_ldexp_f32 v104, v104, v188
    v_ldexp_f32 v105, v105, v188
    v_ldexp_f32 v106, v106, v188
    v_frexp_exp_i32_f32 v188, v122
    v_cvt_f32_i32 v189, v188
    v_sub_u32 v188, 0, v188
    v_add_f32 v123, v123, v189
    v_ldexp_f32 v112, v112, v188
    v_ldexp_f32 v113, v113, v188
    v_ldexp_f32 v114, v114, v188
    v_ldexp_f32 v115, v115, v188
    v_ldexp_f32 v116, v116, v188
    v_ldexp_f32 v117, v117, v188
    v_ldexp_f32 v118, v118, v188
    v_ldexp_f32 v119, v119, v188
    v_ldexp_f32 v120, v120, v188
    v_ldexp_f32 v121, v121, v188
    v_ldexp_f32 v122, v122, v188
    v_frexp_exp_i32_f32 v188, v138
    v_cvt_f32_i32 v189, v188
    v_sub_u32 v188, 0, v188
    v_add_f32 v139, v139, v189
    v_ldexp_f32 v128, v128, v188
    v_ldexp_f32 v129, v129, v188
    v_ldexp_f32 v130, v130, v188
    v_ldexp_f32 v131, v131, v188
    v_ldexp_f32 v132, v132, v188
    v_ldexp_f32 v133, v133, v188
    v_ldexp_f32 v134, v134, v188
    v_ldexp_f32 v135, v135, v188
    v_ldexp_f32 v136, v136, v188
    v_ldexp_f32 v137, v137, v188
    v_ldexp_f32 v138, v138, v188
    s_branch L_at_combine
L_at_fallback:
    s_mul_i32 s29, s25, 163840
    s_add_u32 s29, s29, 4456448
    s_mov_b32 s35, 0
    s_mov_b32 s47, 0
    v_mov_b32 v33, 0
    v_mov_b32 v184, 0xff61b1e6
    v_mov_b32 v80, 0
    v_mov_b32 v81, 0
    v_mov_b32 v82, 0
    v_mov_b32 v83, 0
    v_mov_b32 v84, 0
    v_mov_b32 v85, 0
    v_mov_b32 v86, 0
    v_mov_b32 v87, 0
    v_mov_b32 v88, 0
    v_mov_b32 v89, 0
    v_mov_b32 v90, 0
    v_mov_b32 v91, 0
    v_mov_b32 v92, 0
    v_mov_b32 v93, 0
    v_mov_b32 v94, 0
    v_mov_b32 v95, 0
    v_mov_b32 v37, 0
    v_mov_b32 v185, 0xff61b1e6
    v_mov_b32 v96, 0
    v_mov_b32 v97, 0
    v_mov_b32 v98, 0
    v_mov_b32 v99, 0
    v_mov_b32 v100, 0
    v_mov_b32 v101, 0
    v_mov_b32 v102, 0
    v_mov_b32 v103, 0
    v_mov_b32 v104, 0
    v_mov_b32 v105, 0
    v_mov_b32 v106, 0
    v_mov_b32 v107, 0
    v_mov_b32 v108, 0
    v_mov_b32 v109, 0
    v_mov_b32 v110, 0
    v_mov_b32 v111, 0
    v_mov_b32 v41, 0
    v_mov_b32 v186, 0xff61b1e6
    v_mov_b32 v112, 0
    v_mov_b32 v113, 0
    v_mov_b32 v114, 0
    v_mov_b32 v115, 0
    v_mov_b32 v116, 0
    v_mov_b32 v117, 0
    v_mov_b32 v118, 0
    v_mov_b32 v119, 0
    v_mov_b32 v120, 0
    v_mov_b32 v121, 0
    v_mov_b32 v122, 0
    v_mov_b32 v123, 0
    v_mov_b32 v124, 0
    v_mov_b32 v125, 0
    v_mov_b32 v126, 0
    v_mov_b32 v127, 0
    v_mov_b32 v45, 0
    v_mov_b32 v187, 0xff61b1e6
    v_mov_b32 v128, 0
    v_mov_b32 v129, 0
    v_mov_b32 v130, 0
    v_mov_b32 v131, 0
    v_mov_b32 v132, 0
    v_mov_b32 v133, 0
    v_mov_b32 v134, 0
    v_mov_b32 v135, 0
    v_mov_b32 v136, 0
    v_mov_b32 v137, 0
    v_mov_b32 v138, 0
    v_mov_b32 v139, 0
    v_mov_b32 v140, 0
    v_mov_b32 v141, 0
    v_mov_b32 v142, 0
    v_mov_b32 v143, 0
L_at_fb_loop:
    s_lshl_b32 s3, s47, 10
    s_add_u32 s48, s29, s3
    s_mul_i32 s3, s47, 1536
    s_add_u32 s49, s29, s3
    buffer_load_dwordx4 v[152:155], v3, s[20:23], s48 offen sc1
    buffer_load_ushort v160, v4, s[20:23], s49 offen sc1
    buffer_load_dwordx4 v[168:171], v5, s[20:23], s49 offen sc1
    buffer_load_dwordx4 v[172:175], v5, s[20:23], s49 offen offset:768 sc1
    s_waitcnt vmcnt(0)
    v_mfma_f32_32x32x16_bf16 v[48:63], v[152:155], v[16:19], 0
    v_mfma_f32_32x32x16_bf16 v[48:63], v[160:163], v[32:35], v[48:63]
    s_nop 15
    v_max3_f32 v188, v48, v49, v50
    v_max3_f32 v188, v188, v51, v52
    v_max3_f32 v188, v188, v53, v54
    v_max3_f32 v188, v188, v55, v56
    v_max3_f32 v188, v188, v57, v58
    v_max3_f32 v188, v188, v59, v60
    v_max3_f32 v188, v188, v61, v62
    v_max_f32 v188, v188, v63
    v_mov_b32 v189, v188
    s_nop 1
    v_permlane32_swap_b32 v188, v189
    s_nop 1
    v_max_f32 v188, v188, v189
    v_max_f32 v188, v188, v184
    v_sub_f32 v189, v184, v188
    v_exp_f32 v189, v189
    v_mov_b32 v184, v188
    v_sub_f32 v48, v48, v188
    v_sub_f32 v49, v49, v188
    v_sub_f32 v50, v50, v188
    v_sub_f32 v51, v51, v188
    v_sub_f32 v52, v52, v188
    v_sub_f32 v53, v53, v188
    v_sub_f32 v54, v54, v188
    v_sub_f32 v55, v55, v188
    v_sub_f32 v56, v56, v188
    v_sub_f32 v57, v57, v188
    v_sub_f32 v58, v58, v188
    v_sub_f32 v59, v59, v188
    v_sub_f32 v60, v60, v188
    v_sub_f32 v61, v61, v188
    v_sub_f32 v62, v62, v188
    v_sub_f32 v63, v63, v188
    v_exp_f32 v48, v48
    v_exp_f32 v49, v49
    v_exp_f32 v50, v50
    v_exp_f32 v51, v51
    v_exp_f32 v52, v52
    v_exp_f32 v53, v53
    v_exp_f32 v54, v54
    v_exp_f32 v55, v55
    v_exp_f32 v56, v56
    v_exp_f32 v57, v57
    v_exp_f32 v58, v58
    v_exp_f32 v59, v59
    v_exp_f32 v60, v60
    v_exp_f32 v61, v61
    v_exp_f32 v62, v62
    v_exp_f32 v63, v63
    v_mul_f32 v80, v80, v189
    v_mul_f32 v81, v81, v189
    v_mul_f32 v82, v82, v189
    v_mul_f32 v83, v83, v189
    v_mul_f32 v84, v84, v189
    v_mul_f32 v85, v85, v189
    v_mul_f32 v86, v86, v189
    v_mul_f32 v87, v87, v189
    v_mul_f32 v88, v88, v189
    v_mul_f32 v89, v89, v189
    v_mul_f32 v90, v90, v189
    v_cvt_pk_bf16_f32 v144, v48, v49
    v_cvt_pk_bf16_f32 v145, v50, v51
    v_cvt_pk_bf16_f32 v146, v52, v53
    v_cvt_pk_bf16_f32 v147, v54, v55
    v_cvt_pk_bf16_f32 v148, v56, v57
    v_cvt_pk_bf16_f32 v149, v58, v59
    v_cvt_pk_bf16_f32 v150, v60, v61
    v_cvt_pk_bf16_f32 v151, v62, v63
    s_nop 1
    v_mfma_f32_32x32x16_bf16 v[80:95], v[168:171], v[144:147], v[80:95]
    v_mfma_f32_32x32x16_bf16 v[80:95], v[172:175], v[148:151], v[80:95]
    s_nop 7
    v_mfma_f32_32x32x16_bf16 v[48:63], v[152:155], v[20:23], 0
    v_mfma_f32_32x32x16_bf16 v[48:63], v[160:163], v[36:39], v[48:63]
    s_nop 15
    v_max3_f32 v188, v48, v49, v50
    v_max3_f32 v188, v188, v51, v52
    v_max3_f32 v188, v188, v53, v54
    v_max3_f32 v188, v188, v55, v56
    v_max3_f32 v188, v188, v57, v58
    v_max3_f32 v188, v188, v59, v60
    v_max3_f32 v188, v188, v61, v62
    v_max_f32 v188, v188, v63
    v_mov_b32 v189, v188
    s_nop 1
    v_permlane32_swap_b32 v188, v189
    s_nop 1
    v_max_f32 v188, v188, v189
    v_max_f32 v188, v188, v185
    v_sub_f32 v189, v185, v188
    v_exp_f32 v189, v189
    v_mov_b32 v185, v188
    v_sub_f32 v48, v48, v188
    v_sub_f32 v49, v49, v188
    v_sub_f32 v50, v50, v188
    v_sub_f32 v51, v51, v188
    v_sub_f32 v52, v52, v188
    v_sub_f32 v53, v53, v188
    v_sub_f32 v54, v54, v188
    v_sub_f32 v55, v55, v188
    v_sub_f32 v56, v56, v188
    v_sub_f32 v57, v57, v188
    v_sub_f32 v58, v58, v188
    v_sub_f32 v59, v59, v188
    v_sub_f32 v60, v60, v188
    v_sub_f32 v61, v61, v188
    v_sub_f32 v62, v62, v188
    v_sub_f32 v63, v63, v188
    v_exp_f32 v48, v48
    v_exp_f32 v49, v49
    v_exp_f32 v50, v50
    v_exp_f32 v51, v51
    v_exp_f32 v52, v52
    v_exp_f32 v53, v53
    v_exp_f32 v54, v54
    v_exp_f32 v55, v55
    v_exp_f32 v56, v56
    v_exp_f32 v57, v57
    v_exp_f32 v58, v58
    v_exp_f32 v59, v59
    v_exp_f32 v60, v60
    v_exp_f32 v61, v61
    v_exp_f32 v62, v62
    v_exp_f32 v63, v63
    v_mul_f32 v96, v96, v189
    v_mul_f32 v97, v97, v189
    v_mul_f32 v98, v98, v189
    v_mul_f32 v99, v99, v189
    v_mul_f32 v100, v100, v189
    v_mul_f32 v101, v101, v189
    v_mul_f32 v102, v102, v189
    v_mul_f32 v103, v103, v189
    v_mul_f32 v104, v104, v189
    v_mul_f32 v105, v105, v189
    v_mul_f32 v106, v106, v189
    v_cvt_pk_bf16_f32 v144, v48, v49
    v_cvt_pk_bf16_f32 v145, v50, v51
    v_cvt_pk_bf16_f32 v146, v52, v53
    v_cvt_pk_bf16_f32 v147, v54, v55
    v_cvt_pk_bf16_f32 v148, v56, v57
    v_cvt_pk_bf16_f32 v149, v58, v59
    v_cvt_pk_bf16_f32 v150, v60, v61
    v_cvt_pk_bf16_f32 v151, v62, v63
    s_nop 1
    v_mfma_f32_32x32x16_bf16 v[96:111], v[168:171], v[144:147], v[96:111]
    v_mfma_f32_32x32x16_bf16 v[96:111], v[172:175], v[148:151], v[96:111]
    s_nop 7
    v_mfma_f32_32x32x16_bf16 v[48:63], v[152:155], v[24:27], 0
    v_mfma_f32_32x32x16_bf16 v[48:63], v[160:163], v[40:43], v[48:63]
    s_nop 15
    v_max3_f32 v188, v48, v49, v50
    v_max3_f32 v188, v188, v51, v52
    v_max3_f32 v188, v188, v53, v54
    v_max3_f32 v188, v188, v55, v56
    v_max3_f32 v188, v188, v57, v58
    v_max3_f32 v188, v188, v59, v60
    v_max3_f32 v188, v188, v61, v62
    v_max_f32 v188, v188, v63
    v_mov_b32 v189, v188
    s_nop 1
    v_permlane32_swap_b32 v188, v189
    s_nop 1
    v_max_f32 v188, v188, v189
    v_max_f32 v188, v188, v186
    v_sub_f32 v189, v186, v188
    v_exp_f32 v189, v189
    v_mov_b32 v186, v188
    v_sub_f32 v48, v48, v188
    v_sub_f32 v49, v49, v188
    v_sub_f32 v50, v50, v188
    v_sub_f32 v51, v51, v188
    v_sub_f32 v52, v52, v188
    v_sub_f32 v53, v53, v188
    v_sub_f32 v54, v54, v188
    v_sub_f32 v55, v55, v188
    v_sub_f32 v56, v56, v188
    v_sub_f32 v57, v57, v188
    v_sub_f32 v58, v58, v188
    v_sub_f32 v59, v59, v188
    v_sub_f32 v60, v60, v188
    v_sub_f32 v61, v61, v188
    v_sub_f32 v62, v62, v188
    v_sub_f32 v63, v63, v188
    v_exp_f32 v48, v48
    v_exp_f32 v49, v49
    v_exp_f32 v50, v50
    v_exp_f32 v51, v51
    v_exp_f32 v52, v52
    v_exp_f32 v53, v53
    v_exp_f32 v54, v54
    v_exp_f32 v55, v55
    v_exp_f32 v56, v56
    v_exp_f32 v57, v57
    v_exp_f32 v58, v58
    v_exp_f32 v59, v59
    v_exp_f32 v60, v60
    v_exp_f32 v61, v61
    v_exp_f32 v62, v62
    v_exp_f32 v63, v63
    v_mul_f32 v112, v112, v189
    v_mul_f32 v113, v113, v189
    v_mul_f32 v114, v114, v189
    v_mul_f32 v115, v115, v189
    v_mul_f32 v116, v116, v189
    v_mul_f32 v117, v117, v189
    v_mul_f32 v118, v118, v189
    v_mul_f32 v119, v119, v189
    v_mul_f32 v120, v120, v189
    v_mul_f32 v121, v121, v189
    v_mul_f32 v122, v122, v189
    v_cvt_pk_bf16_f32 v144, v48, v49
    v_cvt_pk_bf16_f32 v145, v50, v51
    v_cvt_pk_bf16_f32 v146, v52, v53
    v_cvt_pk_bf16_f32 v147, v54, v55
    v_cvt_pk_bf16_f32 v148, v56, v57
    v_cvt_pk_bf16_f32 v149, v58, v59
    v_cvt_pk_bf16_f32 v150, v60, v61
    v_cvt_pk_bf16_f32 v151, v62, v63
    s_nop 1
    v_mfma_f32_32x32x16_bf16 v[112:127], v[168:171], v[144:147], v[112:127]
    v_mfma_f32_32x32x16_bf16 v[112:127], v[172:175], v[148:151], v[112:127]
    s_nop 7
    v_mfma_f32_32x32x16_bf16 v[48:63], v[152:155], v[28:31], 0
    v_mfma_f32_32x32x16_bf16 v[48:63], v[160:163], v[44:47], v[48:63]
    s_nop 15
    v_max3_f32 v188, v48, v49, v50
    v_max3_f32 v188, v188, v51, v52
    v_max3_f32 v188, v188, v53, v54
    v_max3_f32 v188, v188, v55, v56
    v_max3_f32 v188, v188, v57, v58
    v_max3_f32 v188, v188, v59, v60
    v_max3_f32 v188, v188, v61, v62
    v_max_f32 v188, v188, v63
    v_mov_b32 v189, v188
    s_nop 1
    v_permlane32_swap_b32 v188, v189
    s_nop 1
    v_max_f32 v188, v188, v189
    v_max_f32 v188, v188, v187
    v_sub_f32 v189, v187, v188
    v_exp_f32 v189, v189
    v_mov_b32 v187, v188
    v_sub_f32 v48, v48, v188
    v_sub_f32 v49, v49, v188
    v_sub_f32 v50, v50, v188
    v_sub_f32 v51, v51, v188
    v_sub_f32 v52, v52, v188
    v_sub_f32 v53, v53, v188
    v_sub_f32 v54, v54, v188
    v_sub_f32 v55, v55, v188
    v_sub_f32 v56, v56, v188
    v_sub_f32 v57, v57, v188
    v_sub_f32 v58, v58, v188
    v_sub_f32 v59, v59, v188
    v_sub_f32 v60, v60, v188
    v_sub_f32 v61, v61, v188
    v_sub_f32 v62, v62, v188
    v_sub_f32 v63, v63, v188
    v_exp_f32 v48, v48
    v_exp_f32 v49, v49
    v_exp_f32 v50, v50
    v_exp_f32 v51, v51
    v_exp_f32 v52, v52
    v_exp_f32 v53, v53
    v_exp_f32 v54, v54
    v_exp_f32 v55, v55
    v_exp_f32 v56, v56
    v_exp_f32 v57, v57
    v_exp_f32 v58, v58
    v_exp_f32 v59, v59
    v_exp_f32 v60, v60
    v_exp_f32 v61, v61
    v_exp_f32 v62, v62
    v_exp_f32 v63, v63
    v_mul_f32 v128, v128, v189
    v_mul_f32 v129, v129, v189
    v_mul_f32 v130, v130, v189
    v_mul_f32 v131, v131, v189
    v_mul_f32 v132, v132, v189
    v_mul_f32 v133, v133, v189
    v_mul_f32 v134, v134, v189
    v_mul_f32 v135, v135, v189
    v_mul_f32 v136, v136, v189
    v_mul_f32 v137, v137, v189
    v_mul_f32 v138, v138, v189
    v_cvt_pk_bf16_f32 v144, v48, v49
    v_cvt_pk_bf16_f32 v145, v50, v51
    v_cvt_pk_bf16_f32 v146, v52, v53
    v_cvt_pk_bf16_f32 v147, v54, v55
    v_cvt_pk_bf16_f32 v148, v56, v57
    v_cvt_pk_bf16_f32 v149, v58, v59
    v_cvt_pk_bf16_f32 v150, v60, v61
    v_cvt_pk_bf16_f32 v151, v62, v63
    s_nop 1
    v_mfma_f32_32x32x16_bf16 v[128:143], v[168:171], v[144:147], v[128:143]
    v_mfma_f32_32x32x16_bf16 v[128:143], v[172:175], v[148:151], v[128:143]
    s_nop 7
    s_nop 15
    s_add_u32 s47, s47, 1
    s_cmp_lt_u32 s47, 4
    s_cbranch_scc1 L_at_fb_loop
    s_mov_b32 s47, 0
    s_add_u32 s29, s29, 20480
    s_add_u32 s35, s35, 1
    s_cmp_lt_u32 s35, 8
    s_cbranch_scc1 L_at_fb_loop
    v_mov_b32 v91, v184
    v_mov_b32 v107, v185
    v_mov_b32 v123, v186
    v_mov_b32 v139, v187
    s_branch L_at_combine
L_g1_end:
    s_endpgm
.section .rodata,"a"
.p2align 6
.amdhsa_kernel parallel_sum__softmax_full_mha__glu_gated_glu__prompt_kernel
  .amdhsa_next_free_vgpr 256
  .amdhsa_next_free_sgpr 102
  .amdhsa_accum_offset 256
  .amdhsa_group_segment_fixed_size 0
  .amdhsa_kernarg_size 80
  .amdhsa_user_sgpr_count 2
  .amdhsa_user_sgpr_kernarg_segment_ptr 1
  .amdhsa_system_sgpr_workgroup_id_x 1
.end_amdhsa_kernel
```
